```python
import torch

def _softmax(x, axis=-1):
    return torch.softmax(x, dim=axis)
def _gelu(x):
    return torch.nn.functional.gelu(x, approximate="tanh")
def _silu(x):
    return torch.nn.functional.silu(x)
def _sigmoid(x):
    return torch.sigmoid(x)
def _layernorm(x, axis=-1, eps=1e-5):
    m = x.mean(dim=axis, keepdim=True)
    v = x.var(dim=axis, keepdim=True, unbiased=False)
    return (x - m) / torch.sqrt(v + eps)
def _scatter_add(tgt, idx, src, axis=0):
    return tgt.clone().index_add_(axis, idx, src)
def _segment_sum(src, seg, n):
    out = torch.zeros((n,) + src.shape[1:], dtype=src.dtype)
    return out.index_add_(0, seg, src)
def _pad(x, pw):
    flat = tuple(v for pair in reversed(pw) for v in pair)
    return torch.nn.functional.pad(x, flat)

kernel_name = 'recurrent_scan__compressed_kv_cla__glu_gated_reglu__prompt'

def setup_inputs():

    _w = (lambda a: (lambda t: t.to(torch.bfloat16) if t.is_floating_point() else t)(torch.as_tensor(a)))
    def _A_setup():
        B, H, Sq, Sk, D, M = 1, 32, 2048, 2048, 128, 512
        Dc = 4 * D
        return {
            "x": _w((lambda *s: torch.randn(*s, dtype=torch.bfloat16) * 0.05)(B, Sq, M)),
            "c_kv": _w((lambda *s: torch.randn(*s, dtype=torch.bfloat16) * 1.6)(B, Sk, Dc)),
            "w_q": _w((lambda *s: torch.randn(*s, dtype=torch.bfloat16) * 1.6)(M, H, D) * (M ** -0.5)),
            "w_uk": _w((lambda *s: torch.randn(*s, dtype=torch.bfloat16) * 1.6)(Dc, H, D) * (Dc ** -0.5)),
            "w_uv": _w((lambda *s: torch.randn(*s, dtype=torch.bfloat16) * 1.6)(Dc, H, D) * (Dc ** -0.5)),
            "w_o": _w((lambda *s: torch.randn(*s, dtype=torch.bfloat16) * 1.6)(H, D, M) * ((H * D) ** -0.5)),
        }
    _A_in = _A_setup()

    def _B_setup():
        B, S, D, F = 1, 2048, 512, 1376
        return {
            "x": _w((lambda *s: torch.randn(*s, dtype=torch.bfloat16) * 0.05)(B, S, D)),
            "W_gate": _w((lambda *s: torch.randn(*s, dtype=torch.bfloat16) * 0.2)(D, F) * (2.0 / D) ** 0.5),
            "W_up": _w((lambda *s: torch.randn(*s, dtype=torch.bfloat16) * 0.2)(D, F) * (2.0 / D) ** 0.5),
            "W_down": _w((lambda *s: torch.randn(*s, dtype=torch.bfloat16) * 0.2)(F, D) * (1.0 / F) ** 0.5),
        }
    _B_in = _B_setup()

    return {
        "A_x": _A_in["x"],
        "A_c_kv": _A_in["c_kv"],
        "A_w_q": _A_in["w_q"],
        "A_w_uk": _A_in["w_uk"],
        "A_w_uv": _A_in["w_uv"],
        "A_w_o": _A_in["w_o"],
        "B_x": _B_in["x"],
        "B_W_gate": _B_in["W_gate"],
        "B_W_up": _B_in["W_up"],
        "B_W_down": _B_in["W_down"],
    }

def reference(A_x, A_c_kv, A_w_q, A_w_uk, A_w_uv, A_w_o, B_x, B_W_gate, B_W_up, B_W_down):
    def _A_ref(x, c_kv, w_q, w_uk, w_uv, w_o):
        B, Sq, M = x.shape[0], x.shape[1], x.shape[2]
        Sk = c_kv.shape[1]
        H, D = w_q.shape[1], w_q.shape[2]
        q = torch.einsum("bqm,mhd->bhqd", x, w_q)
        k = torch.einsum("bkc,chd->bhkd", c_kv, w_uk)
        v = torch.einsum("bkc,chd->bhkd", c_kv, w_uv)
        scores = torch.einsum("bhqd,bhkd->bhqk", q, k) * (D ** -0.5)
        off = Sk - Sq
        qi = torch.arange(Sq)[:, None]
        kj = torch.arange(Sk)[None, :]
        cmask = kj <= (qi + off)
        scores = torch.where(cmask[None, None], scores, -1e9)
        p = _softmax(scores, axis=-1)
        ctx = torch.einsum("bhqk,bhkd->bhqd", p, v)
        return torch.einsum("bhqd,hdm->bqm", ctx, w_o)

    def _B_ref(x, W_gate, W_up, W_down):
        gate = torch.einsum("bsd,df->bsf", x, W_gate)
        up = torch.einsum("bsd,df->bsf", x, W_up)
        gate = gate * (lambda x, dt: x.to(dt))(gate > 0, gate.dtype)
        h = gate * up
        return torch.einsum("bsf,fd->bsd", h, W_down)

    x = A_x
    xn = _layernorm(x, axis=-1)
    s = _A_ref(xn, A_c_kv, A_w_q, A_w_uk, A_w_uv, A_w_o)
    g = _silu(_B_ref(xn, B_W_gate, B_W_up, B_W_down))
    return x + s * g
```

```asm
; @launch grid=(256,1,1) block=(512,1,1) lds=163840
.amdgcn_target "amdgcn-amd-amdhsa--gfx950"
.text
.globl recurrent_scan__compressed_kv_cla__glu_gated_reglu__prompt_kernel
.p2align 8
.type recurrent_scan__compressed_kv_cla__glu_gated_reglu__prompt_kernel,@function
recurrent_scan__compressed_kv_cla__glu_gated_reglu__prompt_kernel:
    s_cmp_ge_u32 s2, 256
    s_cbranch_scc1 f_end
    s_load_dwordx16 s[64:79], s[0:1], 0
    s_load_dwordx8 s[80:87], s[0:1], 64
    s_load_dwordx2 s[88:89], s[0:1], 96
    s_memrealtime s[100:101]
    v_and_b32 v248, 63, v0
    v_lshrrev_b32 v1, 6, v0
    s_nop 0
    v_readfirstlane_b32 s3, v1
    v_lshlrev_b32 v0, 4, v248
    s_and_b32 s4, s2, 7
    s_lshl_b32 s4, s4, 2
    s_bfe_u32 s32, s2, 0x20003
    s_add_u32 s4, s4, s32
    s_lshr_b32 s5, s2, 5
    s_getpc_b64 s[60:61]
    s_andn2_b32 s32, s2, 7
    s_add_u32 s32, s32, s3
    s_lshl_b32 s32, s32, 8
    v_lshlrev_b32 v1, 3, v0
    v_add_u32 v1, s32, v1
    s_cmp_lt_u32 s32, (f_code_end - recurrent_scan__compressed_kv_cla__glu_gated_reglu__prompt_kernel - 512)
    s_cbranch_scc0 f_nocpf
    s_mov_b64 exec, 3
    global_load_dword v212, v1, s[60:61]
    s_mov_b64 exec, -1
f_nocpf:
    s_and_b32 s45, s2, 7
    s_lshr_b32 s46, s3, 2
    s_add_u32 s46, s46, s45
    s_lshr_b32 s52, s3, 2
    s_lshl_b32 s47, s3, 16
    s_and_b32 s48, s3, 3
    s_lshl_b32 s48, s48, 17
    s_add_u32 s48, s48, 128
    s_lshl_b32 s56, s3, 10
    s_add_u32 s56, s56, 16384
    s_mov_b64 s[58:59], 0xffff
    v_bfe_u32 v1, v248, 1, 2
    v_and_b32 v2, 1, v248
    v_lshlrev_b32 v2, 7, v2
    v_lshl_add_u32 v1, v1, 13, v2
    v_lshrrev_b32 v2, 4, v248
    v_lshl_add_u32 v1, v2, 19, v1
    v_and_b32 v3, 15, v248
    v_mov_b32 v21, 0x7f000000
    v_cmp_gt_u32 vcc, 8, v3
    s_nop 1
    v_cndmask_b32 v21, v21, v1, vcc
    v_lshlrev_b32 v1, 10, v3
    v_lshl_add_u32 v1, v2, 7, v1
    s_and_b32 s33, s3, 1
    s_lshl_b32 s35, s5, 16
    s_lshl_b32 s32, s4, 8
    s_add_u32 s35, s35, s32
    s_lshl_b32 s32, s33, 15
    s_add_u32 s35, s35, s32
    s_lshl_b32 s32, s5, 2
    s_and_b32 s53, s4, 3
    s_add_u32 s32, s32, s53
    s_lshl_b32 s32, s32, 16
    s_lshl_b32 s33, s3, 14
    s_add_u32 s32, s32, s33
    s_mov_b32 s53, 512
    s_cmp_lt_u32 s3, 6
    s_waitcnt lgkmcnt(0)
    s_cselect_b32 s24, s70, s72
    s_cselect_b32 s25, s71, s73
    s_mov_b32 s26, 0x400000
    s_cmp_lt_u32 s3, 4
    s_cselect_b32 s54, s32, s35
    s_cselect_b32 s53, s53, 2097152
    s_cselect_b32 s24, s66, s24
    s_cselect_b32 s25, s67, s25
    s_cselect_b32 s26, 0x200000, s26
    s_mov_b32 s27, 0x20000
    s_cselect_b64 vcc, -1, 0
    s_and_b32 s25, s25, 0xffff
    v_cndmask_b32 v23, v21, v1, vcc
    s_add_u32 s53, s53, s54
    s_add_u32 s32, s45, 0
    s_lshl_b32 s33, s32, 4
    s_lshl_b64 exec, s[58:59], s33
    s_bitcmp1_b32 s32, 2
    s_cselect_b32 s32, s53, s54
    buffer_load_dword v204, v23, s[24:27], s32 offen
    s_mov_b64 exec, -1
    s_lshr_b32 s32, s3, 1
    s_lshl_b32 s32, s32, 20
    s_add_u32 s35, s35, s32
    v_mov_b32 v1, 0x7f000000
    v_cmp_gt_u32 vcc, 32, v248
    s_nop 1
    v_cndmask_b32 v21, v1, v21, vcc
    v_lshrrev_b32 v1, 4, v248
    v_bfe_u32 v2, v248, 2, 2
    v_xor_b32 v2, v2, v1
    v_lshlrev_b32 v2, 6, v2
    v_lshl_add_u32 v2, v1, 13, v2
    v_and_b32 v3, 3, v248
    v_lshl_add_u32 v2, v3, 4, v2
    s_lshl_b32 s32, s4, 8
    s_lshl_b32 s33, s3, 16
    s_add_u32 s32, s32, s33
    v_add_u32 v4, s32, v2
    s_and_b32 s42, s3, 1
    s_lshl_b32 s42, s42, 5
    v_xor_b32 v4, s42, v4
    s_lshl_b32 s32, s5, 18
    s_lshl_b32 s33, s3, 15
    s_add_u32 s34, s32, s33
    v_and_b32 v2, 7, v248
    v_xor_b32 v2, v2, v1
    v_lshrrev_b32 v3, 3, v248
    v_lshlrev_b32 v3, 10, v3
    v_add_u32 v3, s34, v3
    v_lshl_add_u32 v9, v2, 4, v3
    v_xor_b32 v2, 4, v2
    v_lshl_add_u32 v10, v2, 4, v3
    v_add_u32 v10, 0x2000, v10
    s_lshl_b32 s6, s3, 11
    s_lshl_b32 s7, s3, 13
    s_add_u32 s7, s7, 73728
    s_mov_b32 s8, s66
    s_and_b32 s9, s67, 0xffff
    s_mov_b32 s10, 0x200000
    s_mov_b32 s11, 0x20000
    s_mov_b32 s12, s70
    s_and_b32 s13, s71, 0xffff
    s_mov_b32 s14, 0x400000
    s_mov_b32 s15, 0x20000
    s_mov_b32 s16, s72
    s_and_b32 s17, s73, 0xffff
    s_mov_b32 s18, 0x400000
    s_mov_b32 s19, 0x20000
    v_lshrrev_b32 v3, 3, v248
    v_lshlrev_b32 v3, 13, v3
    v_and_b32 v2, 7, v248
    v_lshl_add_u32 v3, v2, 4, v3
    v_and_b32 v2, 16, v248
    v_lshlrev_b32 v2, 2, v2
    v_xor_b32 v3, v3, v2
    v_xor_b32 v3, s42, v3
    s_lshl_b32 s32, s4, 8
    v_add_u32 v17, s32, v3
    s_mov_b32 s40, s42
    s_sub_u32 s32, 15, s5
    s_cmp_lt_u32 s4, 16
    s_cselect_b32 s32, s5, s32
    s_lshl_b32 s32, s32, 4
    s_and_b32 s33, s4, 15
    s_add_u32 s32, s32, s33
    s_lshl_b32 s32, s32, 3
    s_add_u32 s36, s32, s3
    s_lshl_b32 s32, s36, 10
    s_mov_b32 s28, s64
    s_and_b32 s29, s65, 0xffff
    s_mov_b32 s30, 0x200000
    s_mov_b32 s31, 0x20000
    buffer_load_dwordx4 v[196:199], v0, s[28:31], s32 offen
    s_mov_b32 s20, s88
    s_and_b32 s21, s89, 0xffff
    s_mov_b32 s22, 0x4880000
    s_mov_b32 s23, 0x20000
    s_mov_b32 s28, s86
    s_and_b32 s29, s87, 0xffff
    s_mov_b32 s30, 0x100
    s_mov_b32 s31, 0x20000
    s_or_b32 s32, s2, s3
    s_cmp_lg_u32 s32, 0
    s_cbranch_scc1 f_nononce
    s_or_b32 s100, s100, 1
    v_mov_b32 v1, s100
    v_mov_b32 v2, 0
    s_mov_b64 exec, 1
    buffer_store_dword v1, v2, s[28:31], 0 offen sc1
    s_mov_b64 exec, -1
f_nononce:
    v_bfe_u32 v1, v248, 2, 2
    v_lshrrev_b32 v2, 4, v248
    v_lshl_add_u32 v2, v2, 3, v1
    v_and_b32 v3, 3, v248
    v_lshlrev_b32 v3, 3, v3
    v_lshl_add_u32 v5, v2, 8, v3
    v_lshl_add_u32 v5, v1, 6, v5
    v_lshl_add_u32 v18, v2, 7, v3
    v_bfe_u32 v1, v248, 4, 1
    v_lshl_add_u32 v5, v1, 5, v5
    v_xor_b32 v6, 64, v5
    v_xor_b32 v7, 128, v5
    v_xor_b32 v8, 192, v5
    v_xor_b32 v15, 32, v5
    v_xor_b32 v16, 96, v5
    v_xor_b32 v11, 160, v5
    v_xor_b32 v12, 224, v5
    v_bfe_u32 v2, v248, 3, 1
    v_lshl_add_u32 v2, v2, 1, v1
    v_lshl_add_u32 v18, v2, 5, v18
    v_add_u32 v18, 0x4000, v18
    v_xor_b32 v19, 32, v18
    v_xor_b32 v20, 64, v18
    v_xor_b32 v22, 96, v18
    v_and_b32 v1, 15, v248
    v_bfe_u32 v2, v248, 1, 3
    v_lshrrev_b32 v3, 4, v248
    v_xor_b32 v2, v2, v3
    v_lshlrev_b32 v2, 4, v2
    v_lshl_add_u32 v2, v1, 7, v2
    v_add_u32 v13, s7, v2
    v_xor_b32 v14, 64, v13
    s_mov_b32 s38, 0x40000
    s_waitcnt vmcnt(1)
    s_add_u32 s50, s45, 0
    s_and_b32 s50, s50, 7
    s_add_u32 m0, s6, 0
    s_lshl_b32 s44, s50, 19
    buffer_load_dwordx4 v4, s[12:15], s44 offen lds
    s_lshl_b32 s50, s50, 7
    s_add_u32 m0, s6, 1024
    s_add_u32 s32, s44, 32768
    buffer_load_dwordx4 v4, s[12:15], s32 offen lds
    s_add_u32 m0, s56, 0
    s_add_u32 s32, s44, s47
    buffer_load_dwordx4 v17, s[16:19], s32 offen lds
    s_add_u32 m0, s7, 0
    s_add_u32 s32, s50, 0
    buffer_load_dwordx4 v9, s[8:11], s32 offen lds
    s_add_u32 m0, s7, 1024
    s_add_u32 s32, s50, 0
    buffer_load_dwordx4 v10, s[8:11], s32 offen lds
    s_add_u32 m0, s7, 2048
    s_add_u32 s32, s50, 16384
    buffer_load_dwordx4 v9, s[8:11], s32 offen lds
    s_add_u32 m0, s7, 3072
    s_add_u32 s32, s50, 16384
    buffer_load_dwordx4 v10, s[8:11], s32 offen lds
    s_add_u32 s32, s45, 1
    s_lshl_b32 s33, s32, 4
    s_lshl_b64 exec, s[58:59], s33
    s_bitcmp1_b32 s32, 2
    s_cselect_b32 s32, s53, s54
    buffer_load_dword v205, v23, s[24:27], s32 offen
    s_mov_b64 exec, -1
    s_add_u32 s32, s45, 2
    s_lshl_b32 s33, s32, 4
    s_lshl_b64 exec, s[58:59], s33
    s_bitcmp1_b32 s32, 2
    s_cselect_b32 s32, s53, s54
    buffer_load_dword v206, v23, s[24:27], s32 offen
    s_mov_b64 exec, -1
    s_waitcnt vmcnt(6)
    s_barrier
    s_waitcnt vmcnt(2)
    ds_read_b128 v[120:123], v13 offset:0
    ds_read_b128 v[124:127], v13 offset:2048
    ds_read_b128 v[128:131], v14 offset:0
    ds_read_b128 v[132:135], v14 offset:2048
    ds_read_b64_tr_b16 v[24:25], v5 offset:0
    ds_read_b64_tr_b16 v[26:27], v5 offset:1024
    ds_read_b64_tr_b16 v[28:29], v5 offset:8192
    ds_read_b64_tr_b16 v[30:31], v5 offset:9216
    ds_read_b64_tr_b16 v[32:33], v15 offset:0
    ds_read_b64_tr_b16 v[34:35], v15 offset:1024
    ds_read_b64_tr_b16 v[36:37], v15 offset:8192
    ds_read_b64_tr_b16 v[38:39], v15 offset:9216
    ds_read_b64_tr_b16 v[40:41], v6 offset:0
    ds_read_b64_tr_b16 v[42:43], v6 offset:1024
    ds_read_b64_tr_b16 v[44:45], v6 offset:8192
    ds_read_b64_tr_b16 v[46:47], v6 offset:9216
    ds_read_b64_tr_b16 v[48:49], v16 offset:0
    ds_read_b64_tr_b16 v[50:51], v16 offset:1024
    s_waitcnt lgkmcnt(12)
    v_mfma_f32_16x16x32_bf16 v[56:59], v[24:27], v[120:123], 0
    ds_read_b64_tr_b16 v[52:53], v16 offset:8192
    s_waitcnt lgkmcnt(11)
    v_mfma_f32_16x16x32_bf16 v[56:59], v[28:31], v[128:131], v[56:59]
    ds_read_b64_tr_b16 v[54:55], v16 offset:9216
    v_mfma_f32_16x16x32_bf16 v[64:67], v[24:27], v[124:127], 0
    ds_read_b64_tr_b16 v[24:25], v7 offset:0
    v_mfma_f32_16x16x32_bf16 v[64:67], v[28:31], v[132:135], v[64:67]
    ds_read_b64_tr_b16 v[26:27], v7 offset:1024
    s_waitcnt lgkmcnt(12)
    v_mfma_f32_16x16x32_bf16 v[60:63], v[32:35], v[120:123], 0
    ds_read_b64_tr_b16 v[28:29], v7 offset:8192
    s_waitcnt lgkmcnt(11)
    v_mfma_f32_16x16x32_bf16 v[60:63], v[36:39], v[128:131], v[60:63]
    ds_read_b64_tr_b16 v[30:31], v7 offset:9216
    v_lshlrev_b32 v184, 16, v196
    v_and_b32 v185, 0xffff0000, v196
    v_mfma_f32_16x16x32_bf16 v[68:71], v[32:35], v[124:127], 0
    ds_read_b64_tr_b16 v[32:33], v11 offset:0
    v_mfma_f32_16x16x32_bf16 v[68:71], v[36:39], v[132:135], v[68:71]
    ds_read_b64_tr_b16 v[34:35], v11 offset:1024
    v_lshlrev_b32 v186, 16, v197
    v_and_b32 v187, 0xffff0000, v197
    s_waitcnt lgkmcnt(12)
    v_mfma_f32_16x16x32_bf16 v[72:75], v[40:43], v[120:123], 0
    ds_read_b64_tr_b16 v[36:37], v11 offset:8192
    s_waitcnt lgkmcnt(11)
    v_mfma_f32_16x16x32_bf16 v[72:75], v[44:47], v[128:131], v[72:75]
    ds_read_b64_tr_b16 v[38:39], v11 offset:9216
    v_lshlrev_b32 v188, 16, v198
    v_and_b32 v189, 0xffff0000, v198
    v_mfma_f32_16x16x32_bf16 v[80:83], v[40:43], v[124:127], 0
    ds_read_b64_tr_b16 v[40:41], v8 offset:0
    v_mfma_f32_16x16x32_bf16 v[80:83], v[44:47], v[132:135], v[80:83]
    ds_read_b64_tr_b16 v[42:43], v8 offset:1024
    v_lshlrev_b32 v190, 16, v199
    v_and_b32 v191, 0xffff0000, v199
    s_waitcnt lgkmcnt(12)
    v_mfma_f32_16x16x32_bf16 v[76:79], v[48:51], v[120:123], 0
    ds_read_b64_tr_b16 v[44:45], v8 offset:8192
    s_waitcnt lgkmcnt(11)
    v_mfma_f32_16x16x32_bf16 v[76:79], v[52:55], v[128:131], v[76:79]
    ds_read_b64_tr_b16 v[46:47], v8 offset:9216
    v_add_f32 v192, v184, v185
    v_add_f32 v192, v192, v186
    v_mfma_f32_16x16x32_bf16 v[84:87], v[48:51], v[124:127], 0
    ds_read_b64_tr_b16 v[48:49], v12 offset:0
    v_mfma_f32_16x16x32_bf16 v[84:87], v[52:55], v[132:135], v[84:87]
    ds_read_b64_tr_b16 v[50:51], v12 offset:1024
    v_add_f32 v192, v192, v187
    v_add_f32 v192, v192, v188
    s_add_u32 s50, s45, 1
    s_and_b32 s50, s50, 7
    s_add_u32 m0, s6, 24576
    s_lshl_b32 s44, s50, 19
    buffer_load_dwordx4 v4, s[12:15], s44 offen lds
    s_lshl_b32 s50, s50, 7
    s_waitcnt lgkmcnt(12)
    v_mfma_f32_16x16x32_bf16 v[88:91], v[24:27], v[120:123], 0
    ds_read_b64_tr_b16 v[52:53], v12 offset:8192
    s_waitcnt lgkmcnt(11)
    v_mfma_f32_16x16x32_bf16 v[88:91], v[28:31], v[128:131], v[88:91]
    ds_read_b64_tr_b16 v[54:55], v12 offset:9216
    v_add_f32 v192, v192, v189
    v_add_f32 v192, v192, v190
    s_add_u32 m0, s7, 4096
    s_add_u32 s32, s50, 0
    buffer_load_dwordx4 v9, s[8:11], s32 offen lds
    v_mfma_f32_16x16x32_bf16 v[96:99], v[24:27], v[124:127], 0
    ds_read_b64_tr_b16 v[24:25], v18 offset:0
    v_mfma_f32_16x16x32_bf16 v[96:99], v[28:31], v[132:135], v[96:99]
    ds_read_b64_tr_b16 v[26:27], v18 offset:512
    v_add_f32 v192, v192, v191
    s_nop 1
    v_add_f32_dpp v192, v192, v192 quad_perm:[1,0,3,2] row_mask:0xf bank_mask:0xf
    s_add_u32 m0, s7, 5120
    s_add_u32 s32, s50, 0
    buffer_load_dwordx4 v10, s[8:11], s32 offen lds
    s_waitcnt lgkmcnt(12)
    v_mfma_f32_16x16x32_bf16 v[92:95], v[32:35], v[120:123], 0
    ds_read_b64_tr_b16 v[28:29], v18 offset:4096
    s_waitcnt lgkmcnt(11)
    v_mfma_f32_16x16x32_bf16 v[92:95], v[36:39], v[128:131], v[92:95]
    ds_read_b64_tr_b16 v[30:31], v18 offset:4608
    v_add_f32_dpp v192, v192, v192 quad_perm:[2,3,0,1] row_mask:0xf bank_mask:0xf
    s_nop 1
    v_add_f32_dpp v192, v192, v192 row_half_mirror row_mask:0xf bank_mask:0xf
    s_add_u32 m0, s7, 6144
    s_add_u32 s32, s50, 16384
    buffer_load_dwordx4 v9, s[8:11], s32 offen lds
    v_mfma_f32_16x16x32_bf16 v[100:103], v[32:35], v[124:127], 0
    ds_read_b64_tr_b16 v[32:33], v19 offset:0
    v_mfma_f32_16x16x32_bf16 v[100:103], v[36:39], v[132:135], v[100:103]
    ds_read_b64_tr_b16 v[34:35], v19 offset:512
    v_add_f32_dpp v192, v192, v192 row_mirror row_mask:0xf bank_mask:0xf
    v_mov_b32 v193, v192
    s_add_u32 m0, s7, 7168
    s_add_u32 s32, s50, 16384
    buffer_load_dwordx4 v10, s[8:11], s32 offen lds
    s_waitcnt lgkmcnt(12)
    v_mfma_f32_16x16x32_bf16 v[104:107], v[40:43], v[120:123], 0
    ds_read_b64_tr_b16 v[36:37], v19 offset:4096
    s_waitcnt lgkmcnt(11)
    v_mfma_f32_16x16x32_bf16 v[104:107], v[44:47], v[128:131], v[104:107]
    ds_read_b64_tr_b16 v[38:39], v19 offset:4608
    v_permlane16_swap_b32 v192, v193
    v_add_f32 v192, v192, v193
    s_add_u32 m0, s6, 25600
    s_add_u32 s32, s44, 32768
    buffer_load_dwordx4 v4, s[12:15], s32 offen lds
    v_mfma_f32_16x16x32_bf16 v[112:115], v[40:43], v[124:127], 0
    ds_read_b64_tr_b16 v[40:41], v20 offset:0
    v_mfma_f32_16x16x32_bf16 v[112:115], v[44:47], v[132:135], v[112:115]
    ds_read_b64_tr_b16 v[42:43], v20 offset:512
    v_mov_b32 v193, v192
    s_nop 1
    v_permlane32_swap_b32 v192, v193
    s_add_u32 m0, s56, 24576
    s_add_u32 s32, s44, s47
    buffer_load_dwordx4 v17, s[16:19], s32 offen lds
    s_waitcnt lgkmcnt(12)
    v_mfma_f32_16x16x32_bf16 v[108:111], v[48:51], v[120:123], 0
    ds_read_b64_tr_b16 v[44:45], v20 offset:4096
    s_waitcnt lgkmcnt(11)
    v_mfma_f32_16x16x32_bf16 v[108:111], v[52:55], v[128:131], v[108:111]
    ds_read_b64_tr_b16 v[46:47], v20 offset:4608
    v_add_f32 v192, v192, v193
    v_mul_f32 v192, 0x3b000000, v192
    s_add_u32 s50, s45, 2
    s_and_b32 s50, s50, 7
    s_add_u32 m0, s6, 49152
    s_lshl_b32 s44, s50, 19
    buffer_load_dwordx4 v4, s[12:15], s44 offen lds
    s_lshl_b32 s50, s50, 7
    v_mfma_f32_16x16x32_bf16 v[116:119], v[48:51], v[124:127], 0
    ds_read_b64_tr_b16 v[48:49], v22 offset:0
    v_mfma_f32_16x16x32_bf16 v[116:119], v[52:55], v[132:135], v[116:119]
    ds_read_b64_tr_b16 v[50:51], v22 offset:512
    v_sub_f32 v168, v184, v192
    v_sub_f32 v169, v185, v192
    s_add_u32 m0, s7, 0
    s_add_u32 s32, s50, 0
    buffer_load_dwordx4 v9, s[8:11], s32 offen lds
    s_waitcnt lgkmcnt(12)
    v_mfma_f32_16x16x32_bf16 v[216:219], v[120:123], v[24:27], 0
    ds_read_b64_tr_b16 v[52:53], v22 offset:4096
    s_waitcnt lgkmcnt(11)
    v_mfma_f32_16x16x32_bf16 v[216:219], v[128:131], v[28:31], v[216:219]
    ds_read_b64_tr_b16 v[54:55], v22 offset:4608
    v_sub_f32 v170, v186, v192
    v_sub_f32 v171, v187, v192
    s_add_u32 m0, s7, 1024
    s_add_u32 s32, s50, 0
    buffer_load_dwordx4 v10, s[8:11], s32 offen lds
    v_mfma_f32_16x16x32_bf16 v[220:223], v[124:127], v[24:27], 0
    v_mfma_f32_16x16x32_bf16 v[220:223], v[132:135], v[28:31], v[220:223]
    v_sub_f32 v172, v188, v192
    v_sub_f32 v173, v189, v192
    s_add_u32 m0, s7, 2048
    s_add_u32 s32, s50, 16384
    buffer_load_dwordx4 v9, s[8:11], s32 offen lds
    s_waitcnt lgkmcnt(10)
    v_mfma_f32_16x16x32_bf16 v[224:227], v[120:123], v[32:35], 0
    s_waitcnt lgkmcnt(8)
    v_mfma_f32_16x16x32_bf16 v[224:227], v[128:131], v[36:39], v[224:227]
    s_waitcnt vmcnt(6)
    ds_read_b128 v[136:139], v13 offset:4096
    ds_read_b128 v[140:143], v13 offset:6144
    ds_read_b128 v[144:147], v14 offset:4096
    ds_read_b128 v[148:151], v14 offset:6144
    v_sub_f32 v174, v190, v192
    v_sub_f32 v175, v191, v192
    s_add_u32 m0, s7, 3072
    s_add_u32 s32, s50, 16384
    buffer_load_dwordx4 v10, s[8:11], s32 offen lds
    v_mfma_f32_16x16x32_bf16 v[228:231], v[124:127], v[32:35], 0
    v_mfma_f32_16x16x32_bf16 v[228:231], v[132:135], v[36:39], v[228:231]
    v_mov_b32 v194, v192
    v_mul_f32 v192, v168, v168
    s_add_u32 m0, s6, 50176
    s_add_u32 s32, s44, 32768
    buffer_load_dwordx4 v4, s[12:15], s32 offen lds
    s_waitcnt lgkmcnt(10)
    v_mfma_f32_16x16x32_bf16 v[232:235], v[120:123], v[40:43], 0
    s_waitcnt lgkmcnt(8)
    v_mfma_f32_16x16x32_bf16 v[232:235], v[128:131], v[44:47], v[232:235]
    s_waitcnt vmcnt(6) lgkmcnt(4)
    s_barrier
    ds_read_b64_tr_b16 v[24:25], v5 offset:24576
    ds_read_b64_tr_b16 v[26:27], v5 offset:25600
    ds_read_b64_tr_b16 v[28:29], v5 offset:32768
    ds_read_b64_tr_b16 v[30:31], v5 offset:33792
    ds_read_b64_tr_b16 v[32:33], v15 offset:24576
    ds_read_b64_tr_b16 v[34:35], v15 offset:25600
    ds_read_b64_tr_b16 v[36:37], v15 offset:32768
    ds_read_b64_tr_b16 v[38:39], v15 offset:33792
    v_fmac_f32 v192, v169, v169
    v_fmac_f32 v192, v170, v170
    s_add_u32 m0, s56, 49152
    s_add_u32 s32, s44, s47
    buffer_load_dwordx4 v17, s[16:19], s32 offen lds
    v_mfma_f32_16x16x32_bf16 v[236:239], v[124:127], v[40:43], 0
    ds_read_b64_tr_b16 v[40:41], v6 offset:24576
    v_mfma_f32_16x16x32_bf16 v[236:239], v[132:135], v[44:47], v[236:239]
    ds_read_b64_tr_b16 v[42:43], v6 offset:25600
    v_fmac_f32 v192, v171, v171
    v_fmac_f32 v192, v172, v172
    s_add_u32 s32, s45, 3
    s_lshl_b32 s33, s32, 4
    s_lshl_b64 exec, s[58:59], s33
    s_bitcmp1_b32 s32, 2
    s_cselect_b32 s32, s53, s54
    buffer_load_dword v207, v23, s[24:27], s32 offen
    s_mov_b64 exec, -1
    s_add_u32 s32, s45, 4
    s_lshl_b32 s33, s32, 4
    s_lshl_b64 exec, s[58:59], s33
    s_bitcmp1_b32 s32, 2
    s_cselect_b32 s32, s53, s54
    buffer_load_dword v208, v23, s[24:27], s32 offen
    s_mov_b64 exec, -1
    v_mfma_f32_16x16x32_bf16 v[240:243], v[120:123], v[48:51], 0
    ds_read_b64_tr_b16 v[44:45], v6 offset:32768
    v_mfma_f32_16x16x32_bf16 v[240:243], v[128:131], v[52:55], v[240:243]
    ds_read_b64_tr_b16 v[46:47], v6 offset:33792
    v_fmac_f32 v192, v173, v173
    v_fmac_f32 v192, v174, v174
    v_mfma_f32_16x16x32_bf16 v[244:247], v[124:127], v[48:51], 0
    ds_read_b64_tr_b16 v[48:49], v16 offset:24576
    v_mfma_f32_16x16x32_bf16 v[244:247], v[132:135], v[52:55], v[244:247]
    ds_read_b64_tr_b16 v[50:51], v16 offset:25600
    v_fmac_f32 v192, v175, v175
    s_nop 1
    v_add_f32_dpp v192, v192, v192 quad_perm:[1,0,3,2] row_mask:0xf bank_mask:0xf
    s_waitcnt lgkmcnt(12)
    v_mfma_f32_16x16x32_bf16 v[56:59], v[24:27], v[136:139], v[56:59]
    ds_read_b64_tr_b16 v[52:53], v16 offset:32768
    s_waitcnt lgkmcnt(11)
    v_mfma_f32_16x16x32_bf16 v[56:59], v[28:31], v[144:147], v[56:59]
    ds_read_b64_tr_b16 v[54:55], v16 offset:33792
    v_add_f32_dpp v192, v192, v192 quad_perm:[2,3,0,1] row_mask:0xf bank_mask:0xf
    s_nop 1
    v_add_f32_dpp v192, v192, v192 row_half_mirror row_mask:0xf bank_mask:0xf
    v_mfma_f32_16x16x32_bf16 v[64:67], v[24:27], v[140:143], v[64:67]
    ds_read_b64_tr_b16 v[24:25], v7 offset:24576
    v_mfma_f32_16x16x32_bf16 v[64:67], v[28:31], v[148:151], v[64:67]
    ds_read_b64_tr_b16 v[26:27], v7 offset:25600
    v_add_f32_dpp v192, v192, v192 row_mirror row_mask:0xf bank_mask:0xf
    v_mov_b32 v193, v192
    s_waitcnt lgkmcnt(12)
    v_mfma_f32_16x16x32_bf16 v[60:63], v[32:35], v[136:139], v[60:63]
    ds_read_b64_tr_b16 v[28:29], v7 offset:32768
    s_waitcnt lgkmcnt(11)
    v_mfma_f32_16x16x32_bf16 v[60:63], v[36:39], v[144:147], v[60:63]
    ds_read_b64_tr_b16 v[30:31], v7 offset:33792
    v_permlane16_swap_b32 v192, v193
    v_add_f32 v192, v192, v193
    v_mfma_f32_16x16x32_bf16 v[68:71], v[32:35], v[140:143], v[68:71]
    ds_read_b64_tr_b16 v[32:33], v11 offset:24576
    v_mfma_f32_16x16x32_bf16 v[68:71], v[36:39], v[148:151], v[68:71]
    ds_read_b64_tr_b16 v[34:35], v11 offset:25600
    v_mov_b32 v193, v192
    s_nop 1
    v_permlane32_swap_b32 v192, v193
    s_waitcnt lgkmcnt(12)
    v_mfma_f32_16x16x32_bf16 v[72:75], v[40:43], v[136:139], v[72:75]
    ds_read_b64_tr_b16 v[36:37], v11 offset:32768
    s_waitcnt lgkmcnt(11)
    v_mfma_f32_16x16x32_bf16 v[72:75], v[44:47], v[144:147], v[72:75]
    ds_read_b64_tr_b16 v[38:39], v11 offset:33792
    v_add_f32 v192, v192, v193
    v_mul_f32 v192, 0x3b000000, v192
    v_mfma_f32_16x16x32_bf16 v[80:83], v[40:43], v[140:143], v[80:83]
    ds_read_b64_tr_b16 v[40:41], v8 offset:24576
    v_mfma_f32_16x16x32_bf16 v[80:83], v[44:47], v[148:151], v[80:83]
    ds_read_b64_tr_b16 v[42:43], v8 offset:25600
    v_cvt_pk_bf16_f32 v192, v192, v192
    v_lshlrev_b32 v192, 16, v192
    s_waitcnt lgkmcnt(12)
    v_mfma_f32_16x16x32_bf16 v[76:79], v[48:51], v[136:139], v[76:79]
    ds_read_b64_tr_b16 v[44:45], v8 offset:32768
    s_waitcnt lgkmcnt(11)
    v_mfma_f32_16x16x32_bf16 v[76:79], v[52:55], v[144:147], v[76:79]
    ds_read_b64_tr_b16 v[46:47], v8 offset:33792
    v_cvt_pk_bf16_f32 v194, v194, v194
    v_lshlrev_b32 v194, 16, v194
    v_mfma_f32_16x16x32_bf16 v[84:87], v[48:51], v[140:143], v[84:87]
    ds_read_b64_tr_b16 v[48:49], v12 offset:24576
    v_mfma_f32_16x16x32_bf16 v[84:87], v[52:55], v[148:151], v[84:87]
    ds_read_b64_tr_b16 v[50:51], v12 offset:25600
    v_add_f32 v192, 0x3727c5ac, v192
    v_cvt_pk_bf16_f32 v192, v192, v192
    s_waitcnt lgkmcnt(12)
    v_mfma_f32_16x16x32_bf16 v[88:91], v[24:27], v[136:139], v[88:91]
    ds_read_b64_tr_b16 v[52:53], v12 offset:32768
    s_waitcnt lgkmcnt(11)
    v_mfma_f32_16x16x32_bf16 v[88:91], v[28:31], v[144:147], v[88:91]
    ds_read_b64_tr_b16 v[54:55], v12 offset:33792
    v_lshlrev_b32 v192, 16, v192
    v_sqrt_f32 v192, v192
    v_mfma_f32_16x16x32_bf16 v[96:99], v[24:27], v[140:143], v[96:99]
    ds_read_b64_tr_b16 v[24:25], v18 offset:24576
    v_mfma_f32_16x16x32_bf16 v[96:99], v[28:31], v[148:151], v[96:99]
    ds_read_b64_tr_b16 v[26:27], v18 offset:25088
    v_cvt_pk_bf16_f32 v192, v192, v192
    v_lshlrev_b32 v192, 16, v192
    s_waitcnt lgkmcnt(12)
    v_mfma_f32_16x16x32_bf16 v[92:95], v[32:35], v[136:139], v[92:95]
    ds_read_b64_tr_b16 v[28:29], v18 offset:28672
    s_waitcnt lgkmcnt(11)
    v_mfma_f32_16x16x32_bf16 v[92:95], v[36:39], v[144:147], v[92:95]
    ds_read_b64_tr_b16 v[30:31], v18 offset:29184
    v_rcp_f32 v192, v192
    v_sub_f32 v168, v184, v194
    v_mfma_f32_16x16x32_bf16 v[100:103], v[32:35], v[140:143], v[100:103]
    ds_read_b64_tr_b16 v[32:33], v19 offset:24576
    v_mfma_f32_16x16x32_bf16 v[100:103], v[36:39], v[148:151], v[100:103]
    ds_read_b64_tr_b16 v[34:35], v19 offset:25088
    v_sub_f32 v169, v185, v194
    v_sub_f32 v170, v186, v194
    s_waitcnt lgkmcnt(12)
    v_mfma_f32_16x16x32_bf16 v[104:107], v[40:43], v[136:139], v[104:107]
    ds_read_b64_tr_b16 v[36:37], v19 offset:28672
    s_waitcnt lgkmcnt(11)
    v_mfma_f32_16x16x32_bf16 v[104:107], v[44:47], v[144:147], v[104:107]
    ds_read_b64_tr_b16 v[38:39], v19 offset:29184
    v_sub_f32 v171, v187, v194
    v_sub_f32 v172, v188, v194
    v_mfma_f32_16x16x32_bf16 v[112:115], v[40:43], v[140:143], v[112:115]
    ds_read_b64_tr_b16 v[40:41], v20 offset:24576
    v_mfma_f32_16x16x32_bf16 v[112:115], v[44:47], v[148:151], v[112:115]
    ds_read_b64_tr_b16 v[42:43], v20 offset:25088
    v_sub_f32 v173, v189, v194
    v_sub_f32 v174, v190, v194
    s_add_u32 s50, s45, 3
    s_and_b32 s50, s50, 7
    s_add_u32 m0, s6, 0
    s_lshl_b32 s44, s50, 19
    buffer_load_dwordx4 v4, s[12:15], s44 offen lds
    s_lshl_b32 s50, s50, 7
    s_waitcnt lgkmcnt(12)
    v_mfma_f32_16x16x32_bf16 v[108:111], v[48:51], v[136:139], v[108:111]
    ds_read_b64_tr_b16 v[44:45], v20 offset:28672
    s_waitcnt lgkmcnt(11)
    v_mfma_f32_16x16x32_bf16 v[108:111], v[52:55], v[144:147], v[108:111]
    ds_read_b64_tr_b16 v[46:47], v20 offset:29184
    v_sub_f32 v175, v191, v194
    v_cvt_pk_bf16_f32 v184, v168, v169
    s_add_u32 m0, s7, 4096
    s_add_u32 s32, s50, 0
    buffer_load_dwordx4 v9, s[8:11], s32 offen lds
    v_mfma_f32_16x16x32_bf16 v[116:119], v[48:51], v[140:143], v[116:119]
    ds_read_b64_tr_b16 v[48:49], v22 offset:24576
    v_mfma_f32_16x16x32_bf16 v[116:119], v[52:55], v[148:151], v[116:119]
    ds_read_b64_tr_b16 v[50:51], v22 offset:25088
    v_cvt_pk_bf16_f32 v185, v170, v171
    v_cvt_pk_bf16_f32 v186, v172, v173
    s_add_u32 m0, s7, 5120
    s_add_u32 s32, s50, 0
    buffer_load_dwordx4 v10, s[8:11], s32 offen lds
    s_waitcnt lgkmcnt(12)
    v_mfma_f32_16x16x32_bf16 v[216:219], v[136:139], v[24:27], v[216:219]
    ds_read_b64_tr_b16 v[52:53], v22 offset:28672
    s_waitcnt lgkmcnt(11)
    v_mfma_f32_16x16x32_bf16 v[216:219], v[144:147], v[28:31], v[216:219]
    ds_read_b64_tr_b16 v[54:55], v22 offset:29184
    v_cvt_pk_bf16_f32 v187, v174, v175
    v_lshlrev_b32 v168, 16, v184
    s_add_u32 m0, s7, 6144
    s_add_u32 s32, s50, 16384
    buffer_load_dwordx4 v9, s[8:11], s32 offen lds
    v_mfma_f32_16x16x32_bf16 v[220:223], v[140:143], v[24:27], v[220:223]
    v_mfma_f32_16x16x32_bf16 v[220:223], v[148:151], v[28:31], v[220:223]
    v_and_b32 v169, 0xffff0000, v184
    v_lshlrev_b32 v170, 16, v185
    s_add_u32 m0, s7, 7168
    s_add_u32 s32, s50, 16384
    buffer_load_dwordx4 v10, s[8:11], s32 offen lds
    s_waitcnt lgkmcnt(10)
    v_mfma_f32_16x16x32_bf16 v[224:227], v[136:139], v[32:35], v[224:227]
    s_waitcnt lgkmcnt(8)
    v_mfma_f32_16x16x32_bf16 v[224:227], v[144:147], v[36:39], v[224:227]
    s_waitcnt vmcnt(9)
    ds_read_b128 v[152:155], v13 offset:0
    ds_read_b128 v[156:159], v13 offset:2048
    ds_read_b128 v[160:163], v14 offset:0
    ds_read_b128 v[164:167], v14 offset:2048
    v_and_b32 v171, 0xffff0000, v185
    v_lshlrev_b32 v172, 16, v186
    s_add_u32 m0, s6, 1024
    s_add_u32 s32, s44, 32768
    buffer_load_dwordx4 v4, s[12:15], s32 offen lds
    v_mfma_f32_16x16x32_bf16 v[228:231], v[140:143], v[32:35], v[228:231]
    v_mfma_f32_16x16x32_bf16 v[228:231], v[148:151], v[36:39], v[228:231]
    v_and_b32 v173, 0xffff0000, v186
    v_lshlrev_b32 v174, 16, v187
    s_add_u32 m0, s56, 0
    s_add_u32 s32, s44, s47
    buffer_load_dwordx4 v17, s[16:19], s32 offen lds
    s_waitcnt lgkmcnt(10)
    v_mfma_f32_16x16x32_bf16 v[232:235], v[136:139], v[40:43], v[232:235]
    s_waitcnt lgkmcnt(8)
    v_mfma_f32_16x16x32_bf16 v[232:235], v[144:147], v[44:47], v[232:235]
    s_waitcnt vmcnt(9) lgkmcnt(4)
    s_barrier
    ds_read_b64_tr_b16 v[24:25], v5 offset:49152
    ds_read_b64_tr_b16 v[26:27], v5 offset:50176
    ds_read_b64_tr_b16 v[28:29], v5 offset:57344
    ds_read_b64_tr_b16 v[30:31], v5 offset:58368
    ds_read_b64_tr_b16 v[32:33], v15 offset:49152
    ds_read_b64_tr_b16 v[34:35], v15 offset:50176
    ds_read_b64_tr_b16 v[36:37], v15 offset:57344
    ds_read_b64_tr_b16 v[38:39], v15 offset:58368
    v_and_b32 v175, 0xffff0000, v187
    v_mul_f32 v168, v168, v192
    v_mfma_f32_16x16x32_bf16 v[236:239], v[140:143], v[40:43], v[236:239]
    ds_read_b64_tr_b16 v[40:41], v6 offset:49152
    v_mfma_f32_16x16x32_bf16 v[236:239], v[148:151], v[44:47], v[236:239]
    ds_read_b64_tr_b16 v[42:43], v6 offset:50176
    v_mul_f32 v169, v169, v192
    v_mul_f32 v170, v170, v192
    v_mfma_f32_16x16x32_bf16 v[240:243], v[136:139], v[48:51], v[240:243]
    ds_read_b64_tr_b16 v[44:45], v6 offset:57344
    v_mfma_f32_16x16x32_bf16 v[240:243], v[144:147], v[52:55], v[240:243]
    ds_read_b64_tr_b16 v[46:47], v6 offset:58368
    v_mul_f32 v171, v171, v192
    v_mul_f32 v172, v172, v192
    v_mfma_f32_16x16x32_bf16 v[244:247], v[140:143], v[48:51], v[244:247]
    ds_read_b64_tr_b16 v[48:49], v16 offset:49152
    v_mfma_f32_16x16x32_bf16 v[244:247], v[148:151], v[52:55], v[244:247]
    ds_read_b64_tr_b16 v[50:51], v16 offset:50176
    v_mul_f32 v173, v173, v192
    v_mul_f32 v174, v174, v192
    s_waitcnt lgkmcnt(12)
    v_mfma_f32_16x16x32_bf16 v[56:59], v[24:27], v[152:155], v[56:59]
    ds_read_b64_tr_b16 v[52:53], v16 offset:57344
    s_waitcnt lgkmcnt(11)
    v_mfma_f32_16x16x32_bf16 v[56:59], v[28:31], v[160:163], v[56:59]
    ds_read_b64_tr_b16 v[54:55], v16 offset:58368
    v_mul_f32 v175, v175, v192
    v_cvt_pk_bf16_f32 v196, v168, v169
    v_mfma_f32_16x16x32_bf16 v[64:67], v[24:27], v[156:159], v[64:67]
    ds_read_b64_tr_b16 v[24:25], v7 offset:49152
    v_mfma_f32_16x16x32_bf16 v[64:67], v[28:31], v[164:167], v[64:67]
    ds_read_b64_tr_b16 v[26:27], v7 offset:50176
    v_cvt_pk_bf16_f32 v197, v170, v171
    v_cvt_pk_bf16_f32 v198, v172, v173
    s_waitcnt lgkmcnt(12)
    v_mfma_f32_16x16x32_bf16 v[60:63], v[32:35], v[152:155], v[60:63]
    ds_read_b64_tr_b16 v[28:29], v7 offset:57344
    s_waitcnt lgkmcnt(11)
    v_mfma_f32_16x16x32_bf16 v[60:63], v[36:39], v[160:163], v[60:63]
    ds_read_b64_tr_b16 v[30:31], v7 offset:58368
    v_cvt_pk_bf16_f32 v199, v174, v175
    v_lshlrev_b32 v1, 3, v0
    s_add_u32 s50, s45, 4
    s_and_b32 s50, s50, 7
    s_add_u32 m0, s6, 24576
    s_lshl_b32 s44, s50, 19
    buffer_load_dwordx4 v4, s[12:15], s44 offen lds
    s_lshl_b32 s50, s50, 7
    v_mfma_f32_16x16x32_bf16 v[68:71], v[32:35], v[156:159], v[68:71]
    ds_read_b64_tr_b16 v[32:33], v11 offset:49152
    v_mfma_f32_16x16x32_bf16 v[68:71], v[36:39], v[164:167], v[68:71]
    ds_read_b64_tr_b16 v[34:35], v11 offset:50176
    s_lshl_b32 s32, s3, 4
    s_add_u32 s32, s32, 139264
    v_add_u32 v1, s32, v1
    ds_write_b128 v1, v[196:199]
    s_add_u32 m0, s7, 0
    s_add_u32 s32, s50, 0
    buffer_load_dwordx4 v9, s[8:11], s32 offen lds
    s_waitcnt lgkmcnt(13)
    v_mfma_f32_16x16x32_bf16 v[72:75], v[40:43], v[152:155], v[72:75]
    ds_read_b64_tr_b16 v[36:37], v11 offset:57344
    s_waitcnt lgkmcnt(12)
    v_mfma_f32_16x16x32_bf16 v[72:75], v[44:47], v[160:163], v[72:75]
    ds_read_b64_tr_b16 v[38:39], v11 offset:58368
    s_cmp_eq_u32 s3, 0
    s_cselect_b32 s32, 0, 0x7f000000
    v_mov_b32 v2, 0
    buffer_load_dword v3, v2, s[28:31], s32 offen sc1
    s_lshl_b32 s33, s5, 3
    s_add_u32 s33, s33, s3
    s_lshl_b32 s33, s33, 14
    s_mul_i32 s51, s4, 1081344
    s_add_u32 s34, s51, s33
    s_add_u32 m0, s7, 1024
    s_add_u32 s32, s50, 0
    buffer_load_dwordx4 v10, s[8:11], s32 offen lds
    v_mfma_f32_16x16x32_bf16 v[80:83], v[40:43], v[156:159], v[80:83]
    ds_read_b64_tr_b16 v[40:41], v8 offset:49152
    v_mfma_f32_16x16x32_bf16 v[80:83], v[44:47], v[164:167], v[80:83]
    ds_read_b64_tr_b16 v[42:43], v8 offset:50176
    s_add_u32 m0, s7, 2048
    s_add_u32 s32, s50, 16384
    buffer_load_dwordx4 v9, s[8:11], s32 offen lds
    s_waitcnt lgkmcnt(13)
    v_mfma_f32_16x16x32_bf16 v[76:79], v[48:51], v[152:155], v[76:79]
    ds_read_b64_tr_b16 v[44:45], v8 offset:57344
    s_waitcnt lgkmcnt(12)
    v_mfma_f32_16x16x32_bf16 v[76:79], v[52:55], v[160:163], v[76:79]
    ds_read_b64_tr_b16 v[46:47], v8 offset:58368
    s_add_u32 m0, s7, 3072
    s_add_u32 s32, s50, 16384
    buffer_load_dwordx4 v10, s[8:11], s32 offen lds
    v_mfma_f32_16x16x32_bf16 v[84:87], v[48:51], v[156:159], v[84:87]
    ds_read_b64_tr_b16 v[48:49], v12 offset:49152
    v_mfma_f32_16x16x32_bf16 v[84:87], v[52:55], v[164:167], v[84:87]
    ds_read_b64_tr_b16 v[50:51], v12 offset:50176
    s_add_u32 m0, s6, 25600
    s_add_u32 s32, s44, 32768
    buffer_load_dwordx4 v4, s[12:15], s32 offen lds
    s_waitcnt lgkmcnt(13)
    v_mfma_f32_16x16x32_bf16 v[88:91], v[24:27], v[152:155], v[88:91]
    ds_read_b64_tr_b16 v[52:53], v12 offset:57344
    s_waitcnt lgkmcnt(12)
    v_mfma_f32_16x16x32_bf16 v[88:91], v[28:31], v[160:163], v[88:91]
    ds_read_b64_tr_b16 v[54:55], v12 offset:58368
    s_add_u32 m0, s56, 24576
    s_add_u32 s32, s44, s47
    buffer_load_dwordx4 v17, s[16:19], s32 offen lds
    v_mfma_f32_16x16x32_bf16 v[96:99], v[24:27], v[156:159], v[96:99]
    ds_read_b64_tr_b16 v[24:25], v18 offset:49152
    v_mfma_f32_16x16x32_bf16 v[96:99], v[28:31], v[164:167], v[96:99]
    ds_read_b64_tr_b16 v[26:27], v18 offset:49664
    s_add_u32 s32, s45, 5
    s_lshl_b32 s33, s32, 4
    s_lshl_b64 exec, s[58:59], s33
    s_bitcmp1_b32 s32, 2
    s_cselect_b32 s32, s53, s54
    buffer_load_dword v209, v23, s[24:27], s32 offen
    s_mov_b64 exec, -1
    s_add_u32 s32, s45, 6
    s_lshl_b32 s33, s32, 4
    s_lshl_b64 exec, s[58:59], s33
    s_bitcmp1_b32 s32, 2
    s_cselect_b32 s32, s53, s54
    buffer_load_dword v210, v23, s[24:27], s32 offen
    s_mov_b64 exec, -1
    s_waitcnt lgkmcnt(13)
    v_mfma_f32_16x16x32_bf16 v[92:95], v[32:35], v[152:155], v[92:95]
    ds_read_b64_tr_b16 v[28:29], v18 offset:53248
    s_waitcnt lgkmcnt(11)
    v_mfma_f32_16x16x32_bf16 v[92:95], v[36:39], v[160:163], v[92:95]
    ds_read_b64_tr_b16 v[30:31], v18 offset:53760
    v_mfma_f32_16x16x32_bf16 v[100:103], v[32:35], v[156:159], v[100:103]
    ds_read_b64_tr_b16 v[32:33], v19 offset:49152
    v_mfma_f32_16x16x32_bf16 v[100:103], v[36:39], v[164:167], v[100:103]
    ds_read_b64_tr_b16 v[34:35], v19 offset:49664
    s_waitcnt lgkmcnt(12)
    v_mfma_f32_16x16x32_bf16 v[104:107], v[40:43], v[152:155], v[104:107]
    ds_read_b64_tr_b16 v[36:37], v19 offset:53248
    s_waitcnt lgkmcnt(11)
    v_mfma_f32_16x16x32_bf16 v[104:107], v[44:47], v[160:163], v[104:107]
    ds_read_b64_tr_b16 v[38:39], v19 offset:53760
    v_mfma_f32_16x16x32_bf16 v[112:115], v[40:43], v[156:159], v[112:115]
    ds_read_b64_tr_b16 v[40:41], v20 offset:49152
    v_mfma_f32_16x16x32_bf16 v[112:115], v[44:47], v[164:167], v[112:115]
    ds_read_b64_tr_b16 v[42:43], v20 offset:49664
    s_waitcnt lgkmcnt(12)
    v_mfma_f32_16x16x32_bf16 v[108:111], v[48:51], v[152:155], v[108:111]
    ds_read_b64_tr_b16 v[44:45], v20 offset:53248
    s_waitcnt lgkmcnt(11)
    v_mfma_f32_16x16x32_bf16 v[108:111], v[52:55], v[160:163], v[108:111]
    ds_read_b64_tr_b16 v[46:47], v20 offset:53760
    v_mfma_f32_16x16x32_bf16 v[116:119], v[48:51], v[156:159], v[116:119]
    ds_read_b64_tr_b16 v[48:49], v22 offset:49152
    v_mfma_f32_16x16x32_bf16 v[116:119], v[52:55], v[164:167], v[116:119]
    ds_read_b64_tr_b16 v[50:51], v22 offset:49664
    s_waitcnt lgkmcnt(12)
    v_mfma_f32_16x16x32_bf16 v[216:219], v[152:155], v[24:27], v[216:219]
    ds_read_b64_tr_b16 v[52:53], v22 offset:53248
    s_waitcnt lgkmcnt(11)
    v_mfma_f32_16x16x32_bf16 v[216:219], v[160:163], v[28:31], v[216:219]
    ds_read_b64_tr_b16 v[54:55], v22 offset:53760
    v_mfma_f32_16x16x32_bf16 v[220:223], v[156:159], v[24:27], v[220:223]
    v_mfma_f32_16x16x32_bf16 v[220:223], v[164:167], v[28:31], v[220:223]
    s_waitcnt lgkmcnt(10)
    v_mfma_f32_16x16x32_bf16 v[224:227], v[152:155], v[32:35], v[224:227]
    s_waitcnt lgkmcnt(8)
    v_mfma_f32_16x16x32_bf16 v[224:227], v[160:163], v[36:39], v[224:227]
    s_waitcnt vmcnt(12)
    ds_read_b128 v[168:171], v13 offset:4096
    ds_read_b128 v[172:175], v13 offset:6144
    ds_read_b128 v[176:179], v14 offset:4096
    ds_read_b128 v[180:183], v14 offset:6144
    v_mfma_f32_16x16x32_bf16 v[228:231], v[156:159], v[32:35], v[228:231]
    v_mfma_f32_16x16x32_bf16 v[228:231], v[164:167], v[36:39], v[228:231]
    s_waitcnt lgkmcnt(10)
    v_mfma_f32_16x16x32_bf16 v[232:235], v[152:155], v[40:43], v[232:235]
    s_waitcnt lgkmcnt(8)
    v_mfma_f32_16x16x32_bf16 v[232:235], v[160:163], v[44:47], v[232:235]
    s_waitcnt vmcnt(10) lgkmcnt(4)
    s_barrier
    ds_read_b64_tr_b16 v[24:25], v5 offset:0
    ds_read_b64_tr_b16 v[26:27], v5 offset:1024
    ds_read_b64_tr_b16 v[28:29], v5 offset:8192
    ds_read_b64_tr_b16 v[30:31], v5 offset:9216
    ds_read_b64_tr_b16 v[32:33], v15 offset:0
    ds_read_b64_tr_b16 v[34:35], v15 offset:1024
    ds_read_b64_tr_b16 v[36:37], v15 offset:8192
    ds_read_b64_tr_b16 v[38:39], v15 offset:9216
    v_mfma_f32_16x16x32_bf16 v[236:239], v[156:159], v[40:43], v[236:239]
    ds_read_b64_tr_b16 v[40:41], v6 offset:0
    v_mfma_f32_16x16x32_bf16 v[236:239], v[164:167], v[44:47], v[236:239]
    ds_read_b64_tr_b16 v[42:43], v6 offset:1024
    v_mfma_f32_16x16x32_bf16 v[240:243], v[152:155], v[48:51], v[240:243]
    ds_read_b64_tr_b16 v[44:45], v6 offset:8192
    v_mfma_f32_16x16x32_bf16 v[240:243], v[160:163], v[52:55], v[240:243]
    ds_read_b64_tr_b16 v[46:47], v6 offset:9216
    s_lshl_b32 s32, s3, 10
    s_add_u32 s32, s32, 139264
    v_add_u32 v1, s32, v0
    ds_read_b128 v[196:199], v1
    v_mfma_f32_16x16x32_bf16 v[244:247], v[156:159], v[48:51], v[244:247]
    ds_read_b64_tr_b16 v[48:49], v16 offset:0
    v_mfma_f32_16x16x32_bf16 v[244:247], v[164:167], v[52:55], v[244:247]
    ds_read_b64_tr_b16 v[50:51], v16 offset:1024
    v_lshrrev_b32 v1, 9, v0
    s_waitcnt lgkmcnt(13)
    v_mfma_f32_16x16x32_bf16 v[56:59], v[24:27], v[168:171], v[56:59]
    ds_read_b64_tr_b16 v[52:53], v16 offset:8192
    s_waitcnt lgkmcnt(12)
    v_mfma_f32_16x16x32_bf16 v[56:59], v[28:31], v[176:179], v[56:59]
    ds_read_b64_tr_b16 v[54:55], v16 offset:9216
    v_lshlrev_b32 v1, 11, v1
    v_bfe_u32 v2, v0, 7, 2
    v_mfma_f32_16x16x32_bf16 v[64:67], v[24:27], v[172:175], v[64:67]
    ds_read_b64_tr_b16 v[24:25], v7 offset:0
    v_mfma_f32_16x16x32_bf16 v[64:67], v[28:31], v[180:183], v[64:67]
    ds_read_b64_tr_b16 v[26:27], v7 offset:1024
    v_lshl_add_u32 v1, v2, 8, v1
    s_waitcnt lgkmcnt(13)
    v_mfma_f32_16x16x32_bf16 v[60:63], v[32:35], v[168:171], v[60:63]
    ds_read_b64_tr_b16 v[28:29], v7 offset:8192
    s_waitcnt lgkmcnt(12)
    v_mfma_f32_16x16x32_bf16 v[60:63], v[36:39], v[176:179], v[60:63]
    ds_read_b64_tr_b16 v[30:31], v7 offset:9216
    v_and_b32 v2, 0x70, v0
    v_mfma_f32_16x16x32_bf16 v[68:71], v[32:35], v[172:175], v[68:71]
    ds_read_b64_tr_b16 v[32:33], v11 offset:0
    v_mfma_f32_16x16x32_bf16 v[68:71], v[36:39], v[180:183], v[68:71]
    ds_read_b64_tr_b16 v[34:35], v11 offset:1024
    v_add_u32 v1, v1, v2
    s_andn2_b32 s36, s36, 7
    s_lshr_b32 s33, s36, 5
    s_lshl_b32 s33, s33, 15
    s_bfe_u32 s32, s36, 0x10004
    s_lshl_b32 s32, s32, 10
    s_add_u32 s33, s33, s32
    s_and_b32 s36, s36, 15
    s_lshl_b32 s36, s36, 4
    s_add_u32 s36, s36, s33
    s_lshl_b32 s33, s3, 12
    s_add_u32 s36, s36, s33
    s_add_u32 s36, s36, 34603008
    s_waitcnt lgkmcnt(13)
    v_mfma_f32_16x16x32_bf16 v[72:75], v[40:43], v[168:171], v[72:75]
    ds_read_b64_tr_b16 v[36:37], v11 offset:8192
    s_waitcnt lgkmcnt(12)
    v_mfma_f32_16x16x32_bf16 v[72:75], v[44:47], v[176:179], v[72:75]
    ds_read_b64_tr_b16 v[38:39], v11 offset:9216
    s_nop 0
    v_mfma_f32_16x16x32_bf16 v[80:83], v[40:43], v[172:175], v[80:83]
    ds_read_b64_tr_b16 v[40:41], v8 offset:0
    v_mfma_f32_16x16x32_bf16 v[80:83], v[44:47], v[180:183], v[80:83]
    ds_read_b64_tr_b16 v[42:43], v8 offset:1024
    s_waitcnt lgkmcnt(14)
    buffer_store_dwordx4 v[196:199], v1, s[20:23], s36 offen sc1
    s_waitcnt lgkmcnt(12)
    v_mfma_f32_16x16x32_bf16 v[76:79], v[48:51], v[168:171], v[76:79]
    ds_read_b64_tr_b16 v[44:45], v8 offset:8192
    s_waitcnt lgkmcnt(11)
    v_mfma_f32_16x16x32_bf16 v[76:79], v[52:55], v[176:179], v[76:79]
    ds_read_b64_tr_b16 v[46:47], v8 offset:9216
    v_mfma_f32_16x16x32_bf16 v[84:87], v[48:51], v[172:175], v[84:87]
    ds_read_b64_tr_b16 v[48:49], v12 offset:0
    v_mfma_f32_16x16x32_bf16 v[84:87], v[52:55], v[180:183], v[84:87]
    ds_read_b64_tr_b16 v[50:51], v12 offset:1024
    s_add_u32 s50, s45, 5
    s_and_b32 s50, s50, 7
    s_add_u32 m0, s6, 49152
    s_lshl_b32 s44, s50, 19
    buffer_load_dwordx4 v4, s[12:15], s44 offen lds
    s_lshl_b32 s50, s50, 7
    s_waitcnt lgkmcnt(12)
    v_mfma_f32_16x16x32_bf16 v[88:91], v[24:27], v[168:171], v[88:91]
    ds_read_b64_tr_b16 v[52:53], v12 offset:8192
    s_waitcnt lgkmcnt(11)
    v_mfma_f32_16x16x32_bf16 v[88:91], v[28:31], v[176:179], v[88:91]
    ds_read_b64_tr_b16 v[54:55], v12 offset:9216
    s_add_u32 m0, s7, 4096
    s_add_u32 s32, s50, 0
    buffer_load_dwordx4 v9, s[8:11], s32 offen lds
    v_mfma_f32_16x16x32_bf16 v[96:99], v[24:27], v[172:175], v[96:99]
    ds_read_b64_tr_b16 v[24:25], v18 offset:0
    v_mfma_f32_16x16x32_bf16 v[96:99], v[28:31], v[180:183], v[96:99]
    ds_read_b64_tr_b16 v[26:27], v18 offset:512
    s_add_u32 m0, s7, 5120
    s_add_u32 s32, s50, 0
    buffer_load_dwordx4 v10, s[8:11], s32 offen lds
    s_waitcnt lgkmcnt(12)
    v_mfma_f32_16x16x32_bf16 v[92:95], v[32:35], v[168:171], v[92:95]
    ds_read_b64_tr_b16 v[28:29], v18 offset:4096
    s_waitcnt lgkmcnt(11)
    v_mfma_f32_16x16x32_bf16 v[92:95], v[36:39], v[176:179], v[92:95]
    ds_read_b64_tr_b16 v[30:31], v18 offset:4608
    s_add_u32 m0, s7, 6144
    s_add_u32 s32, s50, 16384
    buffer_load_dwordx4 v9, s[8:11], s32 offen lds
    v_mfma_f32_16x16x32_bf16 v[100:103], v[32:35], v[172:175], v[100:103]
    ds_read_b64_tr_b16 v[32:33], v19 offset:0
    v_mfma_f32_16x16x32_bf16 v[100:103], v[36:39], v[180:183], v[100:103]
    ds_read_b64_tr_b16 v[34:35], v19 offset:512
    s_add_u32 m0, s7, 7168
    s_add_u32 s32, s50, 16384
    buffer_load_dwordx4 v10, s[8:11], s32 offen lds
    s_waitcnt lgkmcnt(12)
    v_mfma_f32_16x16x32_bf16 v[104:107], v[40:43], v[168:171], v[104:107]
    ds_read_b64_tr_b16 v[36:37], v19 offset:4096
    s_waitcnt lgkmcnt(11)
    v_mfma_f32_16x16x32_bf16 v[104:107], v[44:47], v[176:179], v[104:107]
    ds_read_b64_tr_b16 v[38:39], v19 offset:4608
    s_add_u32 m0, s6, 50176
    s_add_u32 s32, s44, 32768
    buffer_load_dwordx4 v4, s[12:15], s32 offen lds
    v_mfma_f32_16x16x32_bf16 v[112:115], v[40:43], v[172:175], v[112:115]
    ds_read_b64_tr_b16 v[40:41], v20 offset:0
    v_mfma_f32_16x16x32_bf16 v[112:115], v[44:47], v[180:183], v[112:115]
    ds_read_b64_tr_b16 v[42:43], v20 offset:512
    s_add_u32 m0, s56, 49152
    s_add_u32 s32, s44, s47
    buffer_load_dwordx4 v17, s[16:19], s32 offen lds
    s_waitcnt lgkmcnt(12)
    v_mfma_f32_16x16x32_bf16 v[108:111], v[48:51], v[168:171], v[108:111]
    ds_read_b64_tr_b16 v[44:45], v20 offset:4096
    s_waitcnt lgkmcnt(11)
    v_mfma_f32_16x16x32_bf16 v[108:111], v[52:55], v[176:179], v[108:111]
    ds_read_b64_tr_b16 v[46:47], v20 offset:4608
    v_mfma_f32_16x16x32_bf16 v[116:119], v[48:51], v[172:175], v[116:119]
    ds_read_b64_tr_b16 v[48:49], v22 offset:0
    v_mfma_f32_16x16x32_bf16 v[116:119], v[52:55], v[180:183], v[116:119]
    ds_read_b64_tr_b16 v[50:51], v22 offset:512
    s_waitcnt lgkmcnt(12)
    v_mfma_f32_16x16x32_bf16 v[216:219], v[168:171], v[24:27], v[216:219]
    ds_read_b64_tr_b16 v[52:53], v22 offset:4096
    s_waitcnt lgkmcnt(11)
    v_mfma_f32_16x16x32_bf16 v[216:219], v[176:179], v[28:31], v[216:219]
    ds_read_b64_tr_b16 v[54:55], v22 offset:4608
    v_mfma_f32_16x16x32_bf16 v[220:223], v[172:175], v[24:27], v[220:223]
    v_mfma_f32_16x16x32_bf16 v[220:223], v[180:183], v[28:31], v[220:223]
    s_waitcnt lgkmcnt(10)
    v_mfma_f32_16x16x32_bf16 v[224:227], v[168:171], v[32:35], v[224:227]
    s_waitcnt lgkmcnt(8)
    v_mfma_f32_16x16x32_bf16 v[224:227], v[176:179], v[36:39], v[224:227]
    s_waitcnt vmcnt(12)
    ds_read_b128 v[184:187], v13 offset:0
    ds_read_b128 v[188:191], v13 offset:2048
    ds_read_b128 v[192:195], v14 offset:0
    ds_read_b128 v[196:199], v14 offset:2048
    v_mfma_f32_16x16x32_bf16 v[228:231], v[172:175], v[32:35], v[228:231]
    v_mfma_f32_16x16x32_bf16 v[228:231], v[180:183], v[36:39], v[228:231]
    s_waitcnt lgkmcnt(10)
    v_mfma_f32_16x16x32_bf16 v[232:235], v[168:171], v[40:43], v[232:235]
    s_waitcnt lgkmcnt(8)
    v_mfma_f32_16x16x32_bf16 v[232:235], v[176:179], v[44:47], v[232:235]
    s_waitcnt vmcnt(10) lgkmcnt(4)
    s_barrier
    ds_read_b64_tr_b16 v[24:25], v5 offset:24576
    ds_read_b64_tr_b16 v[26:27], v5 offset:25600
    ds_read_b64_tr_b16 v[28:29], v5 offset:32768
    ds_read_b64_tr_b16 v[30:31], v5 offset:33792
    ds_read_b64_tr_b16 v[32:33], v15 offset:24576
    ds_read_b64_tr_b16 v[34:35], v15 offset:25600
    ds_read_b64_tr_b16 v[36:37], v15 offset:32768
    ds_read_b64_tr_b16 v[38:39], v15 offset:33792
    v_mfma_f32_16x16x32_bf16 v[236:239], v[172:175], v[40:43], v[236:239]
    ds_read_b64_tr_b16 v[40:41], v6 offset:24576
    v_mfma_f32_16x16x32_bf16 v[236:239], v[180:183], v[44:47], v[236:239]
    ds_read_b64_tr_b16 v[42:43], v6 offset:25600
    v_mfma_f32_16x16x32_bf16 v[240:243], v[168:171], v[48:51], v[240:243]
    ds_read_b64_tr_b16 v[44:45], v6 offset:32768
    v_mfma_f32_16x16x32_bf16 v[240:243], v[176:179], v[52:55], v[240:243]
    ds_read_b64_tr_b16 v[46:47], v6 offset:33792
    v_mfma_f32_16x16x32_bf16 v[244:247], v[172:175], v[48:51], v[244:247]
    ds_read_b64_tr_b16 v[48:49], v16 offset:24576
    v_mfma_f32_16x16x32_bf16 v[244:247], v[180:183], v[52:55], v[244:247]
    ds_read_b64_tr_b16 v[50:51], v16 offset:25600
    s_waitcnt lgkmcnt(12)
    v_mfma_f32_16x16x32_bf16 v[56:59], v[24:27], v[184:187], v[56:59]
    ds_read_b64_tr_b16 v[52:53], v16 offset:32768
    s_waitcnt lgkmcnt(11)
    v_mfma_f32_16x16x32_bf16 v[56:59], v[28:31], v[192:195], v[56:59]
    ds_read_b64_tr_b16 v[54:55], v16 offset:33792
    v_mfma_f32_16x16x32_bf16 v[64:67], v[24:27], v[188:191], v[64:67]
    ds_read_b64_tr_b16 v[24:25], v7 offset:24576
    v_mfma_f32_16x16x32_bf16 v[64:67], v[28:31], v[196:199], v[64:67]
    ds_read_b64_tr_b16 v[26:27], v7 offset:25600
    s_waitcnt lgkmcnt(12)
    v_mfma_f32_16x16x32_bf16 v[60:63], v[32:35], v[184:187], v[60:63]
    ds_read_b64_tr_b16 v[28:29], v7 offset:32768
    s_waitcnt lgkmcnt(11)
    v_mfma_f32_16x16x32_bf16 v[60:63], v[36:39], v[192:195], v[60:63]
    ds_read_b64_tr_b16 v[30:31], v7 offset:33792
    s_add_u32 s50, s45, 6
    s_and_b32 s50, s50, 7
    s_add_u32 m0, s6, 0
    s_lshl_b32 s44, s50, 19
    buffer_load_dwordx4 v4, s[12:15], s44 offen lds
    s_lshl_b32 s50, s50, 7
    v_mfma_f32_16x16x32_bf16 v[68:71], v[32:35], v[188:191], v[68:71]
    ds_read_b64_tr_b16 v[32:33], v11 offset:24576
    v_mfma_f32_16x16x32_bf16 v[68:71], v[36:39], v[196:199], v[68:71]
    ds_read_b64_tr_b16 v[34:35], v11 offset:25600
    s_add_u32 m0, s7, 0
    s_add_u32 s32, s50, 0
    buffer_load_dwordx4 v9, s[8:11], s32 offen lds
    s_waitcnt lgkmcnt(12)
    v_mfma_f32_16x16x32_bf16 v[72:75], v[40:43], v[184:187], v[72:75]
    ds_read_b64_tr_b16 v[36:37], v11 offset:32768
    s_waitcnt lgkmcnt(11)
    v_mfma_f32_16x16x32_bf16 v[72:75], v[44:47], v[192:195], v[72:75]
    ds_read_b64_tr_b16 v[38:39], v11 offset:33792
    s_add_u32 m0, s7, 1024
    s_add_u32 s32, s50, 0
    buffer_load_dwordx4 v10, s[8:11], s32 offen lds
    v_mfma_f32_16x16x32_bf16 v[80:83], v[40:43], v[188:191], v[80:83]
    ds_read_b64_tr_b16 v[40:41], v8 offset:24576
    v_mfma_f32_16x16x32_bf16 v[80:83], v[44:47], v[196:199], v[80:83]
    ds_read_b64_tr_b16 v[42:43], v8 offset:25600
    s_add_u32 m0, s7, 2048
    s_add_u32 s32, s50, 16384
    buffer_load_dwordx4 v9, s[8:11], s32 offen lds
    s_waitcnt lgkmcnt(12)
    v_mfma_f32_16x16x32_bf16 v[76:79], v[48:51], v[184:187], v[76:79]
    ds_read_b64_tr_b16 v[44:45], v8 offset:32768
    s_waitcnt lgkmcnt(11)
    v_mfma_f32_16x16x32_bf16 v[76:79], v[52:55], v[192:195], v[76:79]
    ds_read_b64_tr_b16 v[46:47], v8 offset:33792
    s_add_u32 m0, s7, 3072
    s_add_u32 s32, s50, 16384
    buffer_load_dwordx4 v10, s[8:11], s32 offen lds
    v_mfma_f32_16x16x32_bf16 v[84:87], v[48:51], v[188:191], v[84:87]
    ds_read_b64_tr_b16 v[48:49], v12 offset:24576
    v_mfma_f32_16x16x32_bf16 v[84:87], v[52:55], v[196:199], v[84:87]
    ds_read_b64_tr_b16 v[50:51], v12 offset:25600
    s_add_u32 m0, s6, 1024
    s_add_u32 s32, s44, 32768
    buffer_load_dwordx4 v4, s[12:15], s32 offen lds
    s_waitcnt lgkmcnt(12)
    v_mfma_f32_16x16x32_bf16 v[88:91], v[24:27], v[184:187], v[88:91]
    ds_read_b64_tr_b16 v[52:53], v12 offset:32768
    s_waitcnt lgkmcnt(11)
    v_mfma_f32_16x16x32_bf16 v[88:91], v[28:31], v[192:195], v[88:91]
    ds_read_b64_tr_b16 v[54:55], v12 offset:33792
    s_add_u32 m0, s56, 0
    s_add_u32 s32, s44, s47
    buffer_load_dwordx4 v17, s[16:19], s32 offen lds
    v_mfma_f32_16x16x32_bf16 v[96:99], v[24:27], v[188:191], v[96:99]
    ds_read_b64_tr_b16 v[24:25], v18 offset:24576
    v_mfma_f32_16x16x32_bf16 v[96:99], v[28:31], v[196:199], v[96:99]
    ds_read_b64_tr_b16 v[26:27], v18 offset:25088
    s_add_u32 s32, s45, 7
    s_lshl_b32 s33, s32, 4
    s_lshl_b64 exec, s[58:59], s33
    s_bitcmp1_b32 s32, 2
    s_cselect_b32 s32, s53, s54
    buffer_load_dword v23, v23, s[24:27], s32 offen
    s_mov_b64 exec, -1
    s_mov_b32 s24, s68
    s_and_b32 s25, s69, 0xffff
    s_mov_b32 s26, 0x400000
    buffer_load_dword v255, v21, s[24:27], s35 offen
    s_waitcnt lgkmcnt(12)
    v_mfma_f32_16x16x32_bf16 v[92:95], v[32:35], v[184:187], v[92:95]
    ds_read_b64_tr_b16 v[28:29], v18 offset:28672
    s_waitcnt lgkmcnt(11)
    v_mfma_f32_16x16x32_bf16 v[92:95], v[36:39], v[192:195], v[92:95]
    ds_read_b64_tr_b16 v[30:31], v18 offset:29184
    v_mfma_f32_16x16x32_bf16 v[100:103], v[32:35], v[188:191], v[100:103]
    ds_read_b64_tr_b16 v[32:33], v19 offset:24576
    v_mfma_f32_16x16x32_bf16 v[100:103], v[36:39], v[196:199], v[100:103]
    ds_read_b64_tr_b16 v[34:35], v19 offset:25088
    v_lshrrev_b32 v21, 13, v21
    s_waitcnt lgkmcnt(12)
    v_mfma_f32_16x16x32_bf16 v[104:107], v[40:43], v[184:187], v[104:107]
    ds_read_b64_tr_b16 v[36:37], v19 offset:28672
    s_waitcnt lgkmcnt(11)
    v_mfma_f32_16x16x32_bf16 v[104:107], v[44:47], v[192:195], v[104:107]
    ds_read_b64_tr_b16 v[38:39], v19 offset:29184
    s_lshr_b32 s32, s35, 13
    v_add_u32 v21, s32, v21
    v_mfma_f32_16x16x32_bf16 v[112:115], v[40:43], v[188:191], v[112:115]
    ds_read_b64_tr_b16 v[40:41], v20 offset:24576
    v_mfma_f32_16x16x32_bf16 v[112:115], v[44:47], v[196:199], v[112:115]
    ds_read_b64_tr_b16 v[42:43], v20 offset:25088
    v_mul_u32_u24 v21, 2752, v21
    s_waitcnt lgkmcnt(12)
    v_mfma_f32_16x16x32_bf16 v[108:111], v[48:51], v[184:187], v[108:111]
    ds_read_b64_tr_b16 v[44:45], v20 offset:28672
    s_waitcnt lgkmcnt(11)
    v_mfma_f32_16x16x32_bf16 v[108:111], v[52:55], v[192:195], v[108:111]
    ds_read_b64_tr_b16 v[46:47], v20 offset:29184
    v_bfe_u32 v1, v0, 4, 1
    v_mfma_f32_16x16x32_bf16 v[116:119], v[48:51], v[188:191], v[116:119]
    ds_read_b64_tr_b16 v[48:49], v22 offset:24576
    v_mfma_f32_16x16x32_bf16 v[116:119], v[52:55], v[196:199], v[116:119]
    ds_read_b64_tr_b16 v[50:51], v22 offset:25088
    v_mul_u32_u24 v1, 92, v1
    s_waitcnt lgkmcnt(12)
    v_mfma_f32_16x16x32_bf16 v[216:219], v[184:187], v[24:27], v[216:219]
    ds_read_b64_tr_b16 v[52:53], v22 offset:28672
    s_waitcnt lgkmcnt(11)
    v_mfma_f32_16x16x32_bf16 v[216:219], v[192:195], v[28:31], v[216:219]
    ds_read_b64_tr_b16 v[54:55], v22 offset:29184
    v_add_u32 v21, v21, v1
    v_mfma_f32_16x16x32_bf16 v[220:223], v[188:191], v[24:27], v[220:223]
    v_mfma_f32_16x16x32_bf16 v[220:223], v[196:199], v[28:31], v[220:223]
    s_mul_i32 s32, s4, 96
    s_lshl_b32 s33, s4, 6
    s_add_u32 s33, s33, 704
    s_cmp_lt_u32 s4, 22
    s_cselect_b32 s57, s32, s33
    s_waitcnt lgkmcnt(10)
    v_mfma_f32_16x16x32_bf16 v[224:227], v[184:187], v[32:35], v[224:227]
    s_waitcnt lgkmcnt(8)
    v_mfma_f32_16x16x32_bf16 v[224:227], v[192:195], v[36:39], v[224:227]
    s_waitcnt vmcnt(11)
    ds_read_b128 v[200:203], v13 offset:4096
    ds_read_b128 v[204:207], v13 offset:6144
    ds_read_b128 v[208:211], v14 offset:4096
    ds_read_b128 v[212:215], v14 offset:6144
    v_mfma_f32_16x16x32_bf16 v[228:231], v[188:191], v[32:35], v[228:231]
    v_mfma_f32_16x16x32_bf16 v[228:231], v[196:199], v[36:39], v[228:231]
    s_waitcnt lgkmcnt(10)
    v_mfma_f32_16x16x32_bf16 v[232:235], v[184:187], v[40:43], v[232:235]
    s_waitcnt lgkmcnt(8)
    v_mfma_f32_16x16x32_bf16 v[232:235], v[192:195], v[44:47], v[232:235]
    s_waitcnt vmcnt(9) lgkmcnt(4)
    s_cmp_lg_u32 s3, 0
    s_cbranch_scc1 f_w01
    v_readfirstlane_b32 s37, v3
    s_nop 1
    s_cmp_lg_u32 s37, 0
    s_cbranch_scc1 f_no2
f_nn2:
    s_sub_u32 s38, s38, 1
    s_cselect_b32 s38, 0, s38
    s_cbranch_scc1 f_no2
    s_sleep 2
    v_mov_b32 v2, 0
    buffer_load_dword v3, v2, s[28:31], 0 offen sc1
    s_waitcnt vmcnt(0)
    v_readfirstlane_b32 s37, v3
    s_nop 1
    s_cmp_lg_u32 s37, 0
    s_cbranch_scc1 f_no2
    s_branch f_nn2
f_no2:
f_w01:
    s_barrier
    ds_read_b64_tr_b16 v[24:25], v5 offset:49152
    ds_read_b64_tr_b16 v[26:27], v5 offset:50176
    ds_read_b64_tr_b16 v[28:29], v5 offset:57344
    ds_read_b64_tr_b16 v[30:31], v5 offset:58368
    ds_read_b64_tr_b16 v[32:33], v15 offset:49152
    ds_read_b64_tr_b16 v[34:35], v15 offset:50176
    ds_read_b64_tr_b16 v[36:37], v15 offset:57344
    ds_read_b64_tr_b16 v[38:39], v15 offset:58368
    s_cmp_lg_u32 s3, 0
    s_cbranch_scc1 f_w03
    s_lshl_b32 s32, s5, 7
    s_lshl_b32 s33, s4, 2
    s_add_u32 s32, s32, s33
    s_add_u32 s32, s32, 59113472
    v_mov_b32 v1, s37
    v_mov_b32 v2, 0
    s_mov_b64 exec, 1
    buffer_store_dword v1, v2, s[20:23], s32 offen sc1
    s_mov_b64 exec, -1
f_w03:
    v_mfma_f32_16x16x32_bf16 v[236:239], v[188:191], v[40:43], v[236:239]
    ds_read_b64_tr_b16 v[40:41], v6 offset:49152
    v_mfma_f32_16x16x32_bf16 v[236:239], v[196:199], v[44:47], v[236:239]
    ds_read_b64_tr_b16 v[42:43], v6 offset:50176
    v_mfma_f32_16x16x32_bf16 v[240:243], v[184:187], v[48:51], v[240:243]
    ds_read_b64_tr_b16 v[44:45], v6 offset:57344
    v_mfma_f32_16x16x32_bf16 v[240:243], v[192:195], v[52:55], v[240:243]
    ds_read_b64_tr_b16 v[46:47], v6 offset:58368
    v_mfma_f32_16x16x32_bf16 v[244:247], v[188:191], v[48:51], v[244:247]
    ds_read_b64_tr_b16 v[48:49], v16 offset:49152
    v_mfma_f32_16x16x32_bf16 v[244:247], v[196:199], v[52:55], v[244:247]
    ds_read_b64_tr_b16 v[50:51], v16 offset:50176
    s_waitcnt lgkmcnt(12)
    v_mfma_f32_16x16x32_bf16 v[56:59], v[24:27], v[200:203], v[56:59]
    ds_read_b64_tr_b16 v[52:53], v16 offset:57344
    s_waitcnt lgkmcnt(11)
    v_mfma_f32_16x16x32_bf16 v[56:59], v[28:31], v[208:211], v[56:59]
    ds_read_b64_tr_b16 v[54:55], v16 offset:58368
    s_sub_u32 s32, 15, s5
    s_lshl_b32 s42, s32, 1
    s_add_u32 s42, s42, 2
    s_lshr_b32 s41, s3, 2
    s_sub_u32 s33, 7, s3
    s_cmp_eq_u32 s41, 0
    s_cselect_b32 s55, s5, s32
    s_cselect_b32 s32, s3, s33
    s_lshl_b32 s55, s55, 2
    s_add_u32 s55, s55, s32
    v_mfma_f32_16x16x32_bf16 v[64:67], v[24:27], v[204:207], v[64:67]
    ds_read_b64_tr_b16 v[24:25], v7 offset:49152
    v_mfma_f32_16x16x32_bf16 v[64:67], v[28:31], v[212:215], v[64:67]
    ds_read_b64_tr_b16 v[26:27], v7 offset:50176
    s_lshl_b32 s39, s55, 15
    s_waitcnt lgkmcnt(12)
    v_mfma_f32_16x16x32_bf16 v[60:63], v[32:35], v[200:203], v[60:63]
    ds_read_b64_tr_b16 v[28:29], v7 offset:57344
    s_waitcnt lgkmcnt(11)
    v_mfma_f32_16x16x32_bf16 v[60:63], v[36:39], v[208:211], v[60:63]
    ds_read_b64_tr_b16 v[30:31], v7 offset:58368
    s_add_u32 s39, s39, 34603008
    v_mfma_f32_16x16x32_bf16 v[68:71], v[32:35], v[204:207], v[68:71]
    ds_read_b64_tr_b16 v[32:33], v11 offset:49152
    v_mfma_f32_16x16x32_bf16 v[68:71], v[36:39], v[212:215], v[68:71]
    ds_read_b64_tr_b16 v[34:35], v11 offset:50176
    s_waitcnt lgkmcnt(12)
    v_mfma_f32_16x16x32_bf16 v[72:75], v[40:43], v[200:203], v[72:75]
    ds_read_b64_tr_b16 v[36:37], v11 offset:57344
    s_waitcnt lgkmcnt(11)
    v_mfma_f32_16x16x32_bf16 v[72:75], v[44:47], v[208:211], v[72:75]
    ds_read_b64_tr_b16 v[38:39], v11 offset:58368
    v_mfma_f32_16x16x32_bf16 v[80:83], v[40:43], v[204:207], v[80:83]
    ds_read_b64_tr_b16 v[40:41], v8 offset:49152
    v_mfma_f32_16x16x32_bf16 v[80:83], v[44:47], v[212:215], v[80:83]
    ds_read_b64_tr_b16 v[42:43], v8 offset:50176
    s_waitcnt lgkmcnt(12)
    v_mfma_f32_16x16x32_bf16 v[76:79], v[48:51], v[200:203], v[76:79]
    ds_read_b64_tr_b16 v[44:45], v8 offset:57344
    s_waitcnt lgkmcnt(11)
    v_mfma_f32_16x16x32_bf16 v[76:79], v[52:55], v[208:211], v[76:79]
    ds_read_b64_tr_b16 v[46:47], v8 offset:58368
    v_mfma_f32_16x16x32_bf16 v[84:87], v[48:51], v[204:207], v[84:87]
    ds_read_b64_tr_b16 v[48:49], v12 offset:49152
    v_mfma_f32_16x16x32_bf16 v[84:87], v[52:55], v[212:215], v[84:87]
    ds_read_b64_tr_b16 v[50:51], v12 offset:50176
    s_add_u32 s50, s45, 7
    s_and_b32 s50, s50, 7
    s_add_u32 m0, s6, 24576
    s_lshl_b32 s44, s50, 19
    buffer_load_dwordx4 v4, s[12:15], s44 offen lds
    s_lshl_b32 s50, s50, 7
    s_waitcnt lgkmcnt(12)
    v_mfma_f32_16x16x32_bf16 v[88:91], v[24:27], v[200:203], v[88:91]
    ds_read_b64_tr_b16 v[52:53], v12 offset:57344
    s_waitcnt lgkmcnt(11)
    v_mfma_f32_16x16x32_bf16 v[88:91], v[28:31], v[208:211], v[88:91]
    ds_read_b64_tr_b16 v[54:55], v12 offset:58368
    s_add_u32 m0, s7, 4096
    s_add_u32 s32, s50, 0
    buffer_load_dwordx4 v9, s[8:11], s32 offen lds
    v_mfma_f32_16x16x32_bf16 v[96:99], v[24:27], v[204:207], v[96:99]
    ds_read_b64_tr_b16 v[24:25], v18 offset:49152
    v_mfma_f32_16x16x32_bf16 v[96:99], v[28:31], v[212:215], v[96:99]
    ds_read_b64_tr_b16 v[26:27], v18 offset:49664
    s_add_u32 m0, s7, 5120
    s_add_u32 s32, s50, 0
    buffer_load_dwordx4 v10, s[8:11], s32 offen lds
    s_waitcnt lgkmcnt(12)
    v_mfma_f32_16x16x32_bf16 v[92:95], v[32:35], v[200:203], v[92:95]
    ds_read_b64_tr_b16 v[28:29], v18 offset:53248
    s_waitcnt lgkmcnt(11)
    v_mfma_f32_16x16x32_bf16 v[92:95], v[36:39], v[208:211], v[92:95]
    ds_read_b64_tr_b16 v[30:31], v18 offset:53760
    s_add_u32 m0, s7, 6144
    s_add_u32 s32, s50, 16384
    buffer_load_dwordx4 v9, s[8:11], s32 offen lds
    v_mfma_f32_16x16x32_bf16 v[100:103], v[32:35], v[204:207], v[100:103]
    ds_read_b64_tr_b16 v[32:33], v19 offset:49152
    v_mfma_f32_16x16x32_bf16 v[100:103], v[36:39], v[212:215], v[100:103]
    ds_read_b64_tr_b16 v[34:35], v19 offset:49664
    s_add_u32 m0, s7, 7168
    s_add_u32 s32, s50, 16384
    buffer_load_dwordx4 v10, s[8:11], s32 offen lds
    s_waitcnt lgkmcnt(12)
    v_mfma_f32_16x16x32_bf16 v[104:107], v[40:43], v[200:203], v[104:107]
    ds_read_b64_tr_b16 v[36:37], v19 offset:53248
    s_waitcnt lgkmcnt(11)
    v_mfma_f32_16x16x32_bf16 v[104:107], v[44:47], v[208:211], v[104:107]
    ds_read_b64_tr_b16 v[38:39], v19 offset:53760
    s_add_u32 m0, s6, 25600
    s_add_u32 s32, s44, 32768
    buffer_load_dwordx4 v4, s[12:15], s32 offen lds
    v_mfma_f32_16x16x32_bf16 v[112:115], v[40:43], v[204:207], v[112:115]
    ds_read_b64_tr_b16 v[40:41], v20 offset:49152
    v_mfma_f32_16x16x32_bf16 v[112:115], v[44:47], v[212:215], v[112:115]
    ds_read_b64_tr_b16 v[42:43], v20 offset:49664
    s_add_u32 m0, s56, 24576
    s_add_u32 s32, s44, s47
    buffer_load_dwordx4 v17, s[16:19], s32 offen lds
    s_waitcnt lgkmcnt(12)
    v_mfma_f32_16x16x32_bf16 v[108:111], v[48:51], v[200:203], v[108:111]
    ds_read_b64_tr_b16 v[44:45], v20 offset:53248
    s_waitcnt lgkmcnt(11)
    v_mfma_f32_16x16x32_bf16 v[108:111], v[52:55], v[208:211], v[108:111]
    ds_read_b64_tr_b16 v[46:47], v20 offset:53760
    v_mfma_f32_16x16x32_bf16 v[116:119], v[48:51], v[204:207], v[116:119]
    ds_read_b64_tr_b16 v[48:49], v22 offset:49152
    v_mfma_f32_16x16x32_bf16 v[116:119], v[52:55], v[212:215], v[116:119]
    ds_read_b64_tr_b16 v[50:51], v22 offset:49664
    s_waitcnt lgkmcnt(12)
    v_mfma_f32_16x16x32_bf16 v[216:219], v[200:203], v[24:27], v[216:219]
    ds_read_b64_tr_b16 v[52:53], v22 offset:53248
    s_waitcnt lgkmcnt(11)
    v_mfma_f32_16x16x32_bf16 v[216:219], v[208:211], v[28:31], v[216:219]
    ds_read_b64_tr_b16 v[54:55], v22 offset:53760
    v_mfma_f32_16x16x32_bf16 v[220:223], v[204:207], v[24:27], v[220:223]
    v_mfma_f32_16x16x32_bf16 v[220:223], v[212:215], v[28:31], v[220:223]
    s_waitcnt vmcnt(11)
    ds_read_b128 v[248:251], v13 offset:0
    s_waitcnt vmcnt(7)
    ds_read_b128 v[252:255], v13 offset:2048
    v_xor_b32 v17, s40, v17
    s_waitcnt lgkmcnt(12)
    v_mfma_f32_16x16x32_bf16 v[224:227], v[200:203], v[32:35], v[224:227]
    s_waitcnt lgkmcnt(10)
    v_mfma_f32_16x16x32_bf16 v[224:227], v[208:211], v[36:39], v[224:227]
    v_xor_b32 v10, 32, v17
    v_mfma_f32_16x16x32_bf16 v[228:231], v[204:207], v[32:35], v[228:231]
    v_mfma_f32_16x16x32_bf16 v[228:231], v[212:215], v[36:39], v[228:231]
    s_waitcnt lgkmcnt(8)
    v_mfma_f32_16x16x32_bf16 v[232:235], v[200:203], v[40:43], v[232:235]
    s_waitcnt lgkmcnt(6)
    v_mfma_f32_16x16x32_bf16 v[232:235], v[208:211], v[44:47], v[232:235]
    s_waitcnt lgkmcnt(2)
    s_barrier
    ds_read_b64_tr_b16 v[24:25], v5 offset:0
    ds_read_b64_tr_b16 v[26:27], v5 offset:1024
    ds_read_b64_tr_b16 v[28:29], v15 offset:0
    ds_read_b64_tr_b16 v[30:31], v15 offset:1024
    ds_read_b64_tr_b16 v[32:33], v6 offset:0
    ds_read_b64_tr_b16 v[34:35], v6 offset:1024
    ds_read_b64_tr_b16 v[36:37], v16 offset:0
    ds_read_b64_tr_b16 v[38:39], v16 offset:1024
    v_lshrrev_b32 v3, 2, v0
    v_and_b32 v3, 127, v3
    s_lshl_b32 s54, s5, 7
    s_add_u32 s54, s54, 59113472
    s_cmp_eq_u32 s3, 0
    s_cselect_b32 s32, s54, 0x7f000000
    buffer_load_dword v23, v3, s[20:23], s32 offen sc1
    v_mfma_f32_16x16x32_bf16 v[236:239], v[204:207], v[40:43], v[236:239]
    ds_read_b64_tr_b16 v[40:41], v7 offset:0
    v_mfma_f32_16x16x32_bf16 v[236:239], v[212:215], v[44:47], v[236:239]
    ds_read_b64_tr_b16 v[42:43], v7 offset:1024
    v_mfma_f32_16x16x32_bf16 v[240:243], v[200:203], v[48:51], v[240:243]
    ds_read_b64_tr_b16 v[44:45], v11 offset:0
    v_mfma_f32_16x16x32_bf16 v[240:243], v[208:211], v[52:55], v[240:243]
    ds_read_b64_tr_b16 v[46:47], v11 offset:1024
    s_add_u32 s44, s46, 0
    s_and_b32 s44, s44, 7
    s_lshl_b32 s44, s44, 19
    s_add_u32 m0, s6, 49152
    s_add_u32 s44, s44, s48
    buffer_load_dwordx4 v17, s[16:19], s44 offen lds
    v_mfma_f32_16x16x32_bf16 v[244:247], v[204:207], v[48:51], v[244:247]
    ds_read_b64_tr_b16 v[48:49], v8 offset:0
    v_mfma_f32_16x16x32_bf16 v[244:247], v[212:215], v[52:55], v[244:247]
    ds_read_b64_tr_b16 v[50:51], v8 offset:1024
    s_waitcnt lgkmcnt(12)
    v_mfma_f32_16x16x32_bf16 v[56:59], v[24:27], v[248:251], v[56:59]
    ds_read_b64_tr_b16 v[52:53], v12 offset:0
    v_mfma_f32_16x16x32_bf16 v[64:67], v[24:27], v[252:255], v[64:67]
    ds_read_b64_tr_b16 v[54:55], v12 offset:1024
    s_add_u32 m0, s6, 50176
    s_add_u32 s32, s44, 65536
    buffer_load_dwordx4 v10, s[16:19], s32 offen lds
    s_waitcnt lgkmcnt(12)
    v_mfma_f32_16x16x32_bf16 v[60:63], v[28:31], v[248:251], v[60:63]
    ds_read_b64_tr_b16 v[24:25], v18 offset:0
    v_mfma_f32_16x16x32_bf16 v[68:71], v[28:31], v[252:255], v[68:71]
    ds_read_b64_tr_b16 v[26:27], v18 offset:512
    s_waitcnt lgkmcnt(12)
    v_mfma_f32_16x16x32_bf16 v[72:75], v[32:35], v[248:251], v[72:75]
    ds_read_b64_tr_b16 v[28:29], v19 offset:0
    v_mfma_f32_16x16x32_bf16 v[80:83], v[32:35], v[252:255], v[80:83]
    ds_read_b64_tr_b16 v[30:31], v19 offset:512
    s_mov_b32 s24, s78
    s_and_b32 s25, s79, 0xffff
    s_mov_b32 s26, 0x158000
    buffer_load_dword v9, v21, s[24:27], s57 offen
    s_mov_b32 s24, s80
    s_and_b32 s25, s81, 0xffff
    s_mov_b32 s26, 0x158000
    buffer_load_dword v9, v21, s[24:27], s57 offen
    s_waitcnt lgkmcnt(12)
    v_mfma_f32_16x16x32_bf16 v[76:79], v[36:39], v[248:251], v[76:79]
    ds_read_b64_tr_b16 v[32:33], v20 offset:0
    v_mfma_f32_16x16x32_bf16 v[84:87], v[36:39], v[252:255], v[84:87]
    ds_read_b64_tr_b16 v[34:35], v20 offset:512
    s_waitcnt lgkmcnt(12)
    v_mfma_f32_16x16x32_bf16 v[88:91], v[40:43], v[248:251], v[88:91]
    ds_read_b64_tr_b16 v[36:37], v22 offset:0
    v_mfma_f32_16x16x32_bf16 v[96:99], v[40:43], v[252:255], v[96:99]
    ds_read_b64_tr_b16 v[38:39], v22 offset:512
    s_waitcnt lgkmcnt(12)
    v_mfma_f32_16x16x32_bf16 v[92:95], v[44:47], v[248:251], v[92:95]
    ds_read_b64_tr_b16 v[40:41], v5 offset:8192
    v_mfma_f32_16x16x32_bf16 v[100:103], v[44:47], v[252:255], v[100:103]
    ds_read_b64_tr_b16 v[42:43], v5 offset:9216
    s_waitcnt lgkmcnt(12)
    v_mfma_f32_16x16x32_bf16 v[104:107], v[48:51], v[248:251], v[104:107]
    ds_read_b64_tr_b16 v[44:45], v15 offset:8192
    v_mfma_f32_16x16x32_bf16 v[112:115], v[48:51], v[252:255], v[112:115]
    ds_read_b64_tr_b16 v[46:47], v15 offset:9216
    s_waitcnt lgkmcnt(12)
    v_mfma_f32_16x16x32_bf16 v[108:111], v[52:55], v[248:251], v[108:111]
    ds_read_b64_tr_b16 v[48:49], v6 offset:8192
    v_mfma_f32_16x16x32_bf16 v[116:119], v[52:55], v[252:255], v[116:119]
    ds_read_b64_tr_b16 v[50:51], v6 offset:9216
    s_waitcnt lgkmcnt(12)
    v_mfma_f32_16x16x32_bf16 v[216:219], v[248:251], v[24:27], v[216:219]
    ds_read_b64_tr_b16 v[52:53], v16 offset:8192
    v_mfma_f32_16x16x32_bf16 v[220:223], v[252:255], v[24:27], v[220:223]
    ds_read_b64_tr_b16 v[54:55], v16 offset:9216
    s_waitcnt lgkmcnt(12)
    v_mfma_f32_16x16x32_bf16 v[224:227], v[248:251], v[28:31], v[224:227]
    ds_read_b64_tr_b16 v[24:25], v7 offset:8192
    v_mfma_f32_16x16x32_bf16 v[228:231], v[252:255], v[28:31], v[228:231]
    ds_read_b64_tr_b16 v[26:27], v7 offset:9216
    s_waitcnt lgkmcnt(12)
    v_mfma_f32_16x16x32_bf16 v[232:235], v[248:251], v[32:35], v[232:235]
    ds_read_b64_tr_b16 v[28:29], v11 offset:8192
    v_mfma_f32_16x16x32_bf16 v[236:239], v[252:255], v[32:35], v[236:239]
    ds_read_b64_tr_b16 v[30:31], v11 offset:9216
    s_waitcnt lgkmcnt(12)
    v_mfma_f32_16x16x32_bf16 v[240:243], v[248:251], v[36:39], v[240:243]
    ds_read_b64_tr_b16 v[32:33], v8 offset:8192
    v_mfma_f32_16x16x32_bf16 v[244:247], v[252:255], v[36:39], v[244:247]
    ds_read_b64_tr_b16 v[34:35], v8 offset:9216
    ds_read_b128 v[248:251], v14 offset:0
    ds_read_b128 v[252:255], v14 offset:2048
    s_waitcnt lgkmcnt(1)
    v_mfma_f32_16x16x32_bf16 v[56:59], v[40:43], v[248:251], v[56:59]
    ds_read_b64_tr_b16 v[36:37], v12 offset:8192
    s_waitcnt lgkmcnt(1)
    v_mfma_f32_16x16x32_bf16 v[64:67], v[40:43], v[252:255], v[64:67]
    ds_read_b64_tr_b16 v[38:39], v12 offset:9216
    v_mfma_f32_16x16x32_bf16 v[60:63], v[44:47], v[248:251], v[60:63]
    ds_read_b64_tr_b16 v[40:41], v18 offset:4096
    v_mfma_f32_16x16x32_bf16 v[68:71], v[44:47], v[252:255], v[68:71]
    ds_read_b64_tr_b16 v[42:43], v18 offset:4608
    v_mfma_f32_16x16x32_bf16 v[72:75], v[48:51], v[248:251], v[72:75]
    ds_read_b64_tr_b16 v[44:45], v19 offset:4096
    v_mfma_f32_16x16x32_bf16 v[80:83], v[48:51], v[252:255], v[80:83]
    ds_read_b64_tr_b16 v[46:47], v19 offset:4608
    v_mfma_f32_16x16x32_bf16 v[76:79], v[52:55], v[248:251], v[76:79]
    ds_read_b64_tr_b16 v[48:49], v20 offset:4096
    v_mfma_f32_16x16x32_bf16 v[84:87], v[52:55], v[252:255], v[84:87]
    ds_read_b64_tr_b16 v[50:51], v20 offset:4608
    v_mfma_f32_16x16x32_bf16 v[88:91], v[24:27], v[248:251], v[88:91]
    ds_read_b64_tr_b16 v[52:53], v22 offset:4096
    v_mfma_f32_16x16x32_bf16 v[96:99], v[24:27], v[252:255], v[96:99]
    ds_read_b64_tr_b16 v[54:55], v22 offset:4608
    v_mfma_f32_16x16x32_bf16 v[92:95], v[28:31], v[248:251], v[92:95]
    v_mfma_f32_16x16x32_bf16 v[100:103], v[28:31], v[252:255], v[100:103]
    v_mfma_f32_16x16x32_bf16 v[104:107], v[32:35], v[248:251], v[104:107]
    v_mfma_f32_16x16x32_bf16 v[112:115], v[32:35], v[252:255], v[112:115]
    s_waitcnt lgkmcnt(8)
    v_mfma_f32_16x16x32_bf16 v[108:111], v[36:39], v[248:251], v[108:111]
    v_mfma_f32_16x16x32_bf16 v[116:119], v[36:39], v[252:255], v[116:119]
    s_waitcnt lgkmcnt(6)
    v_mfma_f32_16x16x32_bf16 v[216:219], v[248:251], v[40:43], v[216:219]
    v_mfma_f32_16x16x32_bf16 v[220:223], v[252:255], v[40:43], v[220:223]
    s_waitcnt vmcnt(5) lgkmcnt(0)
    s_cmp_lg_u32 s3, 0
    s_cbranch_scc1 f_w04
    s_waitcnt vmcnt(4)
    v_cmp_ne_u32 vcc, s37, v23
    s_nop 0
    s_cbranch_vccz f_pk5
f_pl5:
    s_sub_u32 s38, s38, 1
    s_cselect_b32 s38, 0, s38
    s_cbranch_scc1 f_pk5
    s_sleep 2
    buffer_load_dword v23, v3, s[20:23], s54 offen sc1
    s_waitcnt vmcnt(0)
    v_cmp_ne_u32 vcc, s37, v23
    s_nop 0
    s_cbranch_vccz f_pk5
    s_branch f_pl5
f_pk5:
f_w04:
    s_barrier
    ds_read_b64_tr_b16 v[24:25], v5 offset:24576
    ds_read_b64_tr_b16 v[26:27], v5 offset:25600
    ds_read_b64_tr_b16 v[28:29], v15 offset:24576
    ds_read_b64_tr_b16 v[30:31], v15 offset:25600
    ds_read_b64_tr_b16 v[32:33], v6 offset:24576
    ds_read_b64_tr_b16 v[34:35], v6 offset:25600
    ds_read_b64_tr_b16 v[36:37], v16 offset:24576
    ds_read_b64_tr_b16 v[38:39], v16 offset:25600
    v_mfma_f32_16x16x32_bf16 v[224:227], v[248:251], v[44:47], v[224:227]
    ds_read_b64_tr_b16 v[40:41], v7 offset:24576
    v_mfma_f32_16x16x32_bf16 v[228:231], v[252:255], v[44:47], v[228:231]
    ds_read_b64_tr_b16 v[42:43], v7 offset:25600
    v_mfma_f32_16x16x32_bf16 v[232:235], v[248:251], v[48:51], v[232:235]
    ds_read_b64_tr_b16 v[44:45], v11 offset:24576
    v_mfma_f32_16x16x32_bf16 v[236:239], v[252:255], v[48:51], v[236:239]
    ds_read_b64_tr_b16 v[46:47], v11 offset:25600
    v_mfma_f32_16x16x32_bf16 v[240:243], v[248:251], v[52:55], v[240:243]
    ds_read_b64_tr_b16 v[48:49], v8 offset:24576
    v_mfma_f32_16x16x32_bf16 v[244:247], v[252:255], v[52:55], v[244:247]
    ds_read_b64_tr_b16 v[50:51], v8 offset:25600
    ds_read_b128 v[248:251], v13 offset:4096
    ds_read_b128 v[252:255], v13 offset:6144
    s_waitcnt lgkmcnt(1)
    v_mfma_f32_16x16x32_bf16 v[56:59], v[24:27], v[248:251], v[56:59]
    ds_read_b64_tr_b16 v[52:53], v12 offset:24576
    s_waitcnt lgkmcnt(1)
    v_mfma_f32_16x16x32_bf16 v[64:67], v[24:27], v[252:255], v[64:67]
    ds_read_b64_tr_b16 v[54:55], v12 offset:25600
    v_mfma_f32_16x16x32_bf16 v[60:63], v[28:31], v[248:251], v[60:63]
    ds_read_b64_tr_b16 v[24:25], v18 offset:24576
    v_mfma_f32_16x16x32_bf16 v[68:71], v[28:31], v[252:255], v[68:71]
    ds_read_b64_tr_b16 v[26:27], v18 offset:25088
    v_mfma_f32_16x16x32_bf16 v[72:75], v[32:35], v[248:251], v[72:75]
    ds_read_b64_tr_b16 v[28:29], v19 offset:24576
    v_mfma_f32_16x16x32_bf16 v[80:83], v[32:35], v[252:255], v[80:83]
    ds_read_b64_tr_b16 v[30:31], v19 offset:25088
    v_mfma_f32_16x16x32_bf16 v[76:79], v[36:39], v[248:251], v[76:79]
    ds_read_b64_tr_b16 v[32:33], v20 offset:24576
    v_mfma_f32_16x16x32_bf16 v[84:87], v[36:39], v[252:255], v[84:87]
    ds_read_b64_tr_b16 v[34:35], v20 offset:25088
    v_mfma_f32_16x16x32_bf16 v[88:91], v[40:43], v[248:251], v[88:91]
    ds_read_b64_tr_b16 v[36:37], v22 offset:24576
    v_mfma_f32_16x16x32_bf16 v[96:99], v[40:43], v[252:255], v[96:99]
    ds_read_b64_tr_b16 v[38:39], v22 offset:25088
    v_mfma_f32_16x16x32_bf16 v[92:95], v[44:47], v[248:251], v[92:95]
    ds_read_b64_tr_b16 v[40:41], v5 offset:32768
    v_mfma_f32_16x16x32_bf16 v[100:103], v[44:47], v[252:255], v[100:103]
    ds_read_b64_tr_b16 v[42:43], v5 offset:33792
    v_mfma_f32_16x16x32_bf16 v[104:107], v[48:51], v[248:251], v[104:107]
    ds_read_b64_tr_b16 v[44:45], v15 offset:32768
    v_mfma_f32_16x16x32_bf16 v[112:115], v[48:51], v[252:255], v[112:115]
    ds_read_b64_tr_b16 v[46:47], v15 offset:33792
    s_waitcnt lgkmcnt(12)
    v_mfma_f32_16x16x32_bf16 v[108:111], v[52:55], v[248:251], v[108:111]
    ds_read_b64_tr_b16 v[48:49], v6 offset:32768
    v_mfma_f32_16x16x32_bf16 v[116:119], v[52:55], v[252:255], v[116:119]
    ds_read_b64_tr_b16 v[50:51], v6 offset:33792
    s_add_u32 s44, s46, 6
    s_and_b32 s44, s44, 7
    s_lshl_b32 s44, s44, 19
    s_add_u32 m0, s6, 0
    s_add_u32 s44, s44, s48
    buffer_load_dwordx4 v17, s[16:19], s44 offen lds
    s_waitcnt lgkmcnt(12)
    v_mfma_f32_16x16x32_bf16 v[216:219], v[248:251], v[24:27], v[216:219]
    ds_read_b64_tr_b16 v[52:53], v16 offset:32768
    v_mfma_f32_16x16x32_bf16 v[220:223], v[252:255], v[24:27], v[220:223]
    ds_read_b64_tr_b16 v[54:55], v16 offset:33792
    s_waitcnt lgkmcnt(12)
    v_mfma_f32_16x16x32_bf16 v[224:227], v[248:251], v[28:31], v[224:227]
    ds_read_b64_tr_b16 v[24:25], v7 offset:32768
    v_mfma_f32_16x16x32_bf16 v[228:231], v[252:255], v[28:31], v[228:231]
    ds_read_b64_tr_b16 v[26:27], v7 offset:33792
    s_add_u32 m0, s6, 1024
    s_add_u32 s32, s44, 65536
    buffer_load_dwordx4 v10, s[16:19], s32 offen lds
    s_waitcnt lgkmcnt(12)
    v_mfma_f32_16x16x32_bf16 v[232:235], v[248:251], v[32:35], v[232:235]
    ds_read_b64_tr_b16 v[28:29], v11 offset:32768
    v_mfma_f32_16x16x32_bf16 v[236:239], v[252:255], v[32:35], v[236:239]
    ds_read_b64_tr_b16 v[30:31], v11 offset:33792
    s_waitcnt lgkmcnt(12)
    v_mfma_f32_16x16x32_bf16 v[240:243], v[248:251], v[36:39], v[240:243]
    ds_read_b64_tr_b16 v[32:33], v8 offset:32768
    v_mfma_f32_16x16x32_bf16 v[244:247], v[252:255], v[36:39], v[244:247]
    ds_read_b64_tr_b16 v[34:35], v8 offset:33792
    ds_read_b128 v[248:251], v14 offset:4096
    ds_read_b128 v[252:255], v14 offset:6144
    s_waitcnt lgkmcnt(1)
    v_mfma_f32_16x16x32_bf16 v[56:59], v[40:43], v[248:251], v[56:59]
    ds_read_b64_tr_b16 v[36:37], v12 offset:32768
    s_waitcnt lgkmcnt(1)
    v_mfma_f32_16x16x32_bf16 v[64:67], v[40:43], v[252:255], v[64:67]
    ds_read_b64_tr_b16 v[38:39], v12 offset:33792
    v_mfma_f32_16x16x32_bf16 v[60:63], v[44:47], v[248:251], v[60:63]
    ds_read_b64_tr_b16 v[40:41], v18 offset:28672
    v_mfma_f32_16x16x32_bf16 v[68:71], v[44:47], v[252:255], v[68:71]
    ds_read_b64_tr_b16 v[42:43], v18 offset:29184
    v_mfma_f32_16x16x32_bf16 v[72:75], v[48:51], v[248:251], v[72:75]
    ds_read_b64_tr_b16 v[44:45], v19 offset:28672
    v_mfma_f32_16x16x32_bf16 v[80:83], v[48:51], v[252:255], v[80:83]
    ds_read_b64_tr_b16 v[46:47], v19 offset:29184
    v_mfma_f32_16x16x32_bf16 v[76:79], v[52:55], v[248:251], v[76:79]
    ds_read_b64_tr_b16 v[48:49], v20 offset:28672
    v_mfma_f32_16x16x32_bf16 v[84:87], v[52:55], v[252:255], v[84:87]
    ds_read_b64_tr_b16 v[50:51], v20 offset:29184
    v_mfma_f32_16x16x32_bf16 v[88:91], v[24:27], v[248:251], v[88:91]
    ds_read_b64_tr_b16 v[52:53], v22 offset:28672
    v_mfma_f32_16x16x32_bf16 v[96:99], v[24:27], v[252:255], v[96:99]
    ds_read_b64_tr_b16 v[54:55], v22 offset:29184
    v_mfma_f32_16x16x32_bf16 v[92:95], v[28:31], v[248:251], v[92:95]
    v_mfma_f32_16x16x32_bf16 v[100:103], v[28:31], v[252:255], v[100:103]
    v_cvt_pk_bf16_f32 v56, v56, v57
    v_cvt_pk_bf16_f32 v57, v58, v59
    v_cvt_pk_bf16_f32 v58, v60, v61
    v_cvt_pk_bf16_f32 v59, v62, v63
    v_cvt_pk_bf16_f32 v60, v64, v65
    v_cvt_pk_bf16_f32 v61, v66, v67
    v_cvt_pk_bf16_f32 v62, v68, v69
    v_cvt_pk_bf16_f32 v63, v70, v71
    v_mfma_f32_16x16x32_bf16 v[104:107], v[32:35], v[248:251], v[104:107]
    v_mfma_f32_16x16x32_bf16 v[112:115], v[32:35], v[252:255], v[112:115]
    s_waitcnt lgkmcnt(8)
    v_mfma_f32_16x16x32_bf16 v[108:111], v[36:39], v[248:251], v[108:111]
    v_mfma_f32_16x16x32_bf16 v[116:119], v[36:39], v[252:255], v[116:119]
    v_cvt_pk_bf16_f32 v64, v72, v73
    v_cvt_pk_bf16_f32 v65, v74, v75
    v_cvt_pk_bf16_f32 v66, v76, v77
    v_cvt_pk_bf16_f32 v67, v78, v79
    v_cvt_pk_bf16_f32 v68, v80, v81
    v_cvt_pk_bf16_f32 v69, v82, v83
    v_cvt_pk_bf16_f32 v70, v84, v85
    v_cvt_pk_bf16_f32 v71, v86, v87
    s_waitcnt lgkmcnt(6)
    v_mfma_f32_16x16x32_bf16 v[216:219], v[248:251], v[40:43], v[216:219]
    v_mfma_f32_16x16x32_bf16 v[220:223], v[252:255], v[40:43], v[220:223]
    s_waitcnt vmcnt(4) lgkmcnt(0)
    s_barrier
    v_subrev_u32 v18, 0x4000, v18
    v_subrev_u32 v19, 0x4000, v19
    v_subrev_u32 v20, 0x4000, v20
    v_subrev_u32 v22, 0x4000, v22
    ds_read_b64_tr_b16 v[24:25], v18 offset:49152
    ds_read_b64_tr_b16 v[26:27], v18 offset:49664
    ds_read_b64_tr_b16 v[28:29], v18 offset:53248
    ds_read_b64_tr_b16 v[30:31], v18 offset:53760
    ds_read_b64_tr_b16 v[32:33], v18 offset:57344
    ds_read_b64_tr_b16 v[34:35], v18 offset:57856
    ds_read_b64_tr_b16 v[36:37], v18 offset:61440
    ds_read_b64_tr_b16 v[38:39], v18 offset:61952
    v_mfma_f32_16x16x32_bf16 v[224:227], v[248:251], v[44:47], v[224:227]
    ds_read_b64_tr_b16 v[40:41], v19 offset:49152
    v_mfma_f32_16x16x32_bf16 v[228:231], v[252:255], v[44:47], v[228:231]
    ds_read_b64_tr_b16 v[42:43], v19 offset:49664
    s_add_u32 s44, s46, 2
    s_and_b32 s44, s44, 7
    s_lshl_b32 s44, s44, 19
    s_add_u32 m0, s6, 16384
    s_add_u32 s44, s44, s48
    buffer_load_dwordx4 v17, s[16:19], s44 offen lds
    v_cvt_pk_bf16_f32 v72, v88, v89
    v_cvt_pk_bf16_f32 v73, v90, v91
    v_cvt_pk_bf16_f32 v74, v92, v93
    v_cvt_pk_bf16_f32 v75, v94, v95
    v_cvt_pk_bf16_f32 v76, v96, v97
    v_cvt_pk_bf16_f32 v77, v98, v99
    v_cvt_pk_bf16_f32 v78, v100, v101
    v_cvt_pk_bf16_f32 v79, v102, v103
    v_mfma_f32_16x16x32_bf16 v[232:235], v[248:251], v[48:51], v[232:235]
    ds_read_b64_tr_b16 v[44:45], v19 offset:53248
    v_mfma_f32_16x16x32_bf16 v[236:239], v[252:255], v[48:51], v[236:239]
    ds_read_b64_tr_b16 v[46:47], v19 offset:53760
    v_mfma_f32_16x16x32_bf16 v[240:243], v[248:251], v[52:55], v[240:243]
    ds_read_b64_tr_b16 v[48:49], v19 offset:57344
    v_mfma_f32_16x16x32_bf16 v[244:247], v[252:255], v[52:55], v[244:247]
    ds_read_b64_tr_b16 v[50:51], v19 offset:57856
    s_add_u32 m0, s6, 17408
    s_add_u32 s32, s44, 65536
    buffer_load_dwordx4 v10, s[16:19], s32 offen lds
    s_waitcnt lgkmcnt(12)
    v_mfma_f32_16x16x32_bf16 v[88:91], v[120:123], v[24:27], 0
    ds_read_b64_tr_b16 v[52:53], v19 offset:61440
    s_waitcnt lgkmcnt(11)
    v_mfma_f32_16x16x32_bf16 v[88:91], v[128:131], v[28:31], v[88:91]
    ds_read_b64_tr_b16 v[54:55], v19 offset:61952
    v_cvt_pk_bf16_f32 v80, v104, v105
    v_cvt_pk_bf16_f32 v81, v106, v107
    v_cvt_pk_bf16_f32 v82, v108, v109
    v_cvt_pk_bf16_f32 v83, v110, v111
    v_cvt_pk_bf16_f32 v84, v112, v113
    v_cvt_pk_bf16_f32 v85, v114, v115
    v_cvt_pk_bf16_f32 v86, v116, v117
    v_cvt_pk_bf16_f32 v87, v118, v119
    v_mfma_f32_16x16x32_bf16 v[92:95], v[124:127], v[24:27], 0
    ds_read_b64_tr_b16 v[24:25], v20 offset:49152
    v_mfma_f32_16x16x32_bf16 v[92:95], v[132:135], v[28:31], v[92:95]
    ds_read_b64_tr_b16 v[26:27], v20 offset:49664
    s_waitcnt lgkmcnt(12)
    v_mfma_f32_16x16x32_bf16 v[88:91], v[136:139], v[32:35], v[88:91]
    ds_read_b64_tr_b16 v[28:29], v20 offset:53248
    s_waitcnt lgkmcnt(11)
    v_mfma_f32_16x16x32_bf16 v[88:91], v[144:147], v[36:39], v[88:91]
    ds_read_b64_tr_b16 v[30:31], v20 offset:53760
    v_lshrrev_b32 v248, 4, v0
    s_mul_i32 s32, s4, 3
    s_lshl_b32 s33, s4, 1
    s_add_u32 s33, s33, 22
    s_cmp_lt_u32 s4, 22
    s_cselect_b32 s49, s32, s33
    s_cselect_b32 s43, 3, 2
    v_lshrrev_b32 v249, 3, v248
    v_mfma_f32_16x16x32_bf16 v[92:95], v[140:143], v[32:35], v[92:95]
    ds_read_b64_tr_b16 v[32:33], v20 offset:57344
    v_mfma_f32_16x16x32_bf16 v[92:95], v[148:151], v[36:39], v[92:95]
    ds_read_b64_tr_b16 v[34:35], v20 offset:57856
    s_lshl_b32 s32, s3, 3
    v_add_u32 v249, s32, v249
    v_mul_u32_u24 v249, 2752, v249
    v_and_b32 v250, 1, v248
    s_add_u32 s32, s34, 0
    buffer_store_dwordx4 v[56:59], v0, s[20:23], s32 offen sc1
    v_cvt_pk_bf16_f32 v232, v232, v233
    v_cvt_pk_bf16_f32 v233, v234, v235
    v_cvt_pk_bf16_f32 v234, v236, v237
    v_cvt_pk_bf16_f32 v235, v238, v239
    v_cvt_pk_bf16_f32 v236, v240, v241
    v_cvt_pk_bf16_f32 v237, v242, v243
    v_cvt_pk_bf16_f32 v238, v244, v245
    v_cvt_pk_bf16_f32 v239, v246, v247
    s_waitcnt lgkmcnt(12)
    v_mfma_f32_16x16x32_bf16 v[96:99], v[120:123], v[40:43], 0
    ds_read_b64_tr_b16 v[36:37], v20 offset:61440
    s_waitcnt lgkmcnt(11)
    v_mfma_f32_16x16x32_bf16 v[96:99], v[128:131], v[44:47], v[96:99]
    ds_read_b64_tr_b16 v[38:39], v20 offset:61952
    v_lshl_add_u32 v249, v250, 4, v249
    s_lshl_b32 s32, s49, 5
    v_add_u32 v249, s32, v249
    v_bfe_u32 v250, v248, 1, 2
    v_mfma_f32_16x16x32_bf16 v[100:103], v[124:127], v[40:43], 0
    ds_read_b64_tr_b16 v[40:41], v22 offset:49152
    v_mfma_f32_16x16x32_bf16 v[100:103], v[132:135], v[44:47], v[100:103]
    ds_read_b64_tr_b16 v[42:43], v22 offset:49664
    v_bfe_u32 v251, v248, 4, 1
    v_lshlrev_b32 v251, 1, v251
    v_xor_b32 v250, v250, v251
    v_cvt_pk_bf16_f32 v240, v216, v217
    v_cvt_pk_bf16_f32 v241, v218, v219
    v_cvt_pk_bf16_f32 v242, v220, v221
    v_cvt_pk_bf16_f32 v243, v222, v223
    v_cvt_pk_bf16_f32 v244, v224, v225
    v_cvt_pk_bf16_f32 v245, v226, v227
    v_cvt_pk_bf16_f32 v246, v228, v229
    v_cvt_pk_bf16_f32 v247, v230, v231
    s_waitcnt lgkmcnt(12)
    v_mfma_f32_16x16x32_bf16 v[96:99], v[136:139], v[48:51], v[96:99]
    ds_read_b64_tr_b16 v[44:45], v22 offset:53248
    s_waitcnt lgkmcnt(11)
    v_mfma_f32_16x16x32_bf16 v[96:99], v[144:147], v[52:55], v[96:99]
    ds_read_b64_tr_b16 v[46:47], v22 offset:53760
    s_and_b32 s32, s3, 1
    v_xor_b32 v250, s32, v250
    v_mov_b32 v251, 0x7f000000
    s_waitcnt vmcnt(5)
    v_lshl_add_u32 v9, v250, 5, v249
    v_mfma_f32_16x16x32_bf16 v[100:103], v[140:143], v[48:51], v[100:103]
    ds_read_b64_tr_b16 v[48:49], v22 offset:57344
    v_mfma_f32_16x16x32_bf16 v[100:103], v[148:151], v[52:55], v[100:103]
    ds_read_b64_tr_b16 v[50:51], v22 offset:57856
    v_cmp_gt_u32 vcc, s43, v250
    s_nop 1
    v_cndmask_b32 v9, v251, v9, vcc
    s_mul_i32 s40, s55, 350208
    s_add_u32 s40, s40, 36700160
    s_waitcnt lgkmcnt(12)
    v_mfma_f32_16x16x32_bf16 v[104:107], v[120:123], v[24:27], 0
    ds_read_b64_tr_b16 v[52:53], v22 offset:61440
    s_waitcnt lgkmcnt(11)
    v_mfma_f32_16x16x32_bf16 v[104:107], v[128:131], v[28:31], v[104:107]
    ds_read_b64_tr_b16 v[54:55], v22 offset:61952
    s_add_u32 s49, s49, 256
    s_lshl_b32 s49, s49, 10
    s_add_u32 s49, s49, s40
    v_mfma_f32_16x16x32_bf16 v[108:111], v[124:127], v[24:27], 0
    v_mfma_f32_16x16x32_bf16 v[108:111], v[132:135], v[28:31], v[108:111]
    s_cmp_eq_u32 s43, 3
    s_cselect_b32 s57, s49, 0x7f000000
    s_mov_b32 s8, s68
    s_and_b32 s9, s69, 0xffff
    ds_read_b128 v[216:219], v13 offset:0
    ds_read_b128 v[220:223], v13 offset:2048
    s_waitcnt lgkmcnt(12)
    v_mfma_f32_16x16x32_bf16 v[104:107], v[136:139], v[32:35], v[104:107]
    s_waitcnt lgkmcnt(10)
    v_mfma_f32_16x16x32_bf16 v[104:107], v[144:147], v[36:39], v[104:107]
    s_mov_b32 s10, 0x400000
    s_mov_b32 s11, 0x20000
    s_mov_b32 s12, s78
    v_mfma_f32_16x16x32_bf16 v[108:111], v[140:143], v[32:35], v[108:111]
    v_mfma_f32_16x16x32_bf16 v[108:111], v[148:151], v[36:39], v[108:111]
    s_and_b32 s13, s79, 0xffff
    s_mov_b32 s14, 0x158000
    s_mov_b32 s15, 0x20000
    ds_read_b128 v[224:227], v14 offset:0
    ds_read_b128 v[228:231], v14 offset:2048
    s_add_u32 s32, s34, 43008
    buffer_store_dwordx4 v[232:235], v0, s[20:23], s32 offen sc1
    s_waitcnt lgkmcnt(10)
    v_mfma_f32_16x16x32_bf16 v[112:115], v[120:123], v[40:43], 0
    s_waitcnt lgkmcnt(8)
    v_mfma_f32_16x16x32_bf16 v[112:115], v[128:131], v[44:47], v[112:115]
    s_waitcnt vmcnt(4) lgkmcnt(4)
    s_barrier
    ds_read_b64_tr_b16 v[24:25], v18 offset:0
    ds_read_b64_tr_b16 v[26:27], v18 offset:512
    ds_read_b64_tr_b16 v[28:29], v19 offset:0
    ds_read_b64_tr_b16 v[30:31], v19 offset:512
    ds_read_b64_tr_b16 v[32:33], v20 offset:0
    ds_read_b64_tr_b16 v[34:35], v20 offset:512
    ds_read_b64_tr_b16 v[36:37], v22 offset:0
    ds_read_b64_tr_b16 v[38:39], v22 offset:512
    s_mov_b32 s24, s80
    s_and_b32 s25, s81, 0xffff
    s_mov_b32 s26, 0x158000
    v_mfma_f32_16x16x32_bf16 v[116:119], v[124:127], v[40:43], 0
    ds_read_b64_tr_b16 v[40:41], v18 offset:4096
    v_mfma_f32_16x16x32_bf16 v[116:119], v[132:135], v[44:47], v[116:119]
    ds_read_b64_tr_b16 v[42:43], v18 offset:4608
    s_mov_b32 s27, 0x20000
    s_add_u32 s44, s46, 4
    s_and_b32 s44, s44, 7
    s_lshl_b32 s44, s44, 19
    s_add_u32 m0, s6, 32768
    s_add_u32 s44, s44, s48
    buffer_load_dwordx4 v17, s[16:19], s44 offen lds
    v_mfma_f32_16x16x32_bf16 v[112:115], v[136:139], v[48:51], v[112:115]
    ds_read_b64_tr_b16 v[44:45], v19 offset:4096
    v_mfma_f32_16x16x32_bf16 v[112:115], v[144:147], v[52:55], v[112:115]
    ds_read_b64_tr_b16 v[46:47], v19 offset:4608
    v_mfma_f32_16x16x32_bf16 v[116:119], v[140:143], v[48:51], v[116:119]
    ds_read_b64_tr_b16 v[48:49], v20 offset:4096
    v_mfma_f32_16x16x32_bf16 v[116:119], v[148:151], v[52:55], v[116:119]
    ds_read_b64_tr_b16 v[50:51], v20 offset:4608
    s_add_u32 m0, s6, 33792
    s_add_u32 s32, s44, 65536
    buffer_load_dwordx4 v10, s[16:19], s32 offen lds
    s_waitcnt lgkmcnt(12)
    v_mfma_f32_16x16x32_bf16 v[88:91], v[216:219], v[24:27], v[88:91]
    ds_read_b64_tr_b16 v[52:53], v22 offset:4096
    v_mfma_f32_16x16x32_bf16 v[92:95], v[220:223], v[24:27], v[92:95]
    ds_read_b64_tr_b16 v[54:55], v22 offset:4608
    s_waitcnt lgkmcnt(12)
    v_mfma_f32_16x16x32_bf16 v[96:99], v[216:219], v[28:31], v[96:99]
    ds_read_b64_tr_b16 v[24:25], v18 offset:8192
    v_mfma_f32_16x16x32_bf16 v[100:103], v[220:223], v[28:31], v[100:103]
    ds_read_b64_tr_b16 v[26:27], v18 offset:8704
    s_add_u32 s32, s39, 0
    buffer_load_dwordx4 v[120:123], v0, s[20:23], s32 offen offset:0 sc1
    s_waitcnt lgkmcnt(12)
    v_mfma_f32_16x16x32_bf16 v[104:107], v[216:219], v[32:35], v[104:107]
    ds_read_b64_tr_b16 v[28:29], v19 offset:8192
    v_mfma_f32_16x16x32_bf16 v[108:111], v[220:223], v[32:35], v[108:111]
    ds_read_b64_tr_b16 v[30:31], v19 offset:8704
    s_waitcnt lgkmcnt(12)
    v_mfma_f32_16x16x32_bf16 v[112:115], v[216:219], v[36:39], v[112:115]
    ds_read_b64_tr_b16 v[32:33], v20 offset:8192
    v_mfma_f32_16x16x32_bf16 v[116:119], v[220:223], v[36:39], v[116:119]
    ds_read_b64_tr_b16 v[34:35], v20 offset:8704
    ds_read_b128 v[216:219], v13 offset:4096
    ds_read_b128 v[220:223], v13 offset:6144
    s_add_u32 s32, s34, 4096
    buffer_store_dwordx4 v[60:63], v0, s[20:23], s32 offen sc1
    s_waitcnt lgkmcnt(14)
    v_mfma_f32_16x16x32_bf16 v[88:91], v[224:227], v[40:43], v[88:91]
    ds_read_b64_tr_b16 v[36:37], v22 offset:8192
    v_mfma_f32_16x16x32_bf16 v[92:95], v[228:231], v[40:43], v[92:95]
    ds_read_b64_tr_b16 v[38:39], v22 offset:8704
    s_waitcnt lgkmcnt(14)
    v_mfma_f32_16x16x32_bf16 v[96:99], v[224:227], v[44:47], v[96:99]
    ds_read_b64_tr_b16 v[40:41], v18 offset:12288
    v_mfma_f32_16x16x32_bf16 v[100:103], v[228:231], v[44:47], v[100:103]
    ds_read_b64_tr_b16 v[42:43], v18 offset:12800
    s_waitcnt lgkmcnt(14)
    v_mfma_f32_16x16x32_bf16 v[104:107], v[224:227], v[48:51], v[104:107]
    ds_read_b64_tr_b16 v[44:45], v19 offset:12288
    v_mfma_f32_16x16x32_bf16 v[108:111], v[228:231], v[48:51], v[108:111]
    ds_read_b64_tr_b16 v[46:47], v19 offset:12800
    s_add_u32 s32, s39, 0
    buffer_load_dwordx4 v[124:127], v0, s[20:23], s32 offen offset:1024 sc1
    s_waitcnt lgkmcnt(14)
    v_mfma_f32_16x16x32_bf16 v[112:115], v[224:227], v[52:55], v[112:115]
    ds_read_b64_tr_b16 v[48:49], v20 offset:12288
    v_mfma_f32_16x16x32_bf16 v[116:119], v[228:231], v[52:55], v[116:119]
    ds_read_b64_tr_b16 v[50:51], v20 offset:12800
    ds_read_b128 v[224:227], v14 offset:4096
    ds_read_b128 v[228:231], v14 offset:6144
    s_waitcnt lgkmcnt(11)
    v_mfma_f32_16x16x32_bf16 v[88:91], v[216:219], v[24:27], v[88:91]
    ds_read_b64_tr_b16 v[52:53], v22 offset:12288
    s_waitcnt lgkmcnt(11)
    v_mfma_f32_16x16x32_bf16 v[92:95], v[220:223], v[24:27], v[92:95]
    ds_read_b64_tr_b16 v[54:55], v22 offset:12800
    v_mfma_f32_16x16x32_bf16 v[96:99], v[216:219], v[28:31], v[96:99]
    v_mfma_f32_16x16x32_bf16 v[100:103], v[220:223], v[28:31], v[100:103]
    v_mfma_f32_16x16x32_bf16 v[104:107], v[216:219], v[32:35], v[104:107]
    v_mfma_f32_16x16x32_bf16 v[108:111], v[220:223], v[32:35], v[108:111]
    s_waitcnt lgkmcnt(10)
    v_mfma_f32_16x16x32_bf16 v[112:115], v[216:219], v[36:39], v[112:115]
    v_mfma_f32_16x16x32_bf16 v[116:119], v[220:223], v[36:39], v[116:119]
    s_add_u32 s32, s39, 0
    buffer_load_dwordx4 v[128:131], v0, s[20:23], s32 offen offset:2048 sc1
    s_waitcnt lgkmcnt(3)
    v_mfma_f32_16x16x32_bf16 v[88:91], v[224:227], v[40:43], v[88:91]
    s_waitcnt lgkmcnt(2)
    v_mfma_f32_16x16x32_bf16 v[92:95], v[228:231], v[40:43], v[92:95]
    s_waitcnt vmcnt(8) lgkmcnt(0)
    s_barrier
    ds_read_b64_tr_b16 v[24:25], v18 offset:16384
    ds_read_b64_tr_b16 v[26:27], v18 offset:16896
    ds_read_b64_tr_b16 v[28:29], v18 offset:20480
    ds_read_b64_tr_b16 v[30:31], v18 offset:20992
    ds_read_b64_tr_b16 v[32:33], v18 offset:24576
    ds_read_b64_tr_b16 v[34:35], v18 offset:25088
    ds_read_b64_tr_b16 v[36:37], v18 offset:28672
    ds_read_b64_tr_b16 v[38:39], v18 offset:29184
    v_mfma_f32_16x16x32_bf16 v[96:99], v[224:227], v[44:47], v[96:99]
    ds_read_b64_tr_b16 v[40:41], v19 offset:16384
    v_mfma_f32_16x16x32_bf16 v[100:103], v[228:231], v[44:47], v[100:103]
    ds_read_b64_tr_b16 v[42:43], v19 offset:16896
    s_add_u32 m0, s6, 65536
    s_mov_b32 s32, 0
    buffer_load_dwordx4 v4, s[8:11], s32 offen lds
    v_mfma_f32_16x16x32_bf16 v[104:107], v[224:227], v[48:51], v[104:107]
    ds_read_b64_tr_b16 v[44:45], v19 offset:20480
    v_mfma_f32_16x16x32_bf16 v[108:111], v[228:231], v[48:51], v[108:111]
    ds_read_b64_tr_b16 v[46:47], v19 offset:20992
    v_mfma_f32_16x16x32_bf16 v[112:115], v[224:227], v[52:55], v[112:115]
    ds_read_b64_tr_b16 v[48:49], v19 offset:24576
    v_mfma_f32_16x16x32_bf16 v[116:119], v[228:231], v[52:55], v[116:119]
    ds_read_b64_tr_b16 v[50:51], v19 offset:25088
    s_waitcnt lgkmcnt(12)
    v_mfma_f32_16x16x32_bf16 v[88:91], v[152:155], v[24:27], v[88:91]
    ds_read_b64_tr_b16 v[52:53], v19 offset:28672
    s_waitcnt lgkmcnt(11)
    v_mfma_f32_16x16x32_bf16 v[88:91], v[160:163], v[28:31], v[88:91]
    ds_read_b64_tr_b16 v[54:55], v19 offset:29184
    s_add_u32 m0, s6, 66560
    s_mov_b32 s32, 32768
    buffer_load_dwordx4 v4, s[8:11], s32 offen lds
    s_add_u32 s32, s39, 0
    buffer_load_dwordx4 v[132:135], v0, s[20:23], s32 offen offset:3072 sc1
    v_mfma_f32_16x16x32_bf16 v[92:95], v[156:159], v[24:27], v[92:95]
    ds_read_b64_tr_b16 v[24:25], v20 offset:16384
    v_mfma_f32_16x16x32_bf16 v[92:95], v[164:167], v[28:31], v[92:95]
    ds_read_b64_tr_b16 v[26:27], v20 offset:16896
    s_waitcnt lgkmcnt(12)
    v_mfma_f32_16x16x32_bf16 v[88:91], v[168:171], v[32:35], v[88:91]
    ds_read_b64_tr_b16 v[28:29], v20 offset:20480
    s_waitcnt lgkmcnt(11)
    v_mfma_f32_16x16x32_bf16 v[88:91], v[176:179], v[36:39], v[88:91]
    ds_read_b64_tr_b16 v[30:31], v20 offset:20992
    v_mfma_f32_16x16x32_bf16 v[92:95], v[172:175], v[32:35], v[92:95]
    ds_read_b64_tr_b16 v[32:33], v20 offset:24576
    v_mfma_f32_16x16x32_bf16 v[92:95], v[180:183], v[36:39], v[92:95]
    ds_read_b64_tr_b16 v[34:35], v20 offset:25088
    s_add_u32 s32, s34, 1024
    buffer_store_dwordx4 v[64:67], v0, s[20:23], s32 offen sc1
    s_waitcnt lgkmcnt(12)
    v_mfma_f32_16x16x32_bf16 v[96:99], v[152:155], v[40:43], v[96:99]
    ds_read_b64_tr_b16 v[36:37], v20 offset:28672
    s_waitcnt lgkmcnt(11)
    v_mfma_f32_16x16x32_bf16 v[96:99], v[160:163], v[44:47], v[96:99]
    ds_read_b64_tr_b16 v[38:39], v20 offset:29184
    s_add_u32 m0, s56, 65536
    s_mov_b32 s32, 0
    buffer_load_dwordx4 v9, s[12:15], s32 offen lds
    v_mfma_f32_16x16x32_bf16 v[100:103], v[156:159], v[40:43], v[100:103]
    ds_read_b64_tr_b16 v[40:41], v22 offset:16384
    v_mfma_f32_16x16x32_bf16 v[100:103], v[164:167], v[44:47], v[100:103]
    ds_read_b64_tr_b16 v[42:43], v22 offset:16896
    s_add_u32 s32, s39, 4096
    buffer_load_dwordx4 v[136:139], v0, s[20:23], s32 offen offset:0 sc1
    s_waitcnt lgkmcnt(12)
    v_mfma_f32_16x16x32_bf16 v[96:99], v[168:171], v[48:51], v[96:99]
    ds_read_b64_tr_b16 v[44:45], v22 offset:20480
    s_waitcnt lgkmcnt(11)
    v_mfma_f32_16x16x32_bf16 v[96:99], v[176:179], v[52:55], v[96:99]
    ds_read_b64_tr_b16 v[46:47], v22 offset:20992
    v_mfma_f32_16x16x32_bf16 v[100:103], v[172:175], v[48:51], v[100:103]
    ds_read_b64_tr_b16 v[48:49], v22 offset:24576
    v_mfma_f32_16x16x32_bf16 v[100:103], v[180:183], v[52:55], v[100:103]
    ds_read_b64_tr_b16 v[50:51], v22 offset:25088
    s_add_u32 m0, s56, 73728
    s_mov_b32 s32, 0
    buffer_load_dwordx4 v9, s[24:27], s32 offen lds
    s_waitcnt lgkmcnt(12)
    v_mfma_f32_16x16x32_bf16 v[104:107], v[152:155], v[24:27], v[104:107]
    ds_read_b64_tr_b16 v[52:53], v22 offset:28672
    s_waitcnt lgkmcnt(11)
    v_mfma_f32_16x16x32_bf16 v[104:107], v[160:163], v[28:31], v[104:107]
    ds_read_b64_tr_b16 v[54:55], v22 offset:29184
    v_mfma_f32_16x16x32_bf16 v[108:111], v[156:159], v[24:27], v[108:111]
    v_mfma_f32_16x16x32_bf16 v[108:111], v[164:167], v[28:31], v[108:111]
    s_waitcnt lgkmcnt(10)
    v_mfma_f32_16x16x32_bf16 v[104:107], v[168:171], v[32:35], v[104:107]
    s_waitcnt lgkmcnt(8)
    v_mfma_f32_16x16x32_bf16 v[104:107], v[176:179], v[36:39], v[104:107]
    s_add_u32 s32, s39, 4096
    buffer_load_dwordx4 v[140:143], v0, s[20:23], s32 offen offset:1024 sc1
    v_mfma_f32_16x16x32_bf16 v[108:111], v[172:175], v[32:35], v[108:111]
    v_mfma_f32_16x16x32_bf16 v[108:111], v[180:183], v[36:39], v[108:111]
    s_add_u32 m0, s6, 98304
    s_mov_b32 s32, 524288
    buffer_load_dwordx4 v4, s[8:11], s32 offen lds
    s_add_u32 s32, s34, 44032
    buffer_store_dwordx4 v[236:239], v0, s[20:23], s32 offen sc1
    s_waitcnt lgkmcnt(6)
    v_mfma_f32_16x16x32_bf16 v[112:115], v[152:155], v[40:43], v[112:115]
    s_waitcnt lgkmcnt(4)
    v_mfma_f32_16x16x32_bf16 v[112:115], v[160:163], v[44:47], v[112:115]
    s_waitcnt vmcnt(14) lgkmcnt(0)
    s_barrier
    ds_read_b64_tr_b16 v[24:25], v18 offset:32768
    ds_read_b64_tr_b16 v[26:27], v18 offset:33280
    ds_read_b64_tr_b16 v[28:29], v18 offset:36864
    ds_read_b64_tr_b16 v[30:31], v18 offset:37376
    ds_read_b64_tr_b16 v[32:33], v18 offset:40960
    ds_read_b64_tr_b16 v[34:35], v18 offset:41472
    ds_read_b64_tr_b16 v[36:37], v18 offset:45056
    ds_read_b64_tr_b16 v[38:39], v18 offset:45568
    v_mfma_f32_16x16x32_bf16 v[116:119], v[156:159], v[40:43], v[116:119]
    ds_read_b64_tr_b16 v[40:41], v19 offset:32768
    v_mfma_f32_16x16x32_bf16 v[116:119], v[164:167], v[44:47], v[116:119]
    ds_read_b64_tr_b16 v[42:43], v19 offset:33280
    v_mfma_f32_16x16x32_bf16 v[112:115], v[168:171], v[48:51], v[112:115]
    ds_read_b64_tr_b16 v[44:45], v19 offset:36864
    v_mfma_f32_16x16x32_bf16 v[112:115], v[176:179], v[52:55], v[112:115]
    ds_read_b64_tr_b16 v[46:47], v19 offset:37376
    s_add_u32 m0, s6, 99328
    s_mov_b32 s32, 557056
    buffer_load_dwordx4 v4, s[8:11], s32 offen lds
    v_mfma_f32_16x16x32_bf16 v[116:119], v[172:175], v[48:51], v[116:119]
    ds_read_b64_tr_b16 v[48:49], v19 offset:40960
    v_mfma_f32_16x16x32_bf16 v[116:119], v[180:183], v[52:55], v[116:119]
    ds_read_b64_tr_b16 v[50:51], v19 offset:41472
    s_add_u32 s32, s39, 4096
    buffer_load_dwordx4 v[144:147], v0, s[20:23], s32 offen offset:2048 sc1
    s_waitcnt lgkmcnt(12)
    v_mfma_f32_16x16x32_bf16 v[88:91], v[184:187], v[24:27], v[88:91]
    ds_read_b64_tr_b16 v[52:53], v19 offset:45056
    s_waitcnt lgkmcnt(11)
    v_mfma_f32_16x16x32_bf16 v[88:91], v[192:195], v[28:31], v[88:91]
    ds_read_b64_tr_b16 v[54:55], v19 offset:45568
    v_mfma_f32_16x16x32_bf16 v[92:95], v[188:191], v[24:27], v[92:95]
    ds_read_b64_tr_b16 v[24:25], v20 offset:32768
    v_mfma_f32_16x16x32_bf16 v[92:95], v[196:199], v[28:31], v[92:95]
    ds_read_b64_tr_b16 v[26:27], v20 offset:33280
    s_waitcnt lgkmcnt(12)
    v_mfma_f32_16x16x32_bf16 v[88:91], v[200:203], v[32:35], v[88:91]
    ds_read_b64_tr_b16 v[28:29], v20 offset:36864
    s_waitcnt lgkmcnt(11)
    v_mfma_f32_16x16x32_bf16 v[88:91], v[208:211], v[36:39], v[88:91]
    ds_read_b64_tr_b16 v[30:31], v20 offset:37376
    s_add_u32 m0, s56, 98304
    s_mov_b32 s32, 176128
    buffer_load_dwordx4 v9, s[12:15], s32 offen lds
    v_mov_b32 v168, v72
    v_mov_b32 v169, v73
    v_mfma_f32_16x16x32_bf16 v[92:95], v[204:207], v[32:35], v[92:95]
    ds_read_b64_tr_b16 v[32:33], v20 offset:40960
    v_mfma_f32_16x16x32_bf16 v[92:95], v[212:215], v[36:39], v[92:95]
    ds_read_b64_tr_b16 v[34:35], v20 offset:41472
    s_add_u32 s32, s34, 5120
    buffer_store_dwordx4 v[68:71], v0, s[20:23], s32 offen sc1
    v_mov_b32 v170, v74
    s_waitcnt lgkmcnt(12)
    v_mfma_f32_16x16x32_bf16 v[96:99], v[184:187], v[40:43], v[96:99]
    ds_read_b64_tr_b16 v[36:37], v20 offset:45056
    s_waitcnt lgkmcnt(11)
    v_mfma_f32_16x16x32_bf16 v[96:99], v[192:195], v[44:47], v[96:99]
    ds_read_b64_tr_b16 v[38:39], v20 offset:45568
    s_add_u32 s32, s39, 4096
    buffer_load_dwordx4 v[148:151], v0, s[20:23], s32 offen offset:3072 sc1
    v_mov_b32 v171, v75
    v_mfma_f32_16x16x32_bf16 v[100:103], v[188:191], v[40:43], v[100:103]
    ds_read_b64_tr_b16 v[40:41], v22 offset:32768
    v_mfma_f32_16x16x32_bf16 v[100:103], v[196:199], v[44:47], v[100:103]
    ds_read_b64_tr_b16 v[42:43], v22 offset:33280
    s_add_u32 m0, s56, 106496
    s_mov_b32 s32, 176128
    buffer_load_dwordx4 v9, s[24:27], s32 offen lds
    v_mov_b32 v172, v76
    v_mov_b32 v173, v77
    s_waitcnt lgkmcnt(12)
    v_mfma_f32_16x16x32_bf16 v[96:99], v[200:203], v[48:51], v[96:99]
    ds_read_b64_tr_b16 v[44:45], v22 offset:36864
    s_waitcnt lgkmcnt(11)
    v_mfma_f32_16x16x32_bf16 v[96:99], v[208:211], v[52:55], v[96:99]
    ds_read_b64_tr_b16 v[46:47], v22 offset:37376
    v_mov_b32 v174, v78
    v_mfma_f32_16x16x32_bf16 v[100:103], v[204:207], v[48:51], v[100:103]
    ds_read_b64_tr_b16 v[48:49], v22 offset:40960
    v_mfma_f32_16x16x32_bf16 v[100:103], v[212:215], v[52:55], v[100:103]
    ds_read_b64_tr_b16 v[50:51], v22 offset:41472
    v_mov_b32 v175, v79
    s_waitcnt lgkmcnt(12)
    v_mfma_f32_16x16x32_bf16 v[104:107], v[184:187], v[24:27], v[104:107]
    ds_read_b64_tr_b16 v[52:53], v22 offset:45056
    s_waitcnt lgkmcnt(11)
    v_mfma_f32_16x16x32_bf16 v[104:107], v[192:195], v[28:31], v[104:107]
    ds_read_b64_tr_b16 v[54:55], v22 offset:45568
    v_mov_b32 v176, v80
    v_mov_b32 v177, v81
    v_mfma_f32_16x16x32_bf16 v[108:111], v[188:191], v[24:27], v[108:111]
    v_mfma_f32_16x16x32_bf16 v[108:111], v[196:199], v[28:31], v[108:111]
    v_mov_b32 v178, v82
    s_waitcnt lgkmcnt(10)
    v_mfma_f32_16x16x32_bf16 v[104:107], v[200:203], v[32:35], v[104:107]
    s_waitcnt lgkmcnt(8)
    v_mfma_f32_16x16x32_bf16 v[104:107], v[208:211], v[36:39], v[104:107]
    v_mov_b32 v179, v83
    v_mfma_f32_16x16x32_bf16 v[108:111], v[204:207], v[32:35], v[108:111]
    v_mfma_f32_16x16x32_bf16 v[108:111], v[212:215], v[36:39], v[108:111]
    v_mov_b32 v180, v84
    v_mov_b32 v181, v85
    s_waitcnt lgkmcnt(6)
    v_mfma_f32_16x16x32_bf16 v[112:115], v[184:187], v[40:43], v[112:115]
    s_waitcnt lgkmcnt(4)
    v_mfma_f32_16x16x32_bf16 v[112:115], v[192:195], v[44:47], v[112:115]
    s_waitcnt vmcnt(9) lgkmcnt(0)
    s_barrier
    v_add_u32 v18, 0x4000, v18
    v_add_u32 v19, 0x4000, v19
    v_add_u32 v20, 0x4000, v20
    v_xor_b32 v5, 0x10000, v5
    v_xor_b32 v6, 0x10000, v6
    v_xor_b32 v7, 0x10000, v7
    v_xor_b32 v8, 0x10000, v8
    v_xor_b32 v15, 0x10000, v15
    v_xor_b32 v16, 0x10000, v16
    v_xor_b32 v11, 0x10000, v11
    v_xor_b32 v12, 0x10000, v12
    v_xor_b32 v18, 0x10000, v18
    v_xor_b32 v19, 0x10000, v19
    v_xor_b32 v20, 0x10000, v20
    ds_read_b64_tr_b16 v[24:25], v18 offset:0
    ds_read_b64_tr_b16 v[26:27], v18 offset:512
    ds_read_b64_tr_b16 v[28:29], v18 offset:4096
    ds_read_b64_tr_b16 v[30:31], v18 offset:4608
    ds_read_b64_tr_b16 v[32:33], v18 offset:8192
    ds_read_b64_tr_b16 v[34:35], v18 offset:8704
    ds_read_b64_tr_b16 v[36:37], v18 offset:12288
    ds_read_b64_tr_b16 v[38:39], v18 offset:12800
    v_mov_b32 v182, v86
    v_cvt_pk_bf16_f32 v248, v88, v89
    v_cvt_pk_bf16_f32 v249, v90, v91
    v_cvt_pk_bf16_f32 v250, v92, v93
    v_cvt_pk_bf16_f32 v251, v94, v95
    v_cvt_pk_bf16_f32 v252, v96, v97
    v_cvt_pk_bf16_f32 v253, v98, v99
    v_cvt_pk_bf16_f32 v254, v100, v101
    v_cvt_pk_bf16_f32 v255, v102, v103
    v_mfma_f32_16x16x32_bf16 v[116:119], v[188:191], v[40:43], v[116:119]
    ds_read_b64_tr_b16 v[40:41], v19 offset:0
    v_mfma_f32_16x16x32_bf16 v[116:119], v[196:199], v[44:47], v[116:119]
    ds_read_b64_tr_b16 v[42:43], v19 offset:512
    s_add_u32 m0, s6, 0
    s_mov_b32 s32, 1048576
    buffer_load_dwordx4 v4, s[8:11], s32 offen lds
    v_mov_b32 v183, v87
    v_mfma_f32_16x16x32_bf16 v[112:115], v[200:203], v[48:51], v[112:115]
    ds_read_b64_tr_b16 v[44:45], v19 offset:4096
    v_mfma_f32_16x16x32_bf16 v[112:115], v[208:211], v[52:55], v[112:115]
    ds_read_b64_tr_b16 v[46:47], v19 offset:4608
    v_mfma_f32_16x16x32_bf16 v[116:119], v[204:207], v[48:51], v[116:119]
    ds_read_b64_tr_b16 v[48:49], v19 offset:8192
    v_mfma_f32_16x16x32_bf16 v[116:119], v[212:215], v[52:55], v[116:119]
    ds_read_b64_tr_b16 v[50:51], v19 offset:8704
    s_waitcnt lgkmcnt(12)
    v_mfma_f32_16x16x32_bf16 v[184:187], v[24:27], v[120:123], 0
    ds_read_b64_tr_b16 v[52:53], v19 offset:12288
    s_waitcnt lgkmcnt(11)
    v_mfma_f32_16x16x32_bf16 v[184:187], v[28:31], v[128:131], v[184:187]
    ds_read_b64_tr_b16 v[54:55], v19 offset:12800
    v_mfma_f32_16x16x32_bf16 v[188:191], v[24:27], v[124:127], 0
    ds_read_b64_tr_b16 v[24:25], v20 offset:0
    v_mfma_f32_16x16x32_bf16 v[188:191], v[28:31], v[132:135], v[188:191]
    ds_read_b64_tr_b16 v[26:27], v20 offset:512
    s_waitcnt lgkmcnt(12)
    v_mfma_f32_16x16x32_bf16 v[192:195], v[32:35], v[120:123], 0
    ds_read_b64_tr_b16 v[28:29], v20 offset:4096
    s_waitcnt lgkmcnt(11)
    v_mfma_f32_16x16x32_bf16 v[192:195], v[36:39], v[128:131], v[192:195]
    ds_read_b64_tr_b16 v[30:31], v20 offset:4608
    s_add_u32 s32, s39, 8192
    buffer_load_dwordx4 v[152:155], v0, s[20:23], s32 offen offset:0 sc1
    v_mfma_f32_16x16x32_bf16 v[196:199], v[32:35], v[124:127], 0
    ds_read_b64_tr_b16 v[32:33], v20 offset:8192
    v_mfma_f32_16x16x32_bf16 v[196:199], v[36:39], v[132:135], v[196:199]
    ds_read_b64_tr_b16 v[34:35], v20 offset:8704
    s_add_u32 m0, s6, 1024
    s_mov_b32 s32, 1081344
    buffer_load_dwordx4 v4, s[8:11], s32 offen lds
    s_waitcnt lgkmcnt(12)
    v_mfma_f32_16x16x32_bf16 v[200:203], v[40:43], v[120:123], 0
    ds_read_b64_tr_b16 v[36:37], v20 offset:12288
    s_waitcnt lgkmcnt(11)
    v_mfma_f32_16x16x32_bf16 v[200:203], v[44:47], v[128:131], v[200:203]
    ds_read_b64_tr_b16 v[38:39], v20 offset:12800
    v_cvt_pk_bf16_f32 v104, v104, v105
    v_cvt_pk_bf16_f32 v105, v106, v107
    v_cvt_pk_bf16_f32 v106, v108, v109
    v_cvt_pk_bf16_f32 v107, v110, v111
    v_cvt_pk_bf16_f32 v108, v112, v113
    v_cvt_pk_bf16_f32 v109, v114, v115
    v_cvt_pk_bf16_f32 v110, v116, v117
    v_cvt_pk_bf16_f32 v111, v118, v119
    v_mfma_f32_16x16x32_bf16 v[204:207], v[40:43], v[124:127], 0
    ds_read_b64_tr_b16 v[40:41], v5 offset:0
    v_mfma_f32_16x16x32_bf16 v[204:207], v[44:47], v[132:135], v[204:207]
    ds_read_b64_tr_b16 v[42:43], v5 offset:1024
    s_waitcnt lgkmcnt(12)
    v_mfma_f32_16x16x32_bf16 v[208:211], v[48:51], v[120:123], 0
    ds_read_b64_tr_b16 v[44:45], v5 offset:8192
    s_waitcnt lgkmcnt(11)
    v_mfma_f32_16x16x32_bf16 v[208:211], v[52:55], v[128:131], v[208:211]
    ds_read_b64_tr_b16 v[46:47], v5 offset:9216
    v_mfma_f32_16x16x32_bf16 v[212:215], v[48:51], v[124:127], 0
    ds_read_b64_tr_b16 v[48:49], v15 offset:0
    v_mfma_f32_16x16x32_bf16 v[212:215], v[52:55], v[132:135], v[212:215]
    ds_read_b64_tr_b16 v[50:51], v15 offset:1024
    s_add_u32 s32, s34, 47104
    buffer_store_dwordx4 v[104:107], v0, s[20:23], s32 offen sc1
    s_waitcnt lgkmcnt(12)
    v_mfma_f32_16x16x32_bf16 v[216:219], v[24:27], v[120:123], 0
    ds_read_b64_tr_b16 v[52:53], v15 offset:8192
    s_waitcnt lgkmcnt(11)
    v_mfma_f32_16x16x32_bf16 v[216:219], v[28:31], v[128:131], v[216:219]
    ds_read_b64_tr_b16 v[54:55], v15 offset:9216
    s_add_u32 s32, s39, 8192
    buffer_load_dwordx4 v[156:159], v0, s[20:23], s32 offen offset:1024 sc1
    v_mfma_f32_16x16x32_bf16 v[220:223], v[24:27], v[124:127], 0
    ds_read_b64_tr_b16 v[24:25], v6 offset:0
    v_mfma_f32_16x16x32_bf16 v[220:223], v[28:31], v[132:135], v[220:223]
    ds_read_b64_tr_b16 v[26:27], v6 offset:1024
    s_add_u32 m0, s56, 0
    s_mov_b32 s32, 352256
    buffer_load_dwordx4 v9, s[12:15], s32 offen lds
    s_waitcnt lgkmcnt(12)
    v_mfma_f32_16x16x32_bf16 v[224:227], v[32:35], v[120:123], 0
    ds_read_b64_tr_b16 v[28:29], v6 offset:8192
    s_waitcnt lgkmcnt(11)
    v_mfma_f32_16x16x32_bf16 v[224:227], v[36:39], v[128:131], v[224:227]
    ds_read_b64_tr_b16 v[30:31], v6 offset:9216
    v_mfma_f32_16x16x32_bf16 v[228:231], v[32:35], v[124:127], 0
    ds_read_b64_tr_b16 v[32:33], v16 offset:0
    v_mfma_f32_16x16x32_bf16 v[228:231], v[36:39], v[132:135], v[228:231]
    ds_read_b64_tr_b16 v[34:35], v16 offset:1024
    s_waitcnt lgkmcnt(12)
    v_mfma_f32_16x16x32_bf16 v[56:59], v[40:43], v[120:123], 0
    ds_read_b64_tr_b16 v[36:37], v16 offset:8192
    s_waitcnt lgkmcnt(11)
    v_mfma_f32_16x16x32_bf16 v[56:59], v[44:47], v[128:131], v[56:59]
    ds_read_b64_tr_b16 v[38:39], v16 offset:9216
    v_mfma_f32_16x16x32_bf16 v[64:67], v[40:43], v[124:127], 0
    ds_read_b64_tr_b16 v[40:41], v7 offset:0
    v_mfma_f32_16x16x32_bf16 v[64:67], v[44:47], v[132:135], v[64:67]
    ds_read_b64_tr_b16 v[42:43], v7 offset:1024
    s_waitcnt lgkmcnt(12)
    v_mfma_f32_16x16x32_bf16 v[60:63], v[48:51], v[120:123], 0
    ds_read_b64_tr_b16 v[44:45], v7 offset:8192
    s_waitcnt lgkmcnt(11)
    v_mfma_f32_16x16x32_bf16 v[60:63], v[52:55], v[128:131], v[60:63]
    ds_read_b64_tr_b16 v[46:47], v7 offset:9216
    s_add_u32 s32, s39, 8192
    buffer_load_dwordx4 v[160:163], v0, s[20:23], s32 offen offset:2048 sc1
    s_add_u32 s32, s34, 48128
    buffer_store_dwordx4 v[108:111], v0, s[20:23], s32 offen sc1
    v_mfma_f32_16x16x32_bf16 v[68:71], v[48:51], v[124:127], 0
    ds_read_b64_tr_b16 v[48:49], v11 offset:0
    v_mfma_f32_16x16x32_bf16 v[68:71], v[52:55], v[132:135], v[68:71]
    ds_read_b64_tr_b16 v[50:51], v11 offset:1024
    s_add_u32 m0, s56, 8192
    s_mov_b32 s32, 352256
    buffer_load_dwordx4 v9, s[24:27], s32 offen lds
    s_waitcnt lgkmcnt(12)
    v_mfma_f32_16x16x32_bf16 v[72:75], v[24:27], v[120:123], 0
    ds_read_b64_tr_b16 v[52:53], v11 offset:8192
    s_waitcnt lgkmcnt(11)
    v_mfma_f32_16x16x32_bf16 v[72:75], v[28:31], v[128:131], v[72:75]
    ds_read_b64_tr_b16 v[54:55], v11 offset:9216
    v_mfma_f32_16x16x32_bf16 v[80:83], v[24:27], v[124:127], 0
    ds_read_b64_tr_b16 v[24:25], v8 offset:0
    v_mfma_f32_16x16x32_bf16 v[80:83], v[28:31], v[132:135], v[80:83]
    ds_read_b64_tr_b16 v[26:27], v8 offset:1024
    s_waitcnt lgkmcnt(12)
    v_mfma_f32_16x16x32_bf16 v[76:79], v[32:35], v[120:123], 0
    ds_read_b64_tr_b16 v[28:29], v8 offset:8192
    s_waitcnt lgkmcnt(11)
    v_mfma_f32_16x16x32_bf16 v[76:79], v[36:39], v[128:131], v[76:79]
    ds_read_b64_tr_b16 v[30:31], v8 offset:9216
    v_mfma_f32_16x16x32_bf16 v[84:87], v[32:35], v[124:127], 0
    ds_read_b64_tr_b16 v[32:33], v12 offset:0
    v_mfma_f32_16x16x32_bf16 v[84:87], v[36:39], v[132:135], v[84:87]
    ds_read_b64_tr_b16 v[34:35], v12 offset:1024
    s_waitcnt lgkmcnt(12)
    v_mfma_f32_16x16x32_bf16 v[88:91], v[40:43], v[120:123], 0
    ds_read_b64_tr_b16 v[36:37], v12 offset:8192
    s_waitcnt lgkmcnt(11)
    v_mfma_f32_16x16x32_bf16 v[88:91], v[44:47], v[128:131], v[88:91]
    ds_read_b64_tr_b16 v[38:39], v12 offset:9216
    s_add_u32 s32, s39, 8192
    buffer_load_dwordx4 v[164:167], v0, s[20:23], s32 offen offset:3072 sc1
    v_mfma_f32_16x16x32_bf16 v[96:99], v[40:43], v[124:127], 0
    v_mfma_f32_16x16x32_bf16 v[96:99], v[44:47], v[132:135], v[96:99]
    s_waitcnt lgkmcnt(10)
    v_mfma_f32_16x16x32_bf16 v[92:95], v[48:51], v[120:123], 0
    s_waitcnt lgkmcnt(8)
    v_mfma_f32_16x16x32_bf16 v[92:95], v[52:55], v[128:131], v[92:95]
    v_mfma_f32_16x16x32_bf16 v[100:103], v[48:51], v[124:127], 0
    v_mfma_f32_16x16x32_bf16 v[100:103], v[52:55], v[132:135], v[100:103]
    s_waitcnt lgkmcnt(6)
    v_mfma_f32_16x16x32_bf16 v[104:107], v[24:27], v[120:123], 0
    s_waitcnt lgkmcnt(4)
    v_mfma_f32_16x16x32_bf16 v[104:107], v[28:31], v[128:131], v[104:107]
    s_waitcnt vmcnt(10) lgkmcnt(0)
    s_barrier
    ds_read_b64_tr_b16 v[40:41], v18 offset:32768
    ds_read_b64_tr_b16 v[42:43], v18 offset:33280
    ds_read_b64_tr_b16 v[44:45], v18 offset:36864
    ds_read_b64_tr_b16 v[46:47], v18 offset:37376
    ds_read_b64_tr_b16 v[48:49], v18 offset:40960
    ds_read_b64_tr_b16 v[50:51], v18 offset:41472
    ds_read_b64_tr_b16 v[52:53], v18 offset:45056
    ds_read_b64_tr_b16 v[54:55], v18 offset:45568
    v_mfma_f32_16x16x32_bf16 v[112:115], v[24:27], v[124:127], 0
    ds_read_b64_tr_b16 v[24:25], v19 offset:32768
    v_mfma_f32_16x16x32_bf16 v[112:115], v[28:31], v[132:135], v[112:115]
    ds_read_b64_tr_b16 v[26:27], v19 offset:33280
    s_add_u32 m0, s6, 32768
    s_mov_b32 s32, 1572864
    buffer_load_dwordx4 v4, s[8:11], s32 offen lds
    s_add_u32 s32, s34, 2048
    buffer_store_dwordx4 v[168:171], v0, s[20:23], s32 offen sc1
    v_mfma_f32_16x16x32_bf16 v[108:111], v[32:35], v[120:123], 0
    ds_read_b64_tr_b16 v[28:29], v19 offset:36864
    v_mfma_f32_16x16x32_bf16 v[108:111], v[36:39], v[128:131], v[108:111]
    ds_read_b64_tr_b16 v[30:31], v19 offset:37376
    v_mfma_f32_16x16x32_bf16 v[116:119], v[32:35], v[124:127], 0
    ds_read_b64_tr_b16 v[32:33], v19 offset:40960
    v_mfma_f32_16x16x32_bf16 v[116:119], v[36:39], v[132:135], v[116:119]
    ds_read_b64_tr_b16 v[34:35], v19 offset:41472
    s_waitcnt lgkmcnt(12)
    v_mfma_f32_16x16x32_bf16 v[184:187], v[40:43], v[136:139], v[184:187]
    ds_read_b64_tr_b16 v[36:37], v19 offset:45056
    s_waitcnt lgkmcnt(11)
    v_mfma_f32_16x16x32_bf16 v[184:187], v[44:47], v[144:147], v[184:187]
    ds_read_b64_tr_b16 v[38:39], v19 offset:45568
    v_mfma_f32_16x16x32_bf16 v[188:191], v[40:43], v[140:143], v[188:191]
    ds_read_b64_tr_b16 v[40:41], v20 offset:32768
    v_mfma_f32_16x16x32_bf16 v[188:191], v[44:47], v[148:151], v[188:191]
    ds_read_b64_tr_b16 v[42:43], v20 offset:33280
    s_waitcnt lgkmcnt(12)
    v_mfma_f32_16x16x32_bf16 v[192:195], v[48:51], v[136:139], v[192:195]
    ds_read_b64_tr_b16 v[44:45], v20 offset:36864
    s_waitcnt lgkmcnt(11)
    v_mfma_f32_16x16x32_bf16 v[192:195], v[52:55], v[144:147], v[192:195]
    ds_read_b64_tr_b16 v[46:47], v20 offset:37376
    s_add_u32 s32, s39, 12288
    buffer_load_dwordx4 v[120:123], v0, s[20:23], s32 offen offset:0 sc1
    v_mfma_f32_16x16x32_bf16 v[196:199], v[48:51], v[140:143], v[196:199]
    ds_read_b64_tr_b16 v[48:49], v20 offset:40960
    v_mfma_f32_16x16x32_bf16 v[196:199], v[52:55], v[148:151], v[196:199]
    ds_read_b64_tr_b16 v[50:51], v20 offset:41472
    s_add_u32 m0, s6, 33792
    s_mov_b32 s32, 1605632
    buffer_load_dwordx4 v4, s[8:11], s32 offen lds
    s_waitcnt lgkmcnt(12)
    v_mfma_f32_16x16x32_bf16 v[200:203], v[24:27], v[136:139], v[200:203]
    ds_read_b64_tr_b16 v[52:53], v20 offset:45056
    s_waitcnt lgkmcnt(11)
    v_mfma_f32_16x16x32_bf16 v[200:203], v[28:31], v[144:147], v[200:203]
    ds_read_b64_tr_b16 v[54:55], v20 offset:45568
    v_mfma_f32_16x16x32_bf16 v[204:207], v[24:27], v[140:143], v[204:207]
    ds_read_b64_tr_b16 v[24:25], v5 offset:32768
    v_mfma_f32_16x16x32_bf16 v[204:207], v[28:31], v[148:151], v[204:207]
    ds_read_b64_tr_b16 v[26:27], v5 offset:33792
    s_waitcnt lgkmcnt(12)
    v_mfma_f32_16x16x32_bf16 v[208:211], v[32:35], v[136:139], v[208:211]
    ds_read_b64_tr_b16 v[28:29], v5 offset:40960
    s_waitcnt lgkmcnt(11)
    v_mfma_f32_16x16x32_bf16 v[208:211], v[36:39], v[144:147], v[208:211]
    ds_read_b64_tr_b16 v[30:31], v5 offset:41984
    v_mfma_f32_16x16x32_bf16 v[212:215], v[32:35], v[140:143], v[212:215]
    ds_read_b64_tr_b16 v[32:33], v15 offset:32768
    v_mfma_f32_16x16x32_bf16 v[212:215], v[36:39], v[148:151], v[212:215]
    ds_read_b64_tr_b16 v[34:35], v15 offset:33792
    s_waitcnt lgkmcnt(12)
    v_mfma_f32_16x16x32_bf16 v[216:219], v[40:43], v[136:139], v[216:219]
    ds_read_b64_tr_b16 v[36:37], v15 offset:40960
    s_waitcnt lgkmcnt(11)
    v_mfma_f32_16x16x32_bf16 v[216:219], v[44:47], v[144:147], v[216:219]
    ds_read_b64_tr_b16 v[38:39], v15 offset:41984
    s_add_u32 s32, s39, 12288
    buffer_load_dwordx4 v[124:127], v0, s[20:23], s32 offen offset:1024 sc1
    v_mfma_f32_16x16x32_bf16 v[220:223], v[40:43], v[140:143], v[220:223]
    ds_read_b64_tr_b16 v[40:41], v6 offset:32768
    v_mfma_f32_16x16x32_bf16 v[220:223], v[44:47], v[148:151], v[220:223]
    ds_read_b64_tr_b16 v[42:43], v6 offset:33792
    s_add_u32 m0, s56, 32768
    s_mov_b32 s32, 528384
    buffer_load_dwordx4 v9, s[12:15], s32 offen lds
    s_waitcnt lgkmcnt(12)
    v_mfma_f32_16x16x32_bf16 v[224:227], v[48:51], v[136:139], v[224:227]
    ds_read_b64_tr_b16 v[44:45], v6 offset:40960
    s_waitcnt lgkmcnt(11)
    v_mfma_f32_16x16x32_bf16 v[224:227], v[52:55], v[144:147], v[224:227]
    ds_read_b64_tr_b16 v[46:47], v6 offset:41984
    s_add_u32 s32, s34, 6144
    buffer_store_dwordx4 v[172:175], v0, s[20:23], s32 offen sc1
    v_mfma_f32_16x16x32_bf16 v[228:231], v[48:51], v[140:143], v[228:231]
    ds_read_b64_tr_b16 v[48:49], v16 offset:32768
    v_mfma_f32_16x16x32_bf16 v[228:231], v[52:55], v[148:151], v[228:231]
    ds_read_b64_tr_b16 v[50:51], v16 offset:33792
    s_waitcnt lgkmcnt(12)
    v_mfma_f32_16x16x32_bf16 v[56:59], v[24:27], v[136:139], v[56:59]
    ds_read_b64_tr_b16 v[52:53], v16 offset:40960
    s_waitcnt lgkmcnt(11)
    v_mfma_f32_16x16x32_bf16 v[56:59], v[28:31], v[144:147], v[56:59]
    ds_read_b64_tr_b16 v[54:55], v16 offset:41984
    v_mfma_f32_16x16x32_bf16 v[64:67], v[24:27], v[140:143], v[64:67]
    ds_read_b64_tr_b16 v[24:25], v7 offset:32768
    v_mfma_f32_16x16x32_bf16 v[64:67], v[28:31], v[148:151], v[64:67]
    ds_read_b64_tr_b16 v[26:27], v7 offset:33792
    s_waitcnt lgkmcnt(12)
    v_mfma_f32_16x16x32_bf16 v[60:63], v[32:35], v[136:139], v[60:63]
    ds_read_b64_tr_b16 v[28:29], v7 offset:40960
    s_waitcnt lgkmcnt(11)
    v_mfma_f32_16x16x32_bf16 v[60:63], v[36:39], v[144:147], v[60:63]
    ds_read_b64_tr_b16 v[30:31], v7 offset:41984
    s_add_u32 s32, s39, 12288
    buffer_load_dwordx4 v[128:131], v0, s[20:23], s32 offen offset:2048 sc1
    v_mfma_f32_16x16x32_bf16 v[68:71], v[32:35], v[140:143], v[68:71]
    ds_read_b64_tr_b16 v[32:33], v11 offset:32768
    v_mfma_f32_16x16x32_bf16 v[68:71], v[36:39], v[148:151], v[68:71]
    ds_read_b64_tr_b16 v[34:35], v11 offset:33792
    s_add_u32 m0, s56, 40960
    s_mov_b32 s32, 528384
    buffer_load_dwordx4 v9, s[24:27], s32 offen lds
    s_waitcnt lgkmcnt(12)
    v_mfma_f32_16x16x32_bf16 v[72:75], v[40:43], v[136:139], v[72:75]
    ds_read_b64_tr_b16 v[36:37], v11 offset:40960
    s_waitcnt lgkmcnt(11)
    v_mfma_f32_16x16x32_bf16 v[72:75], v[44:47], v[144:147], v[72:75]
    ds_read_b64_tr_b16 v[38:39], v11 offset:41984
    v_mfma_f32_16x16x32_bf16 v[80:83], v[40:43], v[140:143], v[80:83]
    ds_read_b64_tr_b16 v[40:41], v8 offset:32768
    v_mfma_f32_16x16x32_bf16 v[80:83], v[44:47], v[148:151], v[80:83]
    ds_read_b64_tr_b16 v[42:43], v8 offset:33792
    s_waitcnt lgkmcnt(12)
    v_mfma_f32_16x16x32_bf16 v[76:79], v[48:51], v[136:139], v[76:79]
    ds_read_b64_tr_b16 v[44:45], v8 offset:40960
    s_waitcnt lgkmcnt(11)
    v_mfma_f32_16x16x32_bf16 v[76:79], v[52:55], v[144:147], v[76:79]
    ds_read_b64_tr_b16 v[46:47], v8 offset:41984
    v_mfma_f32_16x16x32_bf16 v[84:87], v[48:51], v[140:143], v[84:87]
    ds_read_b64_tr_b16 v[48:49], v12 offset:32768
    v_mfma_f32_16x16x32_bf16 v[84:87], v[52:55], v[148:151], v[84:87]
    ds_read_b64_tr_b16 v[50:51], v12 offset:33792
    s_waitcnt lgkmcnt(12)
    v_mfma_f32_16x16x32_bf16 v[88:91], v[24:27], v[136:139], v[88:91]
    ds_read_b64_tr_b16 v[52:53], v12 offset:40960
    s_waitcnt lgkmcnt(11)
    v_mfma_f32_16x16x32_bf16 v[88:91], v[28:31], v[144:147], v[88:91]
    ds_read_b64_tr_b16 v[54:55], v12 offset:41984
    s_add_u32 s32, s39, 12288
    buffer_load_dwordx4 v[132:135], v0, s[20:23], s32 offen offset:3072 sc1
    v_mfma_f32_16x16x32_bf16 v[96:99], v[24:27], v[140:143], v[96:99]
    v_mfma_f32_16x16x32_bf16 v[96:99], v[28:31], v[148:151], v[96:99]
    s_waitcnt lgkmcnt(10)
    v_mfma_f32_16x16x32_bf16 v[92:95], v[32:35], v[136:139], v[92:95]
    s_waitcnt lgkmcnt(8)
    v_mfma_f32_16x16x32_bf16 v[92:95], v[36:39], v[144:147], v[92:95]
    v_mfma_f32_16x16x32_bf16 v[100:103], v[32:35], v[140:143], v[100:103]
    v_mfma_f32_16x16x32_bf16 v[100:103], v[36:39], v[148:151], v[100:103]
    s_waitcnt lgkmcnt(6)
    v_mfma_f32_16x16x32_bf16 v[104:107], v[40:43], v[136:139], v[104:107]
    s_waitcnt lgkmcnt(4)
    v_mfma_f32_16x16x32_bf16 v[104:107], v[44:47], v[144:147], v[104:107]
    s_waitcnt vmcnt(11) lgkmcnt(0)
    s_barrier
    v_xor_b32 v5, 0x10000, v5
    v_xor_b32 v6, 0x10000, v6
    v_xor_b32 v7, 0x10000, v7
    v_xor_b32 v8, 0x10000, v8
    v_xor_b32 v15, 0x10000, v15
    v_xor_b32 v16, 0x10000, v16
    v_xor_b32 v11, 0x10000, v11
    v_xor_b32 v12, 0x10000, v12
    v_xor_b32 v18, 0x10000, v18
    v_xor_b32 v19, 0x10000, v19
    v_xor_b32 v20, 0x10000, v20
    ds_read_b64_tr_b16 v[24:25], v18 offset:0
    ds_read_b64_tr_b16 v[26:27], v18 offset:512
    ds_read_b64_tr_b16 v[28:29], v18 offset:4096
    ds_read_b64_tr_b16 v[30:31], v18 offset:4608
    ds_read_b64_tr_b16 v[32:33], v18 offset:8192
    ds_read_b64_tr_b16 v[34:35], v18 offset:8704
    ds_read_b64_tr_b16 v[36:37], v18 offset:12288
    ds_read_b64_tr_b16 v[38:39], v18 offset:12800
    s_add_u32 s32, s34, 3072
    buffer_store_dwordx4 v[176:179], v0, s[20:23], s32 offen sc1
    v_mfma_f32_16x16x32_bf16 v[112:115], v[40:43], v[140:143], v[112:115]
    ds_read_b64_tr_b16 v[40:41], v19 offset:0
    v_mfma_f32_16x16x32_bf16 v[112:115], v[44:47], v[148:151], v[112:115]
    ds_read_b64_tr_b16 v[42:43], v19 offset:512
    s_add_u32 m0, s6, 65536
    s_mov_b32 s32, 2097152
    buffer_load_dwordx4 v4, s[8:11], s32 offen lds
    v_mfma_f32_16x16x32_bf16 v[108:111], v[48:51], v[136:139], v[108:111]
    ds_read_b64_tr_b16 v[44:45], v19 offset:4096
    v_mfma_f32_16x16x32_bf16 v[108:111], v[52:55], v[144:147], v[108:111]
    ds_read_b64_tr_b16 v[46:47], v19 offset:4608
    v_mfma_f32_16x16x32_bf16 v[116:119], v[48:51], v[140:143], v[116:119]
    ds_read_b64_tr_b16 v[48:49], v19 offset:8192
    v_mfma_f32_16x16x32_bf16 v[116:119], v[52:55], v[148:151], v[116:119]
    ds_read_b64_tr_b16 v[50:51], v19 offset:8704
    s_waitcnt lgkmcnt(12)
    v_mfma_f32_16x16x32_bf16 v[184:187], v[24:27], v[152:155], v[184:187]
    ds_read_b64_tr_b16 v[52:53], v19 offset:12288
    s_waitcnt lgkmcnt(11)
    v_mfma_f32_16x16x32_bf16 v[184:187], v[28:31], v[160:163], v[184:187]
    ds_read_b64_tr_b16 v[54:55], v19 offset:12800
    v_mfma_f32_16x16x32_bf16 v[188:191], v[24:27], v[156:159], v[188:191]
    ds_read_b64_tr_b16 v[24:25], v20 offset:0
    s_waitcnt vmcnt(12)
    v_mfma_f32_16x16x32_bf16 v[188:191], v[28:31], v[164:167], v[188:191]
    ds_read_b64_tr_b16 v[26:27], v20 offset:512
    s_waitcnt lgkmcnt(12)
    v_mfma_f32_16x16x32_bf16 v[192:195], v[32:35], v[152:155], v[192:195]
    ds_read_b64_tr_b16 v[28:29], v20 offset:4096
    s_waitcnt lgkmcnt(11)
    v_mfma_f32_16x16x32_bf16 v[192:195], v[36:39], v[160:163], v[192:195]
    ds_read_b64_tr_b16 v[30:31], v20 offset:4608
    s_add_u32 s32, s39, 16384
    buffer_load_dwordx4 v[136:139], v0, s[20:23], s32 offen offset:0 sc1
    v_mfma_f32_16x16x32_bf16 v[196:199], v[32:35], v[156:159], v[196:199]
    ds_read_b64_tr_b16 v[32:33], v20 offset:8192
    v_mfma_f32_16x16x32_bf16 v[196:199], v[36:39], v[164:167], v[196:199]
    ds_read_b64_tr_b16 v[34:35], v20 offset:8704
    s_add_u32 m0, s6, 66560
    s_mov_b32 s32, 2129920
    buffer_load_dwordx4 v4, s[8:11], s32 offen lds
    s_waitcnt lgkmcnt(12)
    v_mfma_f32_16x16x32_bf16 v[200:203], v[40:43], v[152:155], v[200:203]
    ds_read_b64_tr_b16 v[36:37], v20 offset:12288
    s_waitcnt lgkmcnt(11)
    v_mfma_f32_16x16x32_bf16 v[200:203], v[44:47], v[160:163], v[200:203]
    ds_read_b64_tr_b16 v[38:39], v20 offset:12800
    v_mfma_f32_16x16x32_bf16 v[204:207], v[40:43], v[156:159], v[204:207]
    ds_read_b64_tr_b16 v[40:41], v5 offset:0
    v_mfma_f32_16x16x32_bf16 v[204:207], v[44:47], v[164:167], v[204:207]
    ds_read_b64_tr_b16 v[42:43], v5 offset:1024
    s_waitcnt lgkmcnt(12)
    v_mfma_f32_16x16x32_bf16 v[208:211], v[48:51], v[152:155], v[208:211]
    ds_read_b64_tr_b16 v[44:45], v5 offset:8192
    s_waitcnt lgkmcnt(11)
    v_mfma_f32_16x16x32_bf16 v[208:211], v[52:55], v[160:163], v[208:211]
    ds_read_b64_tr_b16 v[46:47], v5 offset:9216
    v_mfma_f32_16x16x32_bf16 v[212:215], v[48:51], v[156:159], v[212:215]
    ds_read_b64_tr_b16 v[48:49], v15 offset:0
    v_mfma_f32_16x16x32_bf16 v[212:215], v[52:55], v[164:167], v[212:215]
    ds_read_b64_tr_b16 v[50:51], v15 offset:1024
    s_waitcnt lgkmcnt(12)
    v_mfma_f32_16x16x32_bf16 v[216:219], v[24:27], v[152:155], v[216:219]
    ds_read_b64_tr_b16 v[52:53], v15 offset:8192
    s_waitcnt lgkmcnt(11)
    v_mfma_f32_16x16x32_bf16 v[216:219], v[28:31], v[160:163], v[216:219]
    ds_read_b64_tr_b16 v[54:55], v15 offset:9216
    s_add_u32 s32, s39, 16384
    buffer_load_dwordx4 v[140:143], v0, s[20:23], s32 offen offset:1024 sc1
    v_mfma_f32_16x16x32_bf16 v[220:223], v[24:27], v[156:159], v[220:223]
    ds_read_b64_tr_b16 v[24:25], v6 offset:0
    v_mfma_f32_16x16x32_bf16 v[220:223], v[28:31], v[164:167], v[220:223]
    ds_read_b64_tr_b16 v[26:27], v6 offset:1024
    s_add_u32 m0, s56, 65536
    s_mov_b32 s32, 704512
    buffer_load_dwordx4 v9, s[12:15], s32 offen lds
    s_waitcnt lgkmcnt(12)
    v_mfma_f32_16x16x32_bf16 v[224:227], v[32:35], v[152:155], v[224:227]
    ds_read_b64_tr_b16 v[28:29], v6 offset:8192
    s_waitcnt lgkmcnt(11)
    v_mfma_f32_16x16x32_bf16 v[224:227], v[36:39], v[160:163], v[224:227]
    ds_read_b64_tr_b16 v[30:31], v6 offset:9216
    s_add_u32 s32, s34, 7168
    buffer_store_dwordx4 v[180:183], v0, s[20:23], s32 offen sc1
    v_mfma_f32_16x16x32_bf16 v[228:231], v[32:35], v[156:159], v[228:231]
    ds_read_b64_tr_b16 v[32:33], v16 offset:0
    v_mfma_f32_16x16x32_bf16 v[228:231], v[36:39], v[164:167], v[228:231]
    ds_read_b64_tr_b16 v[34:35], v16 offset:1024
    s_waitcnt lgkmcnt(12)
    v_mfma_f32_16x16x32_bf16 v[56:59], v[40:43], v[152:155], v[56:59]
    ds_read_b64_tr_b16 v[36:37], v16 offset:8192
    s_waitcnt lgkmcnt(11)
    v_mfma_f32_16x16x32_bf16 v[56:59], v[44:47], v[160:163], v[56:59]
    ds_read_b64_tr_b16 v[38:39], v16 offset:9216
    v_mfma_f32_16x16x32_bf16 v[64:67], v[40:43], v[156:159], v[64:67]
    ds_read_b64_tr_b16 v[40:41], v7 offset:0
    v_mfma_f32_16x16x32_bf16 v[64:67], v[44:47], v[164:167], v[64:67]
    ds_read_b64_tr_b16 v[42:43], v7 offset:1024
    s_waitcnt lgkmcnt(12)
    v_mfma_f32_16x16x32_bf16 v[60:63], v[48:51], v[152:155], v[60:63]
    ds_read_b64_tr_b16 v[44:45], v7 offset:8192
    s_waitcnt lgkmcnt(11)
    v_mfma_f32_16x16x32_bf16 v[60:63], v[52:55], v[160:163], v[60:63]
    ds_read_b64_tr_b16 v[46:47], v7 offset:9216
    s_add_u32 s32, s39, 16384
    buffer_load_dwordx4 v[144:147], v0, s[20:23], s32 offen offset:2048 sc1
    v_mfma_f32_16x16x32_bf16 v[68:71], v[48:51], v[156:159], v[68:71]
    ds_read_b64_tr_b16 v[48:49], v11 offset:0
    v_mfma_f32_16x16x32_bf16 v[68:71], v[52:55], v[164:167], v[68:71]
    ds_read_b64_tr_b16 v[50:51], v11 offset:1024
    s_add_u32 m0, s56, 73728
    s_mov_b32 s32, 704512
    buffer_load_dwordx4 v9, s[24:27], s32 offen lds
    s_waitcnt lgkmcnt(12)
    v_mfma_f32_16x16x32_bf16 v[72:75], v[24:27], v[152:155], v[72:75]
    ds_read_b64_tr_b16 v[52:53], v11 offset:8192
    s_waitcnt lgkmcnt(11)
    v_mfma_f32_16x16x32_bf16 v[72:75], v[28:31], v[160:163], v[72:75]
    ds_read_b64_tr_b16 v[54:55], v11 offset:9216
    v_mfma_f32_16x16x32_bf16 v[80:83], v[24:27], v[156:159], v[80:83]
    ds_read_b64_tr_b16 v[24:25], v8 offset:0
    v_mfma_f32_16x16x32_bf16 v[80:83], v[28:31], v[164:167], v[80:83]
    ds_read_b64_tr_b16 v[26:27], v8 offset:1024
    s_waitcnt lgkmcnt(12)
    v_mfma_f32_16x16x32_bf16 v[76:79], v[32:35], v[152:155], v[76:79]
    ds_read_b64_tr_b16 v[28:29], v8 offset:8192
    s_waitcnt lgkmcnt(11)
    v_mfma_f32_16x16x32_bf16 v[76:79], v[36:39], v[160:163], v[76:79]
    ds_read_b64_tr_b16 v[30:31], v8 offset:9216
    v_mfma_f32_16x16x32_bf16 v[84:87], v[32:35], v[156:159], v[84:87]
    ds_read_b64_tr_b16 v[32:33], v12 offset:0
    v_mfma_f32_16x16x32_bf16 v[84:87], v[36:39], v[164:167], v[84:87]
    ds_read_b64_tr_b16 v[34:35], v12 offset:1024
    s_waitcnt lgkmcnt(12)
    v_mfma_f32_16x16x32_bf16 v[88:91], v[40:43], v[152:155], v[88:91]
    ds_read_b64_tr_b16 v[36:37], v12 offset:8192
    s_waitcnt lgkmcnt(11)
    v_mfma_f32_16x16x32_bf16 v[88:91], v[44:47], v[160:163], v[88:91]
    ds_read_b64_tr_b16 v[38:39], v12 offset:9216
    s_add_u32 s32, s39, 16384
    buffer_load_dwordx4 v[148:151], v0, s[20:23], s32 offen offset:3072 sc1
    v_mfma_f32_16x16x32_bf16 v[96:99], v[40:43], v[156:159], v[96:99]
    v_mfma_f32_16x16x32_bf16 v[96:99], v[44:47], v[164:167], v[96:99]
    s_waitcnt lgkmcnt(10)
    v_mfma_f32_16x16x32_bf16 v[92:95], v[48:51], v[152:155], v[92:95]
    s_waitcnt lgkmcnt(8)
    v_mfma_f32_16x16x32_bf16 v[92:95], v[52:55], v[160:163], v[92:95]
    v_mfma_f32_16x16x32_bf16 v[100:103], v[48:51], v[156:159], v[100:103]
    v_mfma_f32_16x16x32_bf16 v[100:103], v[52:55], v[164:167], v[100:103]
    s_waitcnt lgkmcnt(6)
    v_mfma_f32_16x16x32_bf16 v[104:107], v[24:27], v[152:155], v[104:107]
    s_waitcnt lgkmcnt(4)
    v_mfma_f32_16x16x32_bf16 v[104:107], v[28:31], v[160:163], v[104:107]
    s_waitcnt vmcnt(11) lgkmcnt(0)
    s_barrier
    ds_read_b64_tr_b16 v[40:41], v18 offset:32768
    ds_read_b64_tr_b16 v[42:43], v18 offset:33280
    ds_read_b64_tr_b16 v[44:45], v18 offset:36864
    ds_read_b64_tr_b16 v[46:47], v18 offset:37376
    ds_read_b64_tr_b16 v[48:49], v18 offset:40960
    ds_read_b64_tr_b16 v[50:51], v18 offset:41472
    ds_read_b64_tr_b16 v[52:53], v18 offset:45056
    ds_read_b64_tr_b16 v[54:55], v18 offset:45568
    s_add_u32 s32, s34, 40960
    buffer_store_dwordx4 v[240:243], v0, s[20:23], s32 offen sc1
    v_mfma_f32_16x16x32_bf16 v[112:115], v[24:27], v[156:159], v[112:115]
    ds_read_b64_tr_b16 v[24:25], v19 offset:32768
    v_mfma_f32_16x16x32_bf16 v[112:115], v[28:31], v[164:167], v[112:115]
    ds_read_b64_tr_b16 v[26:27], v19 offset:33280
    s_add_u32 m0, s6, 98304
    s_mov_b32 s32, 2621440
    buffer_load_dwordx4 v4, s[8:11], s32 offen lds
    v_mfma_f32_16x16x32_bf16 v[108:111], v[32:35], v[152:155], v[108:111]
    ds_read_b64_tr_b16 v[28:29], v19 offset:36864
    v_mfma_f32_16x16x32_bf16 v[108:111], v[36:39], v[160:163], v[108:111]
    ds_read_b64_tr_b16 v[30:31], v19 offset:37376
    v_mfma_f32_16x16x32_bf16 v[116:119], v[32:35], v[156:159], v[116:119]
    ds_read_b64_tr_b16 v[32:33], v19 offset:40960
    v_mfma_f32_16x16x32_bf16 v[116:119], v[36:39], v[164:167], v[116:119]
    ds_read_b64_tr_b16 v[34:35], v19 offset:41472
    s_waitcnt lgkmcnt(12)
    v_mfma_f32_16x16x32_bf16 v[184:187], v[40:43], v[120:123], v[184:187]
    ds_read_b64_tr_b16 v[36:37], v19 offset:45056
    s_waitcnt lgkmcnt(11)
    v_mfma_f32_16x16x32_bf16 v[184:187], v[44:47], v[128:131], v[184:187]
    ds_read_b64_tr_b16 v[38:39], v19 offset:45568
    v_mfma_f32_16x16x32_bf16 v[188:191], v[40:43], v[124:127], v[188:191]
    ds_read_b64_tr_b16 v[40:41], v20 offset:32768
    s_waitcnt vmcnt(12)
    v_mfma_f32_16x16x32_bf16 v[188:191], v[44:47], v[132:135], v[188:191]
    ds_read_b64_tr_b16 v[42:43], v20 offset:33280
    s_waitcnt lgkmcnt(12)
    v_mfma_f32_16x16x32_bf16 v[192:195], v[48:51], v[120:123], v[192:195]
    ds_read_b64_tr_b16 v[44:45], v20 offset:36864
    s_waitcnt lgkmcnt(11)
    v_mfma_f32_16x16x32_bf16 v[192:195], v[52:55], v[128:131], v[192:195]
    ds_read_b64_tr_b16 v[46:47], v20 offset:37376
    s_add_u32 s32, s39, 20480
    buffer_load_dwordx4 v[152:155], v0, s[20:23], s32 offen offset:0 sc1
    v_mfma_f32_16x16x32_bf16 v[196:199], v[48:51], v[124:127], v[196:199]
    ds_read_b64_tr_b16 v[48:49], v20 offset:40960
    v_mfma_f32_16x16x32_bf16 v[196:199], v[52:55], v[132:135], v[196:199]
    ds_read_b64_tr_b16 v[50:51], v20 offset:41472
    s_add_u32 m0, s6, 99328
    s_mov_b32 s32, 2654208
    buffer_load_dwordx4 v4, s[8:11], s32 offen lds
    s_waitcnt lgkmcnt(12)
    v_mfma_f32_16x16x32_bf16 v[200:203], v[24:27], v[120:123], v[200:203]
    ds_read_b64_tr_b16 v[52:53], v20 offset:45056
    s_waitcnt lgkmcnt(11)
    v_mfma_f32_16x16x32_bf16 v[200:203], v[28:31], v[128:131], v[200:203]
    ds_read_b64_tr_b16 v[54:55], v20 offset:45568
    v_mfma_f32_16x16x32_bf16 v[204:207], v[24:27], v[124:127], v[204:207]
    ds_read_b64_tr_b16 v[24:25], v5 offset:32768
    v_mfma_f32_16x16x32_bf16 v[204:207], v[28:31], v[132:135], v[204:207]
    ds_read_b64_tr_b16 v[26:27], v5 offset:33792
    s_waitcnt lgkmcnt(12)
    v_mfma_f32_16x16x32_bf16 v[208:211], v[32:35], v[120:123], v[208:211]
    ds_read_b64_tr_b16 v[28:29], v5 offset:40960
    s_waitcnt lgkmcnt(11)
    v_mfma_f32_16x16x32_bf16 v[208:211], v[36:39], v[128:131], v[208:211]
    ds_read_b64_tr_b16 v[30:31], v5 offset:41984
    v_mfma_f32_16x16x32_bf16 v[212:215], v[32:35], v[124:127], v[212:215]
    ds_read_b64_tr_b16 v[32:33], v15 offset:32768
    v_mfma_f32_16x16x32_bf16 v[212:215], v[36:39], v[132:135], v[212:215]
    ds_read_b64_tr_b16 v[34:35], v15 offset:33792
    s_waitcnt lgkmcnt(12)
    v_mfma_f32_16x16x32_bf16 v[216:219], v[40:43], v[120:123], v[216:219]
    ds_read_b64_tr_b16 v[36:37], v15 offset:40960
    s_waitcnt lgkmcnt(11)
    v_mfma_f32_16x16x32_bf16 v[216:219], v[44:47], v[128:131], v[216:219]
    ds_read_b64_tr_b16 v[38:39], v15 offset:41984
    s_add_u32 s32, s39, 20480
    buffer_load_dwordx4 v[156:159], v0, s[20:23], s32 offen offset:1024 sc1
    v_mfma_f32_16x16x32_bf16 v[220:223], v[40:43], v[124:127], v[220:223]
    ds_read_b64_tr_b16 v[40:41], v6 offset:32768
    v_mfma_f32_16x16x32_bf16 v[220:223], v[44:47], v[132:135], v[220:223]
    ds_read_b64_tr_b16 v[42:43], v6 offset:33792
    s_add_u32 m0, s56, 98304
    s_mov_b32 s32, 880640
    buffer_load_dwordx4 v9, s[12:15], s32 offen lds
    s_add_u32 s32, s34, 41984
    buffer_store_dwordx4 v[244:247], v0, s[20:23], s32 offen sc1
    s_waitcnt lgkmcnt(12)
    v_mfma_f32_16x16x32_bf16 v[224:227], v[48:51], v[120:123], v[224:227]
    ds_read_b64_tr_b16 v[44:45], v6 offset:40960
    s_waitcnt lgkmcnt(11)
    v_mfma_f32_16x16x32_bf16 v[224:227], v[52:55], v[128:131], v[224:227]
    ds_read_b64_tr_b16 v[46:47], v6 offset:41984
    v_mfma_f32_16x16x32_bf16 v[228:231], v[48:51], v[124:127], v[228:231]
    ds_read_b64_tr_b16 v[48:49], v16 offset:32768
    v_mfma_f32_16x16x32_bf16 v[228:231], v[52:55], v[132:135], v[228:231]
    ds_read_b64_tr_b16 v[50:51], v16 offset:33792
    s_waitcnt lgkmcnt(12)
    v_mfma_f32_16x16x32_bf16 v[56:59], v[24:27], v[120:123], v[56:59]
    ds_read_b64_tr_b16 v[52:53], v16 offset:40960
    s_waitcnt lgkmcnt(11)
    v_mfma_f32_16x16x32_bf16 v[56:59], v[28:31], v[128:131], v[56:59]
    ds_read_b64_tr_b16 v[54:55], v16 offset:41984
    v_mfma_f32_16x16x32_bf16 v[64:67], v[24:27], v[124:127], v[64:67]
    ds_read_b64_tr_b16 v[24:25], v7 offset:32768
    v_mfma_f32_16x16x32_bf16 v[64:67], v[28:31], v[132:135], v[64:67]
    ds_read_b64_tr_b16 v[26:27], v7 offset:33792
    s_waitcnt lgkmcnt(12)
    v_mfma_f32_16x16x32_bf16 v[60:63], v[32:35], v[120:123], v[60:63]
    ds_read_b64_tr_b16 v[28:29], v7 offset:40960
    s_waitcnt lgkmcnt(11)
    v_mfma_f32_16x16x32_bf16 v[60:63], v[36:39], v[128:131], v[60:63]
    ds_read_b64_tr_b16 v[30:31], v7 offset:41984
    s_add_u32 s32, s39, 20480
    buffer_load_dwordx4 v[160:163], v0, s[20:23], s32 offen offset:2048 sc1
    v_mfma_f32_16x16x32_bf16 v[68:71], v[32:35], v[124:127], v[68:71]
    ds_read_b64_tr_b16 v[32:33], v11 offset:32768
    v_mfma_f32_16x16x32_bf16 v[68:71], v[36:39], v[132:135], v[68:71]
    ds_read_b64_tr_b16 v[34:35], v11 offset:33792
    s_add_u32 m0, s56, 106496
    s_mov_b32 s32, 880640
    buffer_load_dwordx4 v9, s[24:27], s32 offen lds
    s_waitcnt lgkmcnt(12)
    v_mfma_f32_16x16x32_bf16 v[72:75], v[40:43], v[120:123], v[72:75]
    ds_read_b64_tr_b16 v[36:37], v11 offset:40960
    s_waitcnt lgkmcnt(11)
    v_mfma_f32_16x16x32_bf16 v[72:75], v[44:47], v[128:131], v[72:75]
    ds_read_b64_tr_b16 v[38:39], v11 offset:41984
    v_mfma_f32_16x16x32_bf16 v[80:83], v[40:43], v[124:127], v[80:83]
    ds_read_b64_tr_b16 v[40:41], v8 offset:32768
    v_mfma_f32_16x16x32_bf16 v[80:83], v[44:47], v[132:135], v[80:83]
    ds_read_b64_tr_b16 v[42:43], v8 offset:33792
    s_waitcnt lgkmcnt(12)
    v_mfma_f32_16x16x32_bf16 v[76:79], v[48:51], v[120:123], v[76:79]
    ds_read_b64_tr_b16 v[44:45], v8 offset:40960
    s_waitcnt lgkmcnt(11)
    v_mfma_f32_16x16x32_bf16 v[76:79], v[52:55], v[128:131], v[76:79]
    ds_read_b64_tr_b16 v[46:47], v8 offset:41984
    v_mfma_f32_16x16x32_bf16 v[84:87], v[48:51], v[124:127], v[84:87]
    ds_read_b64_tr_b16 v[48:49], v12 offset:32768
    v_mfma_f32_16x16x32_bf16 v[84:87], v[52:55], v[132:135], v[84:87]
    ds_read_b64_tr_b16 v[50:51], v12 offset:33792
    s_waitcnt lgkmcnt(12)
    v_mfma_f32_16x16x32_bf16 v[88:91], v[24:27], v[120:123], v[88:91]
    ds_read_b64_tr_b16 v[52:53], v12 offset:40960
    s_waitcnt lgkmcnt(11)
    v_mfma_f32_16x16x32_bf16 v[88:91], v[28:31], v[128:131], v[88:91]
    ds_read_b64_tr_b16 v[54:55], v12 offset:41984
    s_add_u32 s32, s39, 20480
    buffer_load_dwordx4 v[164:167], v0, s[20:23], s32 offen offset:3072 sc1
    v_mfma_f32_16x16x32_bf16 v[96:99], v[24:27], v[124:127], v[96:99]
    v_mfma_f32_16x16x32_bf16 v[96:99], v[28:31], v[132:135], v[96:99]
    s_waitcnt lgkmcnt(10)
    v_mfma_f32_16x16x32_bf16 v[92:95], v[32:35], v[120:123], v[92:95]
    s_waitcnt lgkmcnt(8)
    v_mfma_f32_16x16x32_bf16 v[92:95], v[36:39], v[128:131], v[92:95]
    v_mfma_f32_16x16x32_bf16 v[100:103], v[32:35], v[124:127], v[100:103]
    v_mfma_f32_16x16x32_bf16 v[100:103], v[36:39], v[132:135], v[100:103]
    s_add_u32 s32, s34, 45056
    buffer_store_dwordx4 v[248:251], v0, s[20:23], s32 offen sc1
    s_waitcnt lgkmcnt(6)
    v_mfma_f32_16x16x32_bf16 v[104:107], v[40:43], v[120:123], v[104:107]
    s_waitcnt lgkmcnt(4)
    v_mfma_f32_16x16x32_bf16 v[104:107], v[44:47], v[128:131], v[104:107]
    s_waitcnt vmcnt(12) lgkmcnt(0)
    s_barrier
    v_xor_b32 v5, 0x10000, v5
    v_xor_b32 v6, 0x10000, v6
    v_xor_b32 v7, 0x10000, v7
    v_xor_b32 v8, 0x10000, v8
    v_xor_b32 v15, 0x10000, v15
    v_xor_b32 v16, 0x10000, v16
    v_xor_b32 v11, 0x10000, v11
    v_xor_b32 v12, 0x10000, v12
    v_xor_b32 v18, 0x10000, v18
    v_xor_b32 v19, 0x10000, v19
    v_xor_b32 v20, 0x10000, v20
    ds_read_b64_tr_b16 v[24:25], v18 offset:0
    ds_read_b64_tr_b16 v[26:27], v18 offset:512
    ds_read_b64_tr_b16 v[28:29], v18 offset:4096
    ds_read_b64_tr_b16 v[30:31], v18 offset:4608
    ds_read_b64_tr_b16 v[32:33], v18 offset:8192
    ds_read_b64_tr_b16 v[34:35], v18 offset:8704
    ds_read_b64_tr_b16 v[36:37], v18 offset:12288
    ds_read_b64_tr_b16 v[38:39], v18 offset:12800
    v_mfma_f32_16x16x32_bf16 v[112:115], v[40:43], v[124:127], v[112:115]
    ds_read_b64_tr_b16 v[40:41], v19 offset:0
    v_mfma_f32_16x16x32_bf16 v[112:115], v[44:47], v[132:135], v[112:115]
    ds_read_b64_tr_b16 v[42:43], v19 offset:512
    s_add_u32 m0, s6, 0
    s_mov_b32 s32, 3145728
    buffer_load_dwordx4 v4, s[8:11], s32 offen lds
    v_mfma_f32_16x16x32_bf16 v[108:111], v[48:51], v[120:123], v[108:111]
    ds_read_b64_tr_b16 v[44:45], v19 offset:4096
    v_mfma_f32_16x16x32_bf16 v[108:111], v[52:55], v[128:131], v[108:111]
    ds_read_b64_tr_b16 v[46:47], v19 offset:4608
    v_mfma_f32_16x16x32_bf16 v[116:119], v[48:51], v[124:127], v[116:119]
    ds_read_b64_tr_b16 v[48:49], v19 offset:8192
    v_mfma_f32_16x16x32_bf16 v[116:119], v[52:55], v[132:135], v[116:119]
    ds_read_b64_tr_b16 v[50:51], v19 offset:8704
    s_waitcnt lgkmcnt(12)
    v_mfma_f32_16x16x32_bf16 v[184:187], v[24:27], v[136:139], v[184:187]
    ds_read_b64_tr_b16 v[52:53], v19 offset:12288
    s_waitcnt lgkmcnt(11)
    v_mfma_f32_16x16x32_bf16 v[184:187], v[28:31], v[144:147], v[184:187]
    ds_read_b64_tr_b16 v[54:55], v19 offset:12800
    v_mfma_f32_16x16x32_bf16 v[188:191], v[24:27], v[140:143], v[188:191]
    ds_read_b64_tr_b16 v[24:25], v20 offset:0
    s_waitcnt vmcnt(12)
    v_mfma_f32_16x16x32_bf16 v[188:191], v[28:31], v[148:151], v[188:191]
    ds_read_b64_tr_b16 v[26:27], v20 offset:512
    s_waitcnt lgkmcnt(12)
    v_mfma_f32_16x16x32_bf16 v[192:195], v[32:35], v[136:139], v[192:195]
    ds_read_b64_tr_b16 v[28:29], v20 offset:4096
    s_waitcnt lgkmcnt(11)
    v_mfma_f32_16x16x32_bf16 v[192:195], v[36:39], v[144:147], v[192:195]
    ds_read_b64_tr_b16 v[30:31], v20 offset:4608
    s_add_u32 s32, s39, 24576
    buffer_load_dwordx4 v[120:123], v0, s[20:23], s32 offen offset:0 sc1
    v_mfma_f32_16x16x32_bf16 v[196:199], v[32:35], v[140:143], v[196:199]
    ds_read_b64_tr_b16 v[32:33], v20 offset:8192
    v_mfma_f32_16x16x32_bf16 v[196:199], v[36:39], v[148:151], v[196:199]
    ds_read_b64_tr_b16 v[34:35], v20 offset:8704
    s_add_u32 m0, s6, 1024
    s_mov_b32 s32, 3178496
    buffer_load_dwordx4 v4, s[8:11], s32 offen lds
    s_waitcnt lgkmcnt(12)
    v_mfma_f32_16x16x32_bf16 v[200:203], v[40:43], v[136:139], v[200:203]
    ds_read_b64_tr_b16 v[36:37], v20 offset:12288
    s_waitcnt lgkmcnt(11)
    v_mfma_f32_16x16x32_bf16 v[200:203], v[44:47], v[144:147], v[200:203]
    ds_read_b64_tr_b16 v[38:39], v20 offset:12800
    v_mfma_f32_16x16x32_bf16 v[204:207], v[40:43], v[140:143], v[204:207]
    ds_read_b64_tr_b16 v[40:41], v5 offset:0
    v_mfma_f32_16x16x32_bf16 v[204:207], v[44:47], v[148:151], v[204:207]
    ds_read_b64_tr_b16 v[42:43], v5 offset:1024
    s_waitcnt lgkmcnt(12)
    v_mfma_f32_16x16x32_bf16 v[208:211], v[48:51], v[136:139], v[208:211]
    ds_read_b64_tr_b16 v[44:45], v5 offset:8192
    s_waitcnt lgkmcnt(11)
    v_mfma_f32_16x16x32_bf16 v[208:211], v[52:55], v[144:147], v[208:211]
    ds_read_b64_tr_b16 v[46:47], v5 offset:9216
    v_mfma_f32_16x16x32_bf16 v[212:215], v[48:51], v[140:143], v[212:215]
    ds_read_b64_tr_b16 v[48:49], v15 offset:0
    v_mfma_f32_16x16x32_bf16 v[212:215], v[52:55], v[148:151], v[212:215]
    ds_read_b64_tr_b16 v[50:51], v15 offset:1024
    s_waitcnt lgkmcnt(12)
    v_mfma_f32_16x16x32_bf16 v[216:219], v[24:27], v[136:139], v[216:219]
    ds_read_b64_tr_b16 v[52:53], v15 offset:8192
    s_waitcnt lgkmcnt(11)
    v_mfma_f32_16x16x32_bf16 v[216:219], v[28:31], v[144:147], v[216:219]
    ds_read_b64_tr_b16 v[54:55], v15 offset:9216
    s_add_u32 s32, s39, 24576
    buffer_load_dwordx4 v[124:127], v0, s[20:23], s32 offen offset:1024 sc1
    v_mfma_f32_16x16x32_bf16 v[220:223], v[24:27], v[140:143], v[220:223]
    ds_read_b64_tr_b16 v[24:25], v6 offset:0
    v_mfma_f32_16x16x32_bf16 v[220:223], v[28:31], v[148:151], v[220:223]
    ds_read_b64_tr_b16 v[26:27], v6 offset:1024
    s_add_u32 m0, s56, 0
    s_mov_b32 s32, 1056768
    buffer_load_dwordx4 v9, s[12:15], s32 offen lds
    s_add_u32 s32, s34, 46080
    buffer_store_dwordx4 v[252:255], v0, s[20:23], s32 offen sc1
    s_waitcnt lgkmcnt(12)
    v_mfma_f32_16x16x32_bf16 v[224:227], v[32:35], v[136:139], v[224:227]
    ds_read_b64_tr_b16 v[28:29], v6 offset:8192
    s_waitcnt lgkmcnt(11)
    v_mfma_f32_16x16x32_bf16 v[224:227], v[36:39], v[144:147], v[224:227]
    ds_read_b64_tr_b16 v[30:31], v6 offset:9216
    v_mfma_f32_16x16x32_bf16 v[228:231], v[32:35], v[140:143], v[228:231]
    ds_read_b64_tr_b16 v[32:33], v16 offset:0
    v_mfma_f32_16x16x32_bf16 v[228:231], v[36:39], v[148:151], v[228:231]
    ds_read_b64_tr_b16 v[34:35], v16 offset:1024
    s_waitcnt lgkmcnt(12)
    v_mfma_f32_16x16x32_bf16 v[56:59], v[40:43], v[136:139], v[56:59]
    ds_read_b64_tr_b16 v[36:37], v16 offset:8192
    s_waitcnt lgkmcnt(11)
    v_mfma_f32_16x16x32_bf16 v[56:59], v[44:47], v[144:147], v[56:59]
    ds_read_b64_tr_b16 v[38:39], v16 offset:9216
    v_mfma_f32_16x16x32_bf16 v[64:67], v[40:43], v[140:143], v[64:67]
    ds_read_b64_tr_b16 v[40:41], v7 offset:0
    v_mfma_f32_16x16x32_bf16 v[64:67], v[44:47], v[148:151], v[64:67]
    ds_read_b64_tr_b16 v[42:43], v7 offset:1024
    s_waitcnt lgkmcnt(12)
    v_mfma_f32_16x16x32_bf16 v[60:63], v[48:51], v[136:139], v[60:63]
    ds_read_b64_tr_b16 v[44:45], v7 offset:8192
    s_waitcnt lgkmcnt(11)
    v_mfma_f32_16x16x32_bf16 v[60:63], v[52:55], v[144:147], v[60:63]
    ds_read_b64_tr_b16 v[46:47], v7 offset:9216
    s_add_u32 s32, s39, 24576
    buffer_load_dwordx4 v[128:131], v0, s[20:23], s32 offen offset:2048 sc1
    v_mfma_f32_16x16x32_bf16 v[68:71], v[48:51], v[140:143], v[68:71]
    ds_read_b64_tr_b16 v[48:49], v11 offset:0
    v_mfma_f32_16x16x32_bf16 v[68:71], v[52:55], v[148:151], v[68:71]
    ds_read_b64_tr_b16 v[50:51], v11 offset:1024
    s_add_u32 m0, s56, 8192
    s_mov_b32 s32, 1056768
    buffer_load_dwordx4 v9, s[24:27], s32 offen lds
    s_waitcnt lgkmcnt(12)
    v_mfma_f32_16x16x32_bf16 v[72:75], v[24:27], v[136:139], v[72:75]
    ds_read_b64_tr_b16 v[52:53], v11 offset:8192
    s_waitcnt lgkmcnt(11)
    v_mfma_f32_16x16x32_bf16 v[72:75], v[28:31], v[144:147], v[72:75]
    ds_read_b64_tr_b16 v[54:55], v11 offset:9216
    v_mfma_f32_16x16x32_bf16 v[80:83], v[24:27], v[140:143], v[80:83]
    ds_read_b64_tr_b16 v[24:25], v8 offset:0
    v_mfma_f32_16x16x32_bf16 v[80:83], v[28:31], v[148:151], v[80:83]
    ds_read_b64_tr_b16 v[26:27], v8 offset:1024
    s_waitcnt lgkmcnt(12)
    v_mfma_f32_16x16x32_bf16 v[76:79], v[32:35], v[136:139], v[76:79]
    ds_read_b64_tr_b16 v[28:29], v8 offset:8192
    s_waitcnt lgkmcnt(11)
    v_mfma_f32_16x16x32_bf16 v[76:79], v[36:39], v[144:147], v[76:79]
    ds_read_b64_tr_b16 v[30:31], v8 offset:9216
    v_mfma_f32_16x16x32_bf16 v[84:87], v[32:35], v[140:143], v[84:87]
    ds_read_b64_tr_b16 v[32:33], v12 offset:0
    v_mfma_f32_16x16x32_bf16 v[84:87], v[36:39], v[148:151], v[84:87]
    ds_read_b64_tr_b16 v[34:35], v12 offset:1024
    s_waitcnt lgkmcnt(12)
    v_mfma_f32_16x16x32_bf16 v[88:91], v[40:43], v[136:139], v[88:91]
    ds_read_b64_tr_b16 v[36:37], v12 offset:8192
    s_waitcnt lgkmcnt(11)
    v_mfma_f32_16x16x32_bf16 v[88:91], v[44:47], v[144:147], v[88:91]
    ds_read_b64_tr_b16 v[38:39], v12 offset:9216
    s_add_u32 s32, s39, 24576
    buffer_load_dwordx4 v[132:135], v0, s[20:23], s32 offen offset:3072 sc1
    v_mfma_f32_16x16x32_bf16 v[96:99], v[40:43], v[140:143], v[96:99]
    v_mfma_f32_16x16x32_bf16 v[96:99], v[44:47], v[148:151], v[96:99]
    s_waitcnt lgkmcnt(10)
    v_mfma_f32_16x16x32_bf16 v[92:95], v[48:51], v[136:139], v[92:95]
    s_waitcnt lgkmcnt(8)
    v_mfma_f32_16x16x32_bf16 v[92:95], v[52:55], v[144:147], v[92:95]
    v_mfma_f32_16x16x32_bf16 v[100:103], v[48:51], v[140:143], v[100:103]
    v_mfma_f32_16x16x32_bf16 v[100:103], v[52:55], v[148:151], v[100:103]
    s_waitcnt lgkmcnt(6)
    v_mfma_f32_16x16x32_bf16 v[104:107], v[24:27], v[136:139], v[104:107]
    s_waitcnt lgkmcnt(4)
    v_mfma_f32_16x16x32_bf16 v[104:107], v[28:31], v[144:147], v[104:107]
    s_waitcnt vmcnt(11) lgkmcnt(0)
    s_waitcnt vmcnt(3)
    s_barrier
    ds_read_b64_tr_b16 v[40:41], v18 offset:32768
    ds_read_b64_tr_b16 v[42:43], v18 offset:33280
    ds_read_b64_tr_b16 v[44:45], v18 offset:36864
    ds_read_b64_tr_b16 v[46:47], v18 offset:37376
    ds_read_b64_tr_b16 v[48:49], v18 offset:40960
    ds_read_b64_tr_b16 v[50:51], v18 offset:41472
    ds_read_b64_tr_b16 v[52:53], v18 offset:45056
    ds_read_b64_tr_b16 v[54:55], v18 offset:45568
    s_cmp_lg_u32 s3, 0
    s_cbranch_scc1 f_w06
    s_lshl_b32 s32, s4, 7
    s_lshl_b32 s33, s5, 2
    s_add_u32 s32, s32, s33
    s_add_u32 s32, s32, 59117568
    v_mov_b32 v1, s37
    v_mov_b32 v2, 0
    s_mov_b64 exec, 1
    buffer_store_dword v1, v2, s[20:23], s32 offen sc1
    s_mov_b64 exec, -1
f_w06:
    v_lshrrev_b32 v248, 4, v0
    v_and_b32 v233, 15, v248
    v_lshrrev_b32 v245, 4, v248
    v_mfma_f32_16x16x32_bf16 v[112:115], v[24:27], v[140:143], v[112:115]
    ds_read_b64_tr_b16 v[24:25], v19 offset:32768
    v_mfma_f32_16x16x32_bf16 v[112:115], v[28:31], v[148:151], v[112:115]
    ds_read_b64_tr_b16 v[26:27], v19 offset:33280
    v_lshlrev_b32 v245, 2, v245
    v_sub_u32 v233, v233, v245
    v_mov_b32 v234, 0xff800000
    s_add_u32 m0, s6, 32768
    s_mov_b32 s32, 3670016
    buffer_load_dwordx4 v4, s[8:11], s32 offen lds
    v_mfma_f32_16x16x32_bf16 v[108:111], v[32:35], v[136:139], v[108:111]
    ds_read_b64_tr_b16 v[28:29], v19 offset:36864
    v_mfma_f32_16x16x32_bf16 v[108:111], v[36:39], v[144:147], v[108:111]
    ds_read_b64_tr_b16 v[30:31], v19 offset:37376
    v_mov_b32 v235, 0xff800000
    v_mov_b32 v236, 0
    v_add_u32 v239, 0x1000, v0
    v_mfma_f32_16x16x32_bf16 v[116:119], v[32:35], v[140:143], v[116:119]
    ds_read_b64_tr_b16 v[32:33], v19 offset:40960
    v_mfma_f32_16x16x32_bf16 v[116:119], v[36:39], v[148:151], v[116:119]
    ds_read_b64_tr_b16 v[34:35], v19 offset:41472
    v_add_u32 v232, 65536, v0
    s_mov_b32 s46, 65536
    s_mov_b32 s43, 3
    s_waitcnt lgkmcnt(12)
    v_mfma_f32_16x16x32_bf16 v[184:187], v[40:43], v[152:155], v[184:187]
    ds_read_b64_tr_b16 v[36:37], v19 offset:45056
    s_waitcnt lgkmcnt(11)
    v_mfma_f32_16x16x32_bf16 v[184:187], v[44:47], v[160:163], v[184:187]
    ds_read_b64_tr_b16 v[38:39], v19 offset:45568
    v_mov_b32 v242, 131072
    v_mov_b32 v244, 131088
    s_lshl_b32 s32, s3, 2
    v_add_u32 v243, s32, v244
    v_mfma_f32_16x16x32_bf16 v[188:191], v[40:43], v[156:159], v[188:191]
    ds_read_b64_tr_b16 v[40:41], v20 offset:32768
    v_mfma_f32_16x16x32_bf16 v[188:191], v[44:47], v[164:167], v[188:191]
    ds_read_b64_tr_b16 v[42:43], v20 offset:33280
    v_and_b32 v246, 7, v248
    v_lshl_add_u32 v244, v246, 2, v244
    v_mov_b32 v246, 1
    s_waitcnt lgkmcnt(12)
    v_mfma_f32_16x16x32_bf16 v[192:195], v[48:51], v[152:155], v[192:195]
    ds_read_b64_tr_b16 v[44:45], v20 offset:36864
    s_waitcnt lgkmcnt(11)
    v_mfma_f32_16x16x32_bf16 v[192:195], v[52:55], v[160:163], v[192:195]
    ds_read_b64_tr_b16 v[46:47], v20 offset:37376
    v_mov_b32 v245, 0
    ds_write_b32 v243, v245
    v_add_u32 v241, 2, v248
    s_add_u32 s32, s39, 28672
    buffer_load_dwordx4 v[136:139], v0, s[20:23], s32 offen offset:0 sc1
    v_mfma_f32_16x16x32_bf16 v[196:199], v[48:51], v[156:159], v[196:199]
    ds_read_b64_tr_b16 v[48:49], v20 offset:40960
    v_mfma_f32_16x16x32_bf16 v[196:199], v[52:55], v[164:167], v[196:199]
    ds_read_b64_tr_b16 v[50:51], v20 offset:41472
    v_and_b32 v241, 3, v241
    v_mov_b32 v247, -1
    v_cmp_eq_u32 vcc, 3, v241
    s_nop 1
    v_cndmask_b32 v241, v241, v247, vcc
    s_add_u32 m0, s6, 33792
    s_mov_b32 s32, 3702784
    buffer_load_dwordx4 v4, s[8:11], s32 offen lds
    s_waitcnt lgkmcnt(13)
    v_mfma_f32_16x16x32_bf16 v[200:203], v[24:27], v[152:155], v[200:203]
    ds_read_b64_tr_b16 v[52:53], v20 offset:45056
    s_waitcnt lgkmcnt(12)
    v_mfma_f32_16x16x32_bf16 v[200:203], v[28:31], v[160:163], v[200:203]
    ds_read_b64_tr_b16 v[54:55], v20 offset:45568
    v_and_b32 v240, 3, v248
    v_lshl_add_u32 v240, v240, 2, v242
    ds_write_b32 v240, v241
    v_mfma_f32_16x16x32_bf16 v[204:207], v[24:27], v[156:159], v[204:207]
    ds_read_b64_tr_b16 v[24:25], v5 offset:32768
    v_mfma_f32_16x16x32_bf16 v[204:207], v[28:31], v[164:167], v[204:207]
    ds_read_b64_tr_b16 v[26:27], v5 offset:33792
    s_and_b32 s32, s3, 7
    s_cmp_lg_u32 s32, 0
    s_cbranch_scc1 f_wh7
    v_mov_b32 v247, 131136
    v_mov_b32 v245, s37
    ds_write_b32 v247, v245
f_wh7:
    v_mov_b32 v247, 0
    s_lshl_b32 s32, s3, 13
    s_add_u32 s47, s51, s32
    s_add_u32 s47, s47, 98304
    s_add_u32 s48, s32, 32768
    s_waitcnt lgkmcnt(14)
    v_mfma_f32_16x16x32_bf16 v[208:211], v[32:35], v[152:155], v[208:211]
    ds_read_b64_tr_b16 v[28:29], v5 offset:40960
    s_waitcnt lgkmcnt(13)
    v_mfma_f32_16x16x32_bf16 v[208:211], v[36:39], v[160:163], v[208:211]
    ds_read_b64_tr_b16 v[30:31], v5 offset:41984
    s_mov_b32 s28, s88
    s_and_b32 s29, s89, 0xffff
    s_mov_b32 s30, 0x2100000
    v_mfma_f32_16x16x32_bf16 v[212:215], v[32:35], v[156:159], v[212:215]
    ds_read_b64_tr_b16 v[32:33], v15 offset:32768
    v_mfma_f32_16x16x32_bf16 v[212:215], v[36:39], v[164:167], v[212:215]
    ds_read_b64_tr_b16 v[34:35], v15 offset:33792
    s_mov_b32 s31, 0x20000
    s_waitcnt lgkmcnt(14)
    v_mfma_f32_16x16x32_bf16 v[216:219], v[40:43], v[152:155], v[216:219]
    ds_read_b64_tr_b16 v[36:37], v15 offset:40960
    s_waitcnt lgkmcnt(13)
    v_mfma_f32_16x16x32_bf16 v[216:219], v[44:47], v[160:163], v[216:219]
    ds_read_b64_tr_b16 v[38:39], v15 offset:41984
    s_add_u32 s32, s39, 28672
    buffer_load_dwordx4 v[140:143], v0, s[20:23], s32 offen offset:1024 sc1
    v_mfma_f32_16x16x32_bf16 v[220:223], v[40:43], v[156:159], v[220:223]
    ds_read_b64_tr_b16 v[40:41], v6 offset:32768
    v_mfma_f32_16x16x32_bf16 v[220:223], v[44:47], v[164:167], v[220:223]
    ds_read_b64_tr_b16 v[42:43], v6 offset:33792
    s_add_u32 m0, s56, 32768
    s_mov_b32 s32, 1232896
    buffer_load_dwordx4 v9, s[12:15], s32 offen lds
    s_waitcnt lgkmcnt(13)
    v_mfma_f32_16x16x32_bf16 v[224:227], v[48:51], v[152:155], v[224:227]
    ds_read_b64_tr_b16 v[44:45], v6 offset:40960
    s_waitcnt lgkmcnt(12)
    v_mfma_f32_16x16x32_bf16 v[224:227], v[52:55], v[160:163], v[224:227]
    ds_read_b64_tr_b16 v[46:47], v6 offset:41984
    v_mfma_f32_16x16x32_bf16 v[228:231], v[48:51], v[156:159], v[228:231]
    ds_read_b64_tr_b16 v[48:49], v16 offset:32768
    v_mfma_f32_16x16x32_bf16 v[228:231], v[52:55], v[164:167], v[228:231]
    ds_read_b64_tr_b16 v[50:51], v16 offset:33792
    s_waitcnt lgkmcnt(12)
    v_mfma_f32_16x16x32_bf16 v[56:59], v[24:27], v[152:155], v[56:59]
    ds_read_b64_tr_b16 v[52:53], v16 offset:40960
    s_waitcnt lgkmcnt(11)
    v_mfma_f32_16x16x32_bf16 v[56:59], v[28:31], v[160:163], v[56:59]
    ds_read_b64_tr_b16 v[54:55], v16 offset:41984
    v_mfma_f32_16x16x32_bf16 v[64:67], v[24:27], v[156:159], v[64:67]
    ds_read_b64_tr_b16 v[24:25], v7 offset:32768
    v_mfma_f32_16x16x32_bf16 v[64:67], v[28:31], v[164:167], v[64:67]
    ds_read_b64_tr_b16 v[26:27], v7 offset:33792
    s_waitcnt lgkmcnt(12)
    v_mfma_f32_16x16x32_bf16 v[60:63], v[32:35], v[152:155], v[60:63]
    ds_read_b64_tr_b16 v[28:29], v7 offset:40960
    s_waitcnt lgkmcnt(11)
    v_mfma_f32_16x16x32_bf16 v[60:63], v[36:39], v[160:163], v[60:63]
    ds_read_b64_tr_b16 v[30:31], v7 offset:41984
    s_add_u32 s32, s39, 28672
    buffer_load_dwordx4 v[144:147], v0, s[20:23], s32 offen offset:2048 sc1
    v_mfma_f32_16x16x32_bf16 v[68:71], v[32:35], v[156:159], v[68:71]
    ds_read_b64_tr_b16 v[32:33], v11 offset:32768
    v_mfma_f32_16x16x32_bf16 v[68:71], v[36:39], v[164:167], v[68:71]
    ds_read_b64_tr_b16 v[34:35], v11 offset:33792
    s_add_u32 m0, s56, 40960
    s_mov_b32 s32, 1232896
    buffer_load_dwordx4 v9, s[24:27], s32 offen lds
    s_waitcnt lgkmcnt(12)
    v_mfma_f32_16x16x32_bf16 v[72:75], v[40:43], v[152:155], v[72:75]
    ds_read_b64_tr_b16 v[36:37], v11 offset:40960
    s_waitcnt lgkmcnt(11)
    v_mfma_f32_16x16x32_bf16 v[72:75], v[44:47], v[160:163], v[72:75]
    ds_read_b64_tr_b16 v[38:39], v11 offset:41984
    v_mfma_f32_16x16x32_bf16 v[80:83], v[40:43], v[156:159], v[80:83]
    ds_read_b64_tr_b16 v[40:41], v8 offset:32768
    v_mfma_f32_16x16x32_bf16 v[80:83], v[44:47], v[164:167], v[80:83]
    ds_read_b64_tr_b16 v[42:43], v8 offset:33792
    s_waitcnt lgkmcnt(12)
    v_mfma_f32_16x16x32_bf16 v[76:79], v[48:51], v[152:155], v[76:79]
    ds_read_b64_tr_b16 v[44:45], v8 offset:40960
    s_waitcnt lgkmcnt(11)
    v_mfma_f32_16x16x32_bf16 v[76:79], v[52:55], v[160:163], v[76:79]
    ds_read_b64_tr_b16 v[46:47], v8 offset:41984
    v_mfma_f32_16x16x32_bf16 v[84:87], v[48:51], v[156:159], v[84:87]
    ds_read_b64_tr_b16 v[48:49], v12 offset:32768
    v_mfma_f32_16x16x32_bf16 v[84:87], v[52:55], v[164:167], v[84:87]
    ds_read_b64_tr_b16 v[50:51], v12 offset:33792
    s_waitcnt lgkmcnt(12)
    v_mfma_f32_16x16x32_bf16 v[88:91], v[24:27], v[152:155], v[88:91]
    ds_read_b64_tr_b16 v[52:53], v12 offset:40960
    s_waitcnt lgkmcnt(11)
    v_mfma_f32_16x16x32_bf16 v[88:91], v[28:31], v[160:163], v[88:91]
    ds_read_b64_tr_b16 v[54:55], v12 offset:41984
    s_add_u32 s32, s39, 28672
    buffer_load_dwordx4 v[148:151], v0, s[20:23], s32 offen offset:3072 sc1
    v_mfma_f32_16x16x32_bf16 v[96:99], v[24:27], v[156:159], v[96:99]
    v_mfma_f32_16x16x32_bf16 v[96:99], v[28:31], v[164:167], v[96:99]
    s_waitcnt lgkmcnt(10)
    v_mfma_f32_16x16x32_bf16 v[92:95], v[32:35], v[152:155], v[92:95]
    s_waitcnt lgkmcnt(8)
    v_mfma_f32_16x16x32_bf16 v[92:95], v[36:39], v[160:163], v[92:95]
    v_mfma_f32_16x16x32_bf16 v[100:103], v[32:35], v[156:159], v[100:103]
    v_mfma_f32_16x16x32_bf16 v[100:103], v[36:39], v[164:167], v[100:103]
    s_waitcnt lgkmcnt(6)
    v_mfma_f32_16x16x32_bf16 v[104:107], v[40:43], v[152:155], v[104:107]
    s_waitcnt lgkmcnt(4)
    v_mfma_f32_16x16x32_bf16 v[104:107], v[44:47], v[160:163], v[104:107]
    s_waitcnt vmcnt(9) lgkmcnt(0)
    s_barrier
    v_xor_b32 v5, 0x10000, v5
    v_xor_b32 v6, 0x10000, v6
    v_xor_b32 v7, 0x10000, v7
    v_xor_b32 v8, 0x10000, v8
    v_xor_b32 v15, 0x10000, v15
    v_xor_b32 v16, 0x10000, v16
    v_xor_b32 v11, 0x10000, v11
    v_xor_b32 v12, 0x10000, v12
    v_xor_b32 v18, 0x10000, v18
    v_xor_b32 v19, 0x10000, v19
    v_xor_b32 v20, 0x10000, v20
    ds_read_b64_tr_b16 v[24:25], v18 offset:0
    ds_read_b64_tr_b16 v[26:27], v18 offset:512
    ds_read_b64_tr_b16 v[28:29], v18 offset:4096
    ds_read_b64_tr_b16 v[30:31], v18 offset:4608
    ds_read_b64_tr_b16 v[32:33], v18 offset:8192
    ds_read_b64_tr_b16 v[34:35], v18 offset:8704
    ds_read_b64_tr_b16 v[36:37], v18 offset:12288
    ds_read_b64_tr_b16 v[38:39], v18 offset:12800
    v_lshrrev_b32 v3, 2, v0
    v_and_b32 v3, 28, v3
    s_lshl_b32 s54, s4, 7
    s_add_u32 s54, s54, 59117568
    s_cmp_eq_u32 s3, 0
    s_cselect_b32 s32, s54, 0x7f000000
    buffer_load_dword v23, v3, s[20:23], s32 offen sc1
    v_mfma_f32_16x16x32_bf16 v[112:115], v[40:43], v[156:159], v[112:115]
    ds_read_b64_tr_b16 v[40:41], v19 offset:0
    v_mfma_f32_16x16x32_bf16 v[112:115], v[44:47], v[164:167], v[112:115]
    ds_read_b64_tr_b16 v[42:43], v19 offset:512
    v_mfma_f32_16x16x32_bf16 v[108:111], v[48:51], v[152:155], v[108:111]
    ds_read_b64_tr_b16 v[44:45], v19 offset:4096
    v_mfma_f32_16x16x32_bf16 v[108:111], v[52:55], v[160:163], v[108:111]
    ds_read_b64_tr_b16 v[46:47], v19 offset:4608
    v_mfma_f32_16x16x32_bf16 v[116:119], v[48:51], v[156:159], v[116:119]
    ds_read_b64_tr_b16 v[48:49], v19 offset:8192
    v_mfma_f32_16x16x32_bf16 v[116:119], v[52:55], v[164:167], v[116:119]
    ds_read_b64_tr_b16 v[50:51], v19 offset:8704
    s_waitcnt lgkmcnt(12)
    v_mfma_f32_16x16x32_bf16 v[184:187], v[24:27], v[120:123], v[184:187]
    ds_read_b64_tr_b16 v[52:53], v19 offset:12288
    s_waitcnt lgkmcnt(11)
    v_mfma_f32_16x16x32_bf16 v[184:187], v[28:31], v[128:131], v[184:187]
    ds_read_b64_tr_b16 v[54:55], v19 offset:12800
    v_mfma_f32_16x16x32_bf16 v[188:191], v[24:27], v[124:127], v[188:191]
    ds_read_b64_tr_b16 v[24:25], v20 offset:0
    s_waitcnt vmcnt(9)
    v_mfma_f32_16x16x32_bf16 v[188:191], v[28:31], v[132:135], v[188:191]
    ds_read_b64_tr_b16 v[26:27], v20 offset:512
    s_waitcnt lgkmcnt(12)
    v_mfma_f32_16x16x32_bf16 v[192:195], v[32:35], v[120:123], v[192:195]
    ds_read_b64_tr_b16 v[28:29], v20 offset:4096
    s_waitcnt lgkmcnt(11)
    v_mfma_f32_16x16x32_bf16 v[192:195], v[36:39], v[128:131], v[192:195]
    ds_read_b64_tr_b16 v[30:31], v20 offset:4608
    v_mfma_f32_16x16x32_bf16 v[196:199], v[32:35], v[124:127], v[196:199]
    ds_read_b64_tr_b16 v[32:33], v20 offset:8192
    v_mfma_f32_16x16x32_bf16 v[196:199], v[36:39], v[132:135], v[196:199]
    ds_read_b64_tr_b16 v[34:35], v20 offset:8704
    s_waitcnt lgkmcnt(12)
    v_mfma_f32_16x16x32_bf16 v[200:203], v[40:43], v[120:123], v[200:203]
    ds_read_b64_tr_b16 v[36:37], v20 offset:12288
    s_waitcnt lgkmcnt(11)
    v_mfma_f32_16x16x32_bf16 v[200:203], v[44:47], v[128:131], v[200:203]
    ds_read_b64_tr_b16 v[38:39], v20 offset:12800
    v_mfma_f32_16x16x32_bf16 v[204:207], v[40:43], v[124:127], v[204:207]
    ds_read_b64_tr_b16 v[40:41], v5 offset:0
    v_mfma_f32_16x16x32_bf16 v[204:207], v[44:47], v[132:135], v[204:207]
    ds_read_b64_tr_b16 v[42:43], v5 offset:1024
    s_waitcnt lgkmcnt(12)
    v_mfma_f32_16x16x32_bf16 v[208:211], v[48:51], v[120:123], v[208:211]
    ds_read_b64_tr_b16 v[44:45], v5 offset:8192
    s_waitcnt lgkmcnt(11)
    v_mfma_f32_16x16x32_bf16 v[208:211], v[52:55], v[128:131], v[208:211]
    ds_read_b64_tr_b16 v[46:47], v5 offset:9216
    v_mfma_f32_16x16x32_bf16 v[212:215], v[48:51], v[124:127], v[212:215]
    ds_read_b64_tr_b16 v[48:49], v15 offset:0
    v_mfma_f32_16x16x32_bf16 v[212:215], v[52:55], v[132:135], v[212:215]
    ds_read_b64_tr_b16 v[50:51], v15 offset:1024
    s_waitcnt lgkmcnt(12)
    v_mfma_f32_16x16x32_bf16 v[216:219], v[24:27], v[120:123], v[216:219]
    ds_read_b64_tr_b16 v[52:53], v15 offset:8192
    s_waitcnt lgkmcnt(11)
    v_mfma_f32_16x16x32_bf16 v[216:219], v[28:31], v[128:131], v[216:219]
    ds_read_b64_tr_b16 v[54:55], v15 offset:9216
    v_mfma_f32_16x16x32_bf16 v[220:223], v[24:27], v[124:127], v[220:223]
    ds_read_b64_tr_b16 v[24:25], v6 offset:0
    v_mfma_f32_16x16x32_bf16 v[220:223], v[28:31], v[132:135], v[220:223]
    ds_read_b64_tr_b16 v[26:27], v6 offset:1024
    s_waitcnt lgkmcnt(12)
    v_mfma_f32_16x16x32_bf16 v[224:227], v[32:35], v[120:123], v[224:227]
    ds_read_b64_tr_b16 v[28:29], v6 offset:8192
    s_waitcnt lgkmcnt(11)
    v_mfma_f32_16x16x32_bf16 v[224:227], v[36:39], v[128:131], v[224:227]
    ds_read_b64_tr_b16 v[30:31], v6 offset:9216
    v_mfma_f32_16x16x32_bf16 v[228:231], v[32:35], v[124:127], v[228:231]
    ds_read_b64_tr_b16 v[32:33], v16 offset:0
    v_mfma_f32_16x16x32_bf16 v[228:231], v[36:39], v[132:135], v[228:231]
    ds_read_b64_tr_b16 v[34:35], v16 offset:1024
    s_waitcnt lgkmcnt(12)
    v_mfma_f32_16x16x32_bf16 v[56:59], v[40:43], v[120:123], v[56:59]
    ds_read_b64_tr_b16 v[36:37], v16 offset:8192
    s_waitcnt lgkmcnt(11)
    v_mfma_f32_16x16x32_bf16 v[56:59], v[44:47], v[128:131], v[56:59]
    ds_read_b64_tr_b16 v[38:39], v16 offset:9216
    v_mfma_f32_16x16x32_bf16 v[64:67], v[40:43], v[124:127], v[64:67]
    ds_read_b64_tr_b16 v[40:41], v7 offset:0
    v_mfma_f32_16x16x32_bf16 v[64:67], v[44:47], v[132:135], v[64:67]
    ds_read_b64_tr_b16 v[42:43], v7 offset:1024
    s_waitcnt lgkmcnt(12)
    v_mfma_f32_16x16x32_bf16 v[60:63], v[48:51], v[120:123], v[60:63]
    ds_read_b64_tr_b16 v[44:45], v7 offset:8192
    s_waitcnt lgkmcnt(11)
    v_mfma_f32_16x16x32_bf16 v[60:63], v[52:55], v[128:131], v[60:63]
    ds_read_b64_tr_b16 v[46:47], v7 offset:9216
    v_mfma_f32_16x16x32_bf16 v[68:71], v[48:51], v[124:127], v[68:71]
    ds_read_b64_tr_b16 v[48:49], v11 offset:0
    v_mfma_f32_16x16x32_bf16 v[68:71], v[52:55], v[132:135], v[68:71]
    ds_read_b64_tr_b16 v[50:51], v11 offset:1024
    s_waitcnt lgkmcnt(12)
    v_mfma_f32_16x16x32_bf16 v[72:75], v[24:27], v[120:123], v[72:75]
    ds_read_b64_tr_b16 v[52:53], v11 offset:8192
    s_waitcnt lgkmcnt(11)
    v_mfma_f32_16x16x32_bf16 v[72:75], v[28:31], v[128:131], v[72:75]
    ds_read_b64_tr_b16 v[54:55], v11 offset:9216
    v_mfma_f32_16x16x32_bf16 v[80:83], v[24:27], v[124:127], v[80:83]
    ds_read_b64_tr_b16 v[24:25], v8 offset:0
    v_mfma_f32_16x16x32_bf16 v[80:83], v[28:31], v[132:135], v[80:83]
    ds_read_b64_tr_b16 v[26:27], v8 offset:1024
    s_waitcnt lgkmcnt(12)
    v_mfma_f32_16x16x32_bf16 v[76:79], v[32:35], v[120:123], v[76:79]
    ds_read_b64_tr_b16 v[28:29], v8 offset:8192
    s_waitcnt lgkmcnt(11)
    v_mfma_f32_16x16x32_bf16 v[76:79], v[36:39], v[128:131], v[76:79]
    ds_read_b64_tr_b16 v[30:31], v8 offset:9216
    v_mfma_f32_16x16x32_bf16 v[84:87], v[32:35], v[124:127], v[84:87]
    ds_read_b64_tr_b16 v[32:33], v12 offset:0
    v_mfma_f32_16x16x32_bf16 v[84:87], v[36:39], v[132:135], v[84:87]
    ds_read_b64_tr_b16 v[34:35], v12 offset:1024
    s_waitcnt lgkmcnt(12)
    v_mfma_f32_16x16x32_bf16 v[88:91], v[40:43], v[120:123], v[88:91]
    ds_read_b64_tr_b16 v[36:37], v12 offset:8192
    s_waitcnt lgkmcnt(11)
    v_mfma_f32_16x16x32_bf16 v[88:91], v[44:47], v[128:131], v[88:91]
    ds_read_b64_tr_b16 v[38:39], v12 offset:9216
    v_mfma_f32_16x16x32_bf16 v[96:99], v[40:43], v[124:127], v[96:99]
    v_mfma_f32_16x16x32_bf16 v[96:99], v[44:47], v[132:135], v[96:99]
    s_waitcnt lgkmcnt(10)
    v_mfma_f32_16x16x32_bf16 v[92:95], v[48:51], v[120:123], v[92:95]
    s_waitcnt lgkmcnt(8)
    v_mfma_f32_16x16x32_bf16 v[92:95], v[52:55], v[128:131], v[92:95]
    v_mfma_f32_16x16x32_bf16 v[100:103], v[48:51], v[124:127], v[100:103]
    v_mfma_f32_16x16x32_bf16 v[100:103], v[52:55], v[132:135], v[100:103]
    s_waitcnt lgkmcnt(6)
    v_mfma_f32_16x16x32_bf16 v[104:107], v[24:27], v[120:123], v[104:107]
    s_waitcnt lgkmcnt(4)
    v_mfma_f32_16x16x32_bf16 v[104:107], v[28:31], v[128:131], v[104:107]
    s_waitcnt vmcnt(2) lgkmcnt(0)
    s_cmp_lg_u32 s3, 0
    s_cbranch_scc1 f_w08
    s_waitcnt vmcnt(0)
    v_cmp_ne_u32 vcc, s37, v23
    s_nop 0
    s_cbranch_vccz f_pk9
f_pl9:
    s_sub_u32 s38, s38, 1
    s_cselect_b32 s38, 0, s38
    s_cbranch_scc1 f_pk9
    s_sleep 2
    buffer_load_dword v23, v3, s[20:23], s54 offen sc1
    s_waitcnt vmcnt(0)
    v_cmp_ne_u32 vcc, s37, v23
    s_nop 0
    s_cbranch_vccz f_pk9
    s_branch f_pl9
f_pk9:
f_w08:
    s_barrier
    ds_read_b64_tr_b16 v[40:41], v5 offset:32768
    ds_read_b64_tr_b16 v[42:43], v5 offset:33792
    ds_read_b64_tr_b16 v[44:45], v5 offset:40960
    ds_read_b64_tr_b16 v[46:47], v5 offset:41984
    ds_read_b64_tr_b16 v[48:49], v15 offset:32768
    ds_read_b64_tr_b16 v[50:51], v15 offset:33792
    ds_read_b64_tr_b16 v[52:53], v15 offset:40960
    ds_read_b64_tr_b16 v[54:55], v15 offset:41984
    v_mfma_f32_16x16x32_bf16 v[112:115], v[24:27], v[124:127], v[112:115]
    ds_read_b64_tr_b16 v[24:25], v6 offset:32768
    v_mfma_f32_16x16x32_bf16 v[112:115], v[28:31], v[132:135], v[112:115]
    ds_read_b64_tr_b16 v[26:27], v6 offset:33792
    s_lshl_b32 s32, s3, 12
    s_add_u32 m0, s32, 65536
    s_add_u32 s32, s32, s51
    s_add_u32 s32, s32, 0
    buffer_load_dwordx4 v0, s[28:31], s32 offen offset:0 sc1 lds
    v_mfma_f32_16x16x32_bf16 v[108:111], v[32:35], v[120:123], v[108:111]
    ds_read_b64_tr_b16 v[28:29], v6 offset:40960
    v_mfma_f32_16x16x32_bf16 v[108:111], v[36:39], v[128:131], v[108:111]
    ds_read_b64_tr_b16 v[30:31], v6 offset:41984
    v_mfma_f32_16x16x32_bf16 v[116:119], v[32:35], v[124:127], v[116:119]
    ds_read_b64_tr_b16 v[32:33], v16 offset:32768
    v_mfma_f32_16x16x32_bf16 v[116:119], v[36:39], v[132:135], v[116:119]
    ds_read_b64_tr_b16 v[34:35], v16 offset:33792
    s_lshl_b32 s32, s3, 12
    s_add_u32 m0, s32, 65536
    s_add_u32 s32, s32, s51
    s_add_u32 s32, s32, 0
    buffer_load_dwordx4 v0, s[28:31], s32 offen offset:1024 sc1 lds
    s_waitcnt lgkmcnt(12)
    v_mfma_f32_16x16x32_bf16 v[56:59], v[40:43], v[136:139], v[56:59]
    ds_read_b64_tr_b16 v[36:37], v16 offset:40960
    s_waitcnt lgkmcnt(11)
    v_mfma_f32_16x16x32_bf16 v[56:59], v[44:47], v[144:147], v[56:59]
    ds_read_b64_tr_b16 v[38:39], v16 offset:41984
    v_mfma_f32_16x16x32_bf16 v[64:67], v[40:43], v[140:143], v[64:67]
    ds_read_b64_tr_b16 v[40:41], v7 offset:32768
    s_waitcnt vmcnt(3)
    v_mfma_f32_16x16x32_bf16 v[64:67], v[44:47], v[148:151], v[64:67]
    ds_read_b64_tr_b16 v[42:43], v7 offset:33792
    s_waitcnt lgkmcnt(12)
    v_mfma_f32_16x16x32_bf16 v[60:63], v[48:51], v[136:139], v[60:63]
    ds_read_b64_tr_b16 v[44:45], v7 offset:40960
    s_waitcnt lgkmcnt(11)
    v_mfma_f32_16x16x32_bf16 v[60:63], v[52:55], v[144:147], v[60:63]
    ds_read_b64_tr_b16 v[46:47], v7 offset:41984
    s_lshl_b32 s32, s3, 12
    s_add_u32 m0, s32, 65536
    s_add_u32 s32, s32, s51
    s_add_u32 s32, s32, 0
    buffer_load_dwordx4 v0, s[28:31], s32 offen offset:2048 sc1 lds
    v_mov_b32 v152, 0
    v_mov_b32 v153, 0
    v_mov_b32 v154, 0
    v_mov_b32 v155, 0
    v_mov_b32 v156, 0
    v_mov_b32 v157, 0
    v_mov_b32 v158, 0
    v_mov_b32 v159, 0
    v_mov_b32 v160, 0
    v_mov_b32 v161, 0
    v_mov_b32 v162, 0
    v_mov_b32 v163, 0
    v_mov_b32 v164, 0
    v_mov_b32 v165, 0
    v_mov_b32 v166, 0
    v_mov_b32 v167, 0
    v_mfma_f32_16x16x32_bf16 v[68:71], v[48:51], v[140:143], v[68:71]
    ds_read_b64_tr_b16 v[48:49], v11 offset:32768
    v_mfma_f32_16x16x32_bf16 v[68:71], v[52:55], v[148:151], v[68:71]
    ds_read_b64_tr_b16 v[50:51], v11 offset:33792
    s_waitcnt lgkmcnt(12)
    v_mfma_f32_16x16x32_bf16 v[72:75], v[24:27], v[136:139], v[72:75]
    ds_read_b64_tr_b16 v[52:53], v11 offset:40960
    s_waitcnt lgkmcnt(11)
    v_mfma_f32_16x16x32_bf16 v[72:75], v[28:31], v[144:147], v[72:75]
    ds_read_b64_tr_b16 v[54:55], v11 offset:41984
    s_lshl_b32 s32, s3, 12
    s_add_u32 m0, s32, 65536
    s_add_u32 s32, s32, s51
    s_add_u32 s32, s32, 0
    buffer_load_dwordx4 v0, s[28:31], s32 offen offset:3072 sc1 lds
    v_mfma_f32_16x16x32_bf16 v[80:83], v[24:27], v[140:143], v[80:83]
    ds_read_b64_tr_b16 v[24:25], v8 offset:32768
    v_mfma_f32_16x16x32_bf16 v[80:83], v[28:31], v[148:151], v[80:83]
    ds_read_b64_tr_b16 v[26:27], v8 offset:33792
    s_waitcnt lgkmcnt(12)
    v_mfma_f32_16x16x32_bf16 v[76:79], v[32:35], v[136:139], v[76:79]
    ds_read_b64_tr_b16 v[28:29], v8 offset:40960
    s_waitcnt lgkmcnt(11)
    v_mfma_f32_16x16x32_bf16 v[76:79], v[36:39], v[144:147], v[76:79]
    ds_read_b64_tr_b16 v[30:31], v8 offset:41984
    v_mfma_f32_16x16x32_bf16 v[84:87], v[32:35], v[140:143], v[84:87]
    ds_read_b64_tr_b16 v[32:33], v12 offset:32768
    v_mfma_f32_16x16x32_bf16 v[84:87], v[36:39], v[148:151], v[84:87]
    ds_read_b64_tr_b16 v[34:35], v12 offset:33792
    s_lshl_b32 s32, s3, 12
    s_add_u32 m0, s32, 98304
    s_add_u32 s32, s32, s51
    s_add_u32 s32, s32, 32768
    buffer_load_dwordx4 v0, s[28:31], s32 offen offset:0 sc1 lds
    v_mul_f32 v56, 0x3e0293ee, v56
    v_mul_f32 v57, 0x3e0293ee, v57
    v_mul_f32 v58, 0x3e0293ee, v58
    v_mul_f32 v59, 0x3e0293ee, v59
    v_mul_f32 v60, 0x3e0293ee, v60
    v_mul_f32 v61, 0x3e0293ee, v61
    v_mul_f32 v62, 0x3e0293ee, v62
    v_mul_f32 v63, 0x3e0293ee, v63
    v_mul_f32 v64, 0x3e0293ee, v64
    v_mul_f32 v65, 0x3e0293ee, v65
    v_mul_f32 v66, 0x3e0293ee, v66
    v_mul_f32 v67, 0x3e0293ee, v67
    v_mul_f32 v68, 0x3e0293ee, v68
    v_mul_f32 v69, 0x3e0293ee, v69
    v_mul_f32 v70, 0x3e0293ee, v70
    v_mul_f32 v71, 0x3e0293ee, v71
    v_cvt_pk_bf16_f32 v56, v56, v57
    v_cvt_pk_bf16_f32 v57, v58, v59
    v_cvt_pk_bf16_f32 v58, v60, v61
    v_cvt_pk_bf16_f32 v59, v62, v63
    v_cvt_pk_bf16_f32 v60, v64, v65
    v_cvt_pk_bf16_f32 v61, v66, v67
    v_cvt_pk_bf16_f32 v62, v68, v69
    v_cvt_pk_bf16_f32 v63, v70, v71
    s_waitcnt lgkmcnt(12)
    v_mfma_f32_16x16x32_bf16 v[88:91], v[40:43], v[136:139], v[88:91]
    ds_read_b64_tr_b16 v[36:37], v12 offset:40960
    s_waitcnt lgkmcnt(11)
    v_mfma_f32_16x16x32_bf16 v[88:91], v[44:47], v[144:147], v[88:91]
    ds_read_b64_tr_b16 v[38:39], v12 offset:41984
    v_mfma_f32_16x16x32_bf16 v[96:99], v[40:43], v[140:143], v[96:99]
    ds_read_b64_tr_b16 v[40:41], v18 offset:32768
    v_mfma_f32_16x16x32_bf16 v[96:99], v[44:47], v[148:151], v[96:99]
    ds_read_b64_tr_b16 v[42:43], v18 offset:33280
    s_lshl_b32 s32, s3, 12
    s_add_u32 m0, s32, 98304
    s_add_u32 s32, s32, s51
    s_add_u32 s32, s32, 32768
    buffer_load_dwordx4 v0, s[28:31], s32 offen offset:1024 sc1 lds
    s_waitcnt lgkmcnt(12)
    v_mfma_f32_16x16x32_bf16 v[92:95], v[48:51], v[136:139], v[92:95]
    ds_read_b64_tr_b16 v[44:45], v18 offset:36864
    s_waitcnt lgkmcnt(11)
    v_mfma_f32_16x16x32_bf16 v[92:95], v[52:55], v[144:147], v[92:95]
    ds_read_b64_tr_b16 v[46:47], v18 offset:37376
    v_mfma_f32_16x16x32_bf16 v[100:103], v[48:51], v[140:143], v[100:103]
    ds_read_b64_tr_b16 v[48:49], v18 offset:40960
    v_mfma_f32_16x16x32_bf16 v[100:103], v[52:55], v[148:151], v[100:103]
    ds_read_b64_tr_b16 v[50:51], v18 offset:41472
    v_mul_f32 v72, 0x3e0293ee, v72
    v_mul_f32 v73, 0x3e0293ee, v73
    v_mul_f32 v74, 0x3e0293ee, v74
    v_mul_f32 v75, 0x3e0293ee, v75
    v_mul_f32 v76, 0x3e0293ee, v76
    v_mul_f32 v77, 0x3e0293ee, v77
    v_mul_f32 v78, 0x3e0293ee, v78
    v_mul_f32 v79, 0x3e0293ee, v79
    v_mul_f32 v80, 0x3e0293ee, v80
    v_mul_f32 v81, 0x3e0293ee, v81
    v_mul_f32 v82, 0x3e0293ee, v82
    v_mul_f32 v83, 0x3e0293ee, v83
    v_mul_f32 v84, 0x3e0293ee, v84
    v_mul_f32 v85, 0x3e0293ee, v85
    v_mul_f32 v86, 0x3e0293ee, v86
    v_mul_f32 v87, 0x3e0293ee, v87
    v_cvt_pk_bf16_f32 v64, v72, v73
    v_cvt_pk_bf16_f32 v65, v74, v75
    v_cvt_pk_bf16_f32 v66, v76, v77
    v_cvt_pk_bf16_f32 v67, v78, v79
    v_cvt_pk_bf16_f32 v68, v80, v81
    v_cvt_pk_bf16_f32 v69, v82, v83
    v_cvt_pk_bf16_f32 v70, v84, v85
    v_cvt_pk_bf16_f32 v71, v86, v87
    s_waitcnt lgkmcnt(12)
    v_mfma_f32_16x16x32_bf16 v[104:107], v[24:27], v[136:139], v[104:107]
    ds_read_b64_tr_b16 v[52:53], v18 offset:45056
    s_waitcnt lgkmcnt(11)
    v_mfma_f32_16x16x32_bf16 v[104:107], v[28:31], v[144:147], v[104:107]
    ds_read_b64_tr_b16 v[54:55], v18 offset:45568
    s_lshl_b32 s32, s3, 12
    s_add_u32 m0, s32, 98304
    s_add_u32 s32, s32, s51
    s_add_u32 s32, s32, 32768
    buffer_load_dwordx4 v0, s[28:31], s32 offen offset:2048 sc1 lds
    v_mfma_f32_16x16x32_bf16 v[112:115], v[24:27], v[140:143], v[112:115]
    ds_read_b64_tr_b16 v[24:25], v19 offset:32768
    v_mfma_f32_16x16x32_bf16 v[112:115], v[28:31], v[148:151], v[112:115]
    ds_read_b64_tr_b16 v[26:27], v19 offset:33280
    s_waitcnt lgkmcnt(12)
    v_mfma_f32_16x16x32_bf16 v[108:111], v[32:35], v[136:139], v[108:111]
    ds_read_b64_tr_b16 v[28:29], v19 offset:36864
    s_waitcnt lgkmcnt(11)
    v_mfma_f32_16x16x32_bf16 v[108:111], v[36:39], v[144:147], v[108:111]
    ds_read_b64_tr_b16 v[30:31], v19 offset:37376
    s_lshl_b32 s32, s3, 12
    s_add_u32 m0, s32, 98304
    s_add_u32 s32, s32, s51
    s_add_u32 s32, s32, 32768
    buffer_load_dwordx4 v0, s[28:31], s32 offen offset:3072 sc1 lds
    v_mfma_f32_16x16x32_bf16 v[116:119], v[32:35], v[140:143], v[116:119]
    ds_read_b64_tr_b16 v[32:33], v19 offset:40960
    v_mfma_f32_16x16x32_bf16 v[116:119], v[36:39], v[148:151], v[116:119]
    ds_read_b64_tr_b16 v[34:35], v19 offset:41472
    v_mul_f32 v88, 0x3e0293ee, v88
    v_mul_f32 v89, 0x3e0293ee, v89
    v_mul_f32 v90, 0x3e0293ee, v90
    v_mul_f32 v91, 0x3e0293ee, v91
    v_mul_f32 v92, 0x3e0293ee, v92
    v_mul_f32 v93, 0x3e0293ee, v93
    v_mul_f32 v94, 0x3e0293ee, v94
    v_mul_f32 v95, 0x3e0293ee, v95
    v_mul_f32 v96, 0x3e0293ee, v96
    v_mul_f32 v97, 0x3e0293ee, v97
    v_mul_f32 v98, 0x3e0293ee, v98
    v_mul_f32 v99, 0x3e0293ee, v99
    v_mul_f32 v100, 0x3e0293ee, v100
    v_mul_f32 v101, 0x3e0293ee, v101
    v_mul_f32 v102, 0x3e0293ee, v102
    v_mul_f32 v103, 0x3e0293ee, v103
    v_cvt_pk_bf16_f32 v72, v88, v89
    v_cvt_pk_bf16_f32 v73, v90, v91
    v_cvt_pk_bf16_f32 v74, v92, v93
    v_cvt_pk_bf16_f32 v75, v94, v95
    v_cvt_pk_bf16_f32 v76, v96, v97
    v_cvt_pk_bf16_f32 v77, v98, v99
    v_cvt_pk_bf16_f32 v78, v100, v101
    v_cvt_pk_bf16_f32 v79, v102, v103
    s_waitcnt lgkmcnt(12)
    v_mfma_f32_16x16x32_bf16 v[184:187], v[40:43], v[136:139], v[184:187]
    ds_read_b64_tr_b16 v[36:37], v19 offset:45056
    s_waitcnt lgkmcnt(11)
    v_mfma_f32_16x16x32_bf16 v[184:187], v[44:47], v[144:147], v[184:187]
    ds_read_b64_tr_b16 v[38:39], v19 offset:45568
    v_mfma_f32_16x16x32_bf16 v[188:191], v[40:43], v[140:143], v[188:191]
    ds_read_b64_tr_b16 v[40:41], v20 offset:32768
    v_mfma_f32_16x16x32_bf16 v[188:191], v[44:47], v[148:151], v[188:191]
    ds_read_b64_tr_b16 v[42:43], v20 offset:33280
    s_waitcnt lgkmcnt(12)
    v_mfma_f32_16x16x32_bf16 v[192:195], v[48:51], v[136:139], v[192:195]
    ds_read_b64_tr_b16 v[44:45], v20 offset:36864
    s_waitcnt lgkmcnt(11)
    v_mfma_f32_16x16x32_bf16 v[192:195], v[52:55], v[144:147], v[192:195]
    ds_read_b64_tr_b16 v[46:47], v20 offset:37376
    v_mfma_f32_16x16x32_bf16 v[196:199], v[48:51], v[140:143], v[196:199]
    ds_read_b64_tr_b16 v[48:49], v20 offset:40960
    v_mfma_f32_16x16x32_bf16 v[196:199], v[52:55], v[148:151], v[196:199]
    ds_read_b64_tr_b16 v[50:51], v20 offset:41472
    v_mul_f32 v104, 0x3e0293ee, v104
    v_mul_f32 v105, 0x3e0293ee, v105
    v_mul_f32 v106, 0x3e0293ee, v106
    v_mul_f32 v107, 0x3e0293ee, v107
    v_mul_f32 v108, 0x3e0293ee, v108
    v_mul_f32 v109, 0x3e0293ee, v109
    v_mul_f32 v110, 0x3e0293ee, v110
    v_mul_f32 v111, 0x3e0293ee, v111
    v_mul_f32 v112, 0x3e0293ee, v112
    v_mul_f32 v113, 0x3e0293ee, v113
    v_mul_f32 v114, 0x3e0293ee, v114
    v_mul_f32 v115, 0x3e0293ee, v115
    v_mul_f32 v116, 0x3e0293ee, v116
    v_mul_f32 v117, 0x3e0293ee, v117
    v_mul_f32 v118, 0x3e0293ee, v118
    v_mul_f32 v119, 0x3e0293ee, v119
    v_cvt_pk_bf16_f32 v80, v104, v105
    v_cvt_pk_bf16_f32 v81, v106, v107
    v_cvt_pk_bf16_f32 v82, v108, v109
    v_cvt_pk_bf16_f32 v83, v110, v111
    v_cvt_pk_bf16_f32 v84, v112, v113
    v_cvt_pk_bf16_f32 v85, v114, v115
    v_cvt_pk_bf16_f32 v86, v116, v117
    v_cvt_pk_bf16_f32 v87, v118, v119
    s_waitcnt lgkmcnt(12)
    v_mfma_f32_16x16x32_bf16 v[200:203], v[24:27], v[136:139], v[200:203]
    ds_read_b64_tr_b16 v[52:53], v20 offset:45056
    s_waitcnt lgkmcnt(11)
    v_mfma_f32_16x16x32_bf16 v[200:203], v[28:31], v[144:147], v[200:203]
    ds_read_b64_tr_b16 v[54:55], v20 offset:45568
    v_mfma_f32_16x16x32_bf16 v[204:207], v[24:27], v[140:143], v[204:207]
    v_mfma_f32_16x16x32_bf16 v[204:207], v[28:31], v[148:151], v[204:207]
    s_waitcnt lgkmcnt(10)
    v_mfma_f32_16x16x32_bf16 v[208:211], v[32:35], v[136:139], v[208:211]
    s_waitcnt lgkmcnt(8)
    v_mfma_f32_16x16x32_bf16 v[208:211], v[36:39], v[144:147], v[208:211]
    v_mfma_f32_16x16x32_bf16 v[212:215], v[32:35], v[140:143], v[212:215]
    v_mfma_f32_16x16x32_bf16 v[212:215], v[36:39], v[148:151], v[212:215]
    s_waitcnt lgkmcnt(6)
    v_mfma_f32_16x16x32_bf16 v[216:219], v[40:43], v[136:139], v[216:219]
    s_waitcnt lgkmcnt(4)
    v_mfma_f32_16x16x32_bf16 v[216:219], v[44:47], v[144:147], v[216:219]
    s_waitcnt vmcnt(4) lgkmcnt(0)
    s_barrier
    ds_read_b128 v[24:27], v232 offset:0
    ds_read_b128 v[28:31], v232 offset:1024
    ds_read_b128 v[32:35], v232 offset:2048
    ds_read_b128 v[36:39], v232 offset:3072
    v_mov_b32 v1, 131136
    ds_read_b32 v2, v1
    s_waitcnt lgkmcnt(0)
    v_readfirstlane_b32 s37, v2
    v_mfma_f32_16x16x32_bf16 v[220:223], v[40:43], v[140:143], v[220:223]
    v_mfma_f32_16x16x32_bf16 v[220:223], v[44:47], v[148:151], v[220:223]
    ds_read_b128 v[40:43], v232 offset:4096
    s_lshl_b32 s32, s3, 12
    s_add_u32 m0, s32, 0
    s_add_u32 s32, s32, s51
    s_add_u32 s32, s32, 65536
    buffer_load_dwordx4 v0, s[28:31], s32 offen offset:0 sc1 lds
    v_mfma_f32_16x16x32_bf16 v[224:227], v[48:51], v[136:139], v[224:227]
    v_mfma_f32_16x16x32_bf16 v[224:227], v[52:55], v[144:147], v[224:227]
    ds_read_b128 v[44:47], v232 offset:5120
    v_mfma_f32_16x16x32_bf16 v[228:231], v[48:51], v[140:143], v[228:231]
    v_mfma_f32_16x16x32_bf16 v[228:231], v[52:55], v[148:151], v[228:231]
    ds_read_b128 v[48:51], v232 offset:6144
    s_lshl_b32 s32, s3, 12
    s_add_u32 m0, s32, 0
    s_add_u32 s32, s32, s51
    s_add_u32 s32, s32, 65536
    buffer_load_dwordx4 v0, s[28:31], s32 offen offset:1024 sc1 lds
    s_cmp_lg_u32 s55, 0
    s_cbranch_scc1 f_nm10
    v_cmp_gt_i32 s[58:59], 0, v233
    v_cmp_gt_i32 s[60:61], 1, v233
    v_cmp_gt_i32 s[62:63], 2, v233
    v_cndmask_b32 v152, v152, v234, s[58:59]
    v_cndmask_b32 v153, v153, v234, s[60:61]
    v_cndmask_b32 v154, v154, v234, s[62:63]
    v_cmp_gt_i32 s[58:59], 3, v233
    v_cmp_gt_i32 s[60:61], 16, v233
    v_cmp_gt_i32 s[62:63], 17, v233
    v_cndmask_b32 v155, v155, v234, s[58:59]
    v_cndmask_b32 v156, v156, v234, s[60:61]
    v_cndmask_b32 v157, v157, v234, s[62:63]
    v_cmp_gt_i32 s[58:59], 18, v233
    v_cmp_gt_i32 s[60:61], 19, v233
    v_cmp_gt_i32 s[62:63], -16, v233
    v_cndmask_b32 v158, v158, v234, s[58:59]
    v_cndmask_b32 v159, v159, v234, s[60:61]
    v_cndmask_b32 v160, v160, v234, s[62:63]
    v_cmp_gt_i32 s[58:59], -15, v233
    v_cmp_gt_i32 s[60:61], -14, v233
    v_cmp_gt_i32 s[62:63], -13, v233
    v_cndmask_b32 v161, v161, v234, s[58:59]
    v_cndmask_b32 v162, v162, v234, s[60:61]
    v_cndmask_b32 v163, v163, v234, s[62:63]
    v_cmp_gt_i32 s[58:59], 0, v233
    v_cmp_gt_i32 s[60:61], 1, v233
    v_cmp_gt_i32 s[62:63], 2, v233
    v_cndmask_b32 v164, v164, v234, s[58:59]
    v_cndmask_b32 v165, v165, v234, s[60:61]
    v_cndmask_b32 v166, v166, v234, s[62:63]
    v_cmp_gt_i32 s[58:59], 3, v233
    s_nop 1
    v_cndmask_b32 v167, v167, v234, s[58:59]
f_nm10:
    v_mfma_f32_16x16x32_bf16 v[120:123], v[24:27], v[56:59], v[152:155]
    v_mfma_f32_16x16x32_bf16 v[120:123], v[28:31], v[64:67], v[120:123]
    ds_read_b128 v[52:55], v232 offset:7168
    v_mfma_f32_16x16x32_bf16 v[120:123], v[32:35], v[72:75], v[120:123]
    v_mfma_f32_16x16x32_bf16 v[120:123], v[36:39], v[80:83], v[120:123]
    s_lshl_b32 s32, s3, 12
    s_add_u32 m0, s32, 0
    s_add_u32 s32, s32, s51
    s_add_u32 s32, s32, 65536
    buffer_load_dwordx4 v0, s[28:31], s32 offen offset:2048 sc1 lds
    v_max_f32 v184, 0, v184
    v_max_f32 v185, 0, v185
    v_max_f32 v186, 0, v186
    v_max_f32 v187, 0, v187
    v_max_f32 v188, 0, v188
    v_max_f32 v189, 0, v189
    v_max_f32 v190, 0, v190
    v_max_f32 v191, 0, v191
    v_mul_f32 v184, v184, v192
    v_mul_f32 v185, v185, v193
    v_mul_f32 v186, v186, v194
    v_mul_f32 v187, v187, v195
    v_mul_f32 v188, v188, v196
    v_mul_f32 v189, v189, v197
    v_mul_f32 v190, v190, v198
    v_mul_f32 v191, v191, v199
    v_cvt_pk_bf16_f32 v192, v184, v185
    v_cvt_pk_bf16_f32 v193, v186, v187
    v_cvt_pk_bf16_f32 v194, v188, v189
    v_cvt_pk_bf16_f32 v195, v190, v191
    s_nop 0
    v_permlane16_swap_b32 v192, v194
    v_permlane16_swap_b32 v193, v195
    s_nop 0
    v_permlane32_swap_b32 v192, v194
    v_permlane32_swap_b32 v193, v195
    buffer_store_dwordx4 v[192:195], v0, s[20:23], s49 offen offset:0 sc1
    v_mfma_f32_16x16x32_bf16 v[128:131], v[24:27], v[60:63], v[160:163]
    v_mfma_f32_16x16x32_bf16 v[128:131], v[28:31], v[68:71], v[128:131]
    ds_read_b128 v[24:27], v232 offset:16384
    ds_read_b128 v[28:31], v232 offset:17408
    v_mfma_f32_16x16x32_bf16 v[128:131], v[32:35], v[76:79], v[128:131]
    v_mfma_f32_16x16x32_bf16 v[128:131], v[36:39], v[84:87], v[128:131]
    ds_read_b128 v[32:35], v232 offset:18432
    ds_read_b128 v[36:39], v232 offset:19456
    s_lshl_b32 s32, s3, 12
    s_add_u32 m0, s32, 0
    s_add_u32 s32, s32, s51
    s_add_u32 s32, s32, 65536
    buffer_load_dwordx4 v0, s[28:31], s32 offen offset:3072 sc1 lds
    v_mov_b32 v252, 0x3f803f80
    v_mov_b32 v253, 0x3f803f80
    v_mov_b32 v254, 0x3f803f80
    v_mov_b32 v255, 0x3f803f80
    s_waitcnt lgkmcnt(7)
    v_mfma_f32_16x16x32_bf16 v[124:127], v[40:43], v[56:59], v[156:159]
    s_waitcnt lgkmcnt(6)
    v_mfma_f32_16x16x32_bf16 v[124:127], v[44:47], v[64:67], v[124:127]
    v_max_f32 v200, 0, v200
    v_max_f32 v201, 0, v201
    v_max_f32 v202, 0, v202
    v_max_f32 v203, 0, v203
    v_max_f32 v204, 0, v204
    v_max_f32 v205, 0, v205
    v_max_f32 v206, 0, v206
    v_max_f32 v207, 0, v207
    v_mul_f32 v200, v200, v208
    v_mul_f32 v201, v201, v209
    v_mul_f32 v202, v202, v210
    v_mul_f32 v203, v203, v211
    v_mul_f32 v204, v204, v212
    v_mul_f32 v205, v205, v213
    v_mul_f32 v206, v206, v214
    v_mul_f32 v207, v207, v215
    v_cvt_pk_bf16_f32 v208, v200, v201
    v_cvt_pk_bf16_f32 v209, v202, v203
    v_cvt_pk_bf16_f32 v210, v204, v205
    v_cvt_pk_bf16_f32 v211, v206, v207
    s_nop 0
    v_permlane16_swap_b32 v208, v210
    v_permlane16_swap_b32 v209, v211
    s_nop 0
    v_permlane32_swap_b32 v208, v210
    v_permlane32_swap_b32 v209, v211
    buffer_store_dwordx4 v[208:211], v0, s[20:23], s49 offen offset:1024 sc1
    s_waitcnt lgkmcnt(5)
    v_mfma_f32_16x16x32_bf16 v[124:127], v[48:51], v[72:75], v[124:127]
    s_waitcnt lgkmcnt(4)
    v_mfma_f32_16x16x32_bf16 v[124:127], v[52:55], v[80:83], v[124:127]
    v_mfma_f32_16x16x32_bf16 v[132:135], v[40:43], v[60:63], v[164:167]
    v_mfma_f32_16x16x32_bf16 v[132:135], v[44:47], v[68:71], v[132:135]
    ds_read_b128 v[40:43], v232 offset:20480
    ds_read_b128 v[44:47], v232 offset:21504
    v_mfma_f32_16x16x32_bf16 v[132:135], v[48:51], v[76:79], v[132:135]
    v_mfma_f32_16x16x32_bf16 v[132:135], v[52:55], v[84:87], v[132:135]
    ds_read_b128 v[48:51], v232 offset:22528
    ds_read_b128 v[52:55], v232 offset:23552
    v_max_f32 v216, 0, v216
    v_max_f32 v217, 0, v217
    v_max_f32 v218, 0, v218
    v_max_f32 v219, 0, v219
    v_max_f32 v220, 0, v220
    v_max_f32 v221, 0, v221
    v_max_f32 v222, 0, v222
    v_max_f32 v223, 0, v223
    v_mul_f32 v216, v216, v224
    v_mul_f32 v217, v217, v225
    v_mul_f32 v218, v218, v226
    v_mul_f32 v219, v219, v227
    v_mul_f32 v220, v220, v228
    v_mul_f32 v221, v221, v229
    v_mul_f32 v222, v222, v230
    v_mul_f32 v223, v223, v231
    v_cvt_pk_bf16_f32 v224, v216, v217
    v_cvt_pk_bf16_f32 v225, v218, v219
    v_cvt_pk_bf16_f32 v226, v220, v221
    v_cvt_pk_bf16_f32 v227, v222, v223
    s_nop 0
    v_permlane16_swap_b32 v224, v226
    v_permlane16_swap_b32 v225, v227
    s_nop 0
    v_permlane32_swap_b32 v224, v226
    v_permlane32_swap_b32 v225, v227
    buffer_store_dwordx4 v[224:227], v0, s[20:23], s57 offen offset:2048 sc1
    s_cmp_lg_u32 s55, 1
    s_cbranch_scc1 f_nm11
    v_cmp_gt_i32 s[58:59], 0, v233
    v_cmp_gt_i32 s[60:61], 1, v233
    v_cmp_gt_i32 s[62:63], 2, v233
    v_cndmask_b32 v152, v152, v234, s[58:59]
    v_cndmask_b32 v153, v153, v234, s[60:61]
    v_cndmask_b32 v154, v154, v234, s[62:63]
    v_cmp_gt_i32 s[58:59], 3, v233
    v_cmp_gt_i32 s[60:61], 16, v233
    v_cmp_gt_i32 s[62:63], 17, v233
    v_cndmask_b32 v155, v155, v234, s[58:59]
    v_cndmask_b32 v156, v156, v234, s[60:61]
    v_cndmask_b32 v157, v157, v234, s[62:63]
    v_cmp_gt_i32 s[58:59], 18, v233
    v_cmp_gt_i32 s[60:61], 19, v233
    v_cmp_gt_i32 s[62:63], -16, v233
    v_cndmask_b32 v158, v158, v234, s[58:59]
    v_cndmask_b32 v159, v159, v234, s[60:61]
    v_cndmask_b32 v160, v160, v234, s[62:63]
    v_cmp_gt_i32 s[58:59], -15, v233
    v_cmp_gt_i32 s[60:61], -14, v233
    v_cmp_gt_i32 s[62:63], -13, v233
    v_cndmask_b32 v161, v161, v234, s[58:59]
    v_cndmask_b32 v162, v162, v234, s[60:61]
    v_cndmask_b32 v163, v163, v234, s[62:63]
    v_cmp_gt_i32 s[58:59], 0, v233
    v_cmp_gt_i32 s[60:61], 1, v233
    v_cmp_gt_i32 s[62:63], 2, v233
    v_cndmask_b32 v164, v164, v234, s[58:59]
    v_cndmask_b32 v165, v165, v234, s[60:61]
    v_cndmask_b32 v166, v166, v234, s[62:63]
    v_cmp_gt_i32 s[58:59], 3, v233
    s_nop 1
    v_cndmask_b32 v167, v167, v234, s[58:59]
f_nm11:
    s_waitcnt lgkmcnt(7)
    v_mfma_f32_16x16x32_bf16 v[136:139], v[24:27], v[56:59], v[152:155]
    s_waitcnt lgkmcnt(6)
    v_mfma_f32_16x16x32_bf16 v[136:139], v[28:31], v[64:67], v[136:139]
    s_waitcnt lgkmcnt(5)
    v_mfma_f32_16x16x32_bf16 v[136:139], v[32:35], v[72:75], v[136:139]
    s_waitcnt lgkmcnt(4)
    v_mfma_f32_16x16x32_bf16 v[136:139], v[36:39], v[80:83], v[136:139]
    v_mov_b32 v88, 0
    v_mov_b32 v89, 0
    v_mov_b32 v90, 0
    v_mov_b32 v91, 0
    v_mov_b32 v92, 0
    v_mov_b32 v93, 0
    v_mov_b32 v94, 0
    v_mov_b32 v95, 0
    v_mov_b32 v96, 0
    v_mov_b32 v97, 0
    v_mov_b32 v98, 0
    v_mov_b32 v99, 0
    v_mov_b32 v100, 0
    v_mov_b32 v101, 0
    v_mov_b32 v102, 0
    v_mov_b32 v103, 0
    v_mov_b32 v104, 0
    v_mov_b32 v105, 0
    v_mov_b32 v106, 0
    v_mov_b32 v107, 0
    v_mov_b32 v108, 0
    v_mov_b32 v109, 0
    v_mov_b32 v110, 0
    v_mov_b32 v111, 0
    v_mov_b32 v112, 0
    v_mov_b32 v113, 0
    v_mov_b32 v114, 0
    v_mov_b32 v115, 0
    v_mov_b32 v116, 0
    v_mov_b32 v117, 0
    v_mov_b32 v118, 0
    v_mov_b32 v119, 0
    v_mfma_f32_16x16x32_bf16 v[144:147], v[24:27], v[60:63], v[160:163]
    v_mfma_f32_16x16x32_bf16 v[144:147], v[28:31], v[68:71], v[144:147]
    v_mfma_f32_16x16x32_bf16 v[144:147], v[32:35], v[76:79], v[144:147]
    v_mfma_f32_16x16x32_bf16 v[144:147], v[36:39], v[84:87], v[144:147]
    s_waitcnt lgkmcnt(3)
    v_mfma_f32_16x16x32_bf16 v[140:143], v[40:43], v[56:59], v[156:159]
    s_waitcnt lgkmcnt(2)
    v_mfma_f32_16x16x32_bf16 v[140:143], v[44:47], v[64:67], v[140:143]
    v_mov_b32 v184, 0
    v_mov_b32 v185, 0
    v_mov_b32 v186, 0
    v_mov_b32 v187, 0
    v_mov_b32 v188, 0
    v_mov_b32 v189, 0
    v_mov_b32 v190, 0
    v_mov_b32 v191, 0
    v_mov_b32 v192, 0
    v_mov_b32 v193, 0
    v_mov_b32 v194, 0
    v_mov_b32 v195, 0
    v_mov_b32 v196, 0
    v_mov_b32 v197, 0
    v_mov_b32 v198, 0
    v_mov_b32 v199, 0
    v_mov_b32 v200, 0
    v_mov_b32 v201, 0
    v_mov_b32 v202, 0
    v_mov_b32 v203, 0
    v_mov_b32 v204, 0
    v_mov_b32 v205, 0
    v_mov_b32 v206, 0
    v_mov_b32 v207, 0
    v_mov_b32 v208, 0
    v_mov_b32 v209, 0
    v_mov_b32 v210, 0
    v_mov_b32 v211, 0
    v_mov_b32 v212, 0
    v_mov_b32 v213, 0
    v_mov_b32 v214, 0
    v_mov_b32 v215, 0
    s_waitcnt lgkmcnt(1)
    v_mfma_f32_16x16x32_bf16 v[140:143], v[48:51], v[72:75], v[140:143]
    s_waitcnt lgkmcnt(0)
    v_mfma_f32_16x16x32_bf16 v[140:143], v[52:55], v[80:83], v[140:143]
    v_mfma_f32_16x16x32_bf16 v[148:151], v[40:43], v[60:63], v[164:167]
    v_mfma_f32_16x16x32_bf16 v[148:151], v[44:47], v[68:71], v[148:151]
    v_mov_b32 v224, 0
    v_mov_b32 v225, 0
    v_mov_b32 v226, 0
    v_mov_b32 v227, 0
    v_mov_b32 v228, 0
    v_mov_b32 v229, 0
    v_mov_b32 v230, 0
    v_mov_b32 v231, 0
    v_mfma_f32_16x16x32_bf16 v[148:151], v[48:51], v[76:79], v[148:151]
    v_mfma_f32_16x16x32_bf16 v[148:151], v[52:55], v[84:87], v[148:151]
    s_add_u32 s46, s46, 32768
    s_and_b32 s46, s46, 0x1ffff
    s_lshr_b32 s33, s46, 13
    v_add_u32 v240, s33, v242
    v_add_u32 v232, s46, v0
    s_waitcnt vmcnt(2)
    s_barrier
    ds_read_b128 v[24:27], v232 offset:0
    ds_read_b128 v[28:31], v232 offset:1024
    ds_read_b128 v[32:35], v232 offset:2048
    ds_read_b128 v[36:39], v232 offset:3072
    ds_read_b128 v[40:43], v232 offset:4096
    ds_read_b128 v[44:47], v232 offset:5120
    ds_read_b128 v[48:51], v232 offset:6144
    ds_read_b128 v[52:55], v232 offset:7168
    v_mov_b32 v245, 1
    ds_write_b32 v243, v245
    s_mov_b32 s45, 2
    s_mov_b32 s52, 0
    s_sub_u32 s44, s55, 3
    s_cmp_eq_u32 s55, 1
    s_cselect_b32 s50, 1, 0
    s_setprio 1
    s_branch f_fix0
f_ret_p0:
    s_mov_b32 s45, 0
    s_cmp_lg_u32 s55, 0
    s_cbranch_scc1 f_u_ge1
    ds_read_b128 v[24:27], v232 offset:8192
    ds_read_b128 v[28:31], v232 offset:9216
    ds_read_b128 v[32:35], v232 offset:10240
    ds_read_b128 v[36:39], v232 offset:11264
    ds_read_b128 v[40:43], v232 offset:12288
    ds_read_b128 v[44:47], v232 offset:13312
    ds_read_b128 v[48:51], v232 offset:14336
    ds_read_b128 v[52:55], v232 offset:15360
    s_branch f_final0
f_u_ge1:
    s_cmp_le_u32 s55, 2
    s_cbranch_scc1 f_special1
    s_cmp_eq_u32 s41, 0
    s_cbranch_scc1 f_fullA1
f_fullB1:
    s_waitcnt lgkmcnt(4)
    v_mfma_f32_16x16x32_bf16 v[120:123], v[24:27], v[56:59], v[152:155]
    v_exp_f32 v220, v140
    v_mfma_f32_16x16x32_bf16 v[120:123], v[28:31], v[64:67], v[120:123]
    v_cvt_pk_bf16_f32 v176, v216, v217
    s_add_u32 s46, s46, 32768
    v_mfma_f32_16x16x32_bf16 v[120:123], v[32:35], v[72:75], v[120:123]
    v_exp_f32 v221, v141
    v_mfma_f32_16x16x32_bf16 v[120:123], v[36:39], v[80:83], v[120:123]
    v_cvt_pk_bf16_f32 v177, v218, v219
    s_and_b32 s46, s46, 0x1ffff
    v_mfma_f32_16x16x32_bf16 v[128:131], v[24:27], v[60:63], v[160:163]
    v_exp_f32 v222, v142
    v_mfma_f32_16x16x32_bf16 v[128:131], v[28:31], v[68:71], v[128:131]
    ds_read_b128 v[24:27], v232 offset:8192
    ds_read_b128 v[28:31], v232 offset:9216
    v_mfma_f32_16x16x32_bf16 v[128:131], v[32:35], v[76:79], v[128:131]
    v_exp_f32 v223, v143
    v_mfma_f32_16x16x32_bf16 v[128:131], v[36:39], v[84:87], v[128:131]
    ds_read_b128 v[32:35], v232 offset:10240
    ds_read_b128 v[36:39], v232 offset:11264
    v_cvt_pk_bf16_f32 v178, v220, v221
    s_waitcnt lgkmcnt(4)
    v_mfma_f32_16x16x32_bf16 v[124:127], v[40:43], v[56:59], v[156:159]
    v_exp_f32 v216, v144
    v_mfma_f32_16x16x32_bf16 v[124:127], v[44:47], v[64:67], v[124:127]
    v_or3_b32 v249, v176, v177, v178
    v_mfma_f32_16x16x32_bf16 v[124:127], v[48:51], v[72:75], v[124:127]
    v_exp_f32 v217, v145
    v_mfma_f32_16x16x32_bf16 v[124:127], v[52:55], v[80:83], v[124:127]
    v_cvt_pk_bf16_f32 v179, v222, v223
    v_mfma_f32_16x16x32_bf16 v[132:135], v[40:43], v[60:63], v[164:167]
    v_exp_f32 v218, v146
    v_mfma_f32_16x16x32_bf16 v[132:135], v[44:47], v[68:71], v[132:135]
    ds_read_b128 v[40:43], v232 offset:12288
    ds_read_b128 v[44:47], v232 offset:13312
    v_mfma_f32_16x16x32_bf16 v[132:135], v[48:51], v[76:79], v[132:135]
    v_exp_f32 v219, v147
    v_mfma_f32_16x16x32_bf16 v[132:135], v[52:55], v[84:87], v[132:135]
    ds_read_b128 v[48:51], v232 offset:14336
    ds_read_b128 v[52:55], v232 offset:15360
    v_cvt_pk_bf16_f32 v180, v216, v217
    s_waitcnt lgkmcnt(4)
    v_mfma_f32_16x16x32_bf16 v[88:91], v[24:27], v[168:171], v[88:91]
    v_exp_f32 v220, v148
    v_mfma_f32_16x16x32_bf16 v[92:95], v[24:27], v[172:175], v[92:95]
    ds_read_b128 v[24:27], v232 offset:16384
    v_or3_b32 v249, v249, v179, v180
    v_mfma_f32_16x16x32_bf16 v[96:99], v[28:31], v[168:171], v[96:99]
    v_exp_f32 v221, v149
    v_mfma_f32_16x16x32_bf16 v[100:103], v[28:31], v[172:175], v[100:103]
    ds_read_b128 v[28:31], v232 offset:17408
    v_cvt_pk_bf16_f32 v181, v218, v219
    v_mfma_f32_16x16x32_bf16 v[104:107], v[32:35], v[168:171], v[104:107]
    v_exp_f32 v222, v150
    v_mfma_f32_16x16x32_bf16 v[108:111], v[32:35], v[172:175], v[108:111]
    ds_read_b128 v[32:35], v232 offset:18432
    v_mfma_f32_16x16x32_bf16 v[224:227], v[252:255], v[168:171], v[224:227]
    s_lshr_b32 s33, s46, 13
    v_add_u32 v240, s33, v242
    v_mfma_f32_16x16x32_bf16 v[112:115], v[36:39], v[168:171], v[112:115]
    v_exp_f32 v223, v151
    v_mfma_f32_16x16x32_bf16 v[116:119], v[36:39], v[172:175], v[116:119]
    ds_read_b128 v[36:39], v232 offset:19456
    v_cvt_pk_bf16_f32 v182, v220, v221
    s_waitcnt lgkmcnt(4)
    v_mfma_f32_16x16x32_bf16 v[184:187], v[40:43], v[168:171], v[184:187]
    v_exp_f32 v216, v120
    v_mfma_f32_16x16x32_bf16 v[188:191], v[40:43], v[172:175], v[188:191]
    ds_read_b128 v[40:43], v232 offset:20480
    v_or3_b32 v249, v249, v181, v182
    v_cvt_pk_bf16_f32 v183, v222, v223
    v_mfma_f32_16x16x32_bf16 v[192:195], v[44:47], v[168:171], v[192:195]
    v_exp_f32 v217, v121
    v_mfma_f32_16x16x32_bf16 v[196:199], v[44:47], v[172:175], v[196:199]
    ds_read_b128 v[44:47], v232 offset:21504
    v_or_b32 v249, v249, v183
    v_and_b32 v249, 0x40004000, v249
    v_add_u32 v245, 1, v245
    ds_read_b32 v241, v240
    v_mfma_f32_16x16x32_bf16 v[200:203], v[48:51], v[168:171], v[200:203]
    v_exp_f32 v218, v122
    v_mfma_f32_16x16x32_bf16 v[204:207], v[48:51], v[172:175], v[204:207]
    ds_read_b128 v[48:51], v232 offset:22528
    v_cmp_ne_u32 vcc, 0, v249
    v_mfma_f32_16x16x32_bf16 v[228:231], v[252:255], v[172:175], v[228:231]
    v_mfma_f32_16x16x32_bf16 v[208:211], v[52:55], v[168:171], v[208:211]
    v_exp_f32 v219, v123
    v_mfma_f32_16x16x32_bf16 v[212:215], v[52:55], v[172:175], v[212:215]
    ds_read_b128 v[52:55], v232 offset:23552
    s_sub_u32 s44, s44, 1
    s_cbranch_vccnz f_fix1
f_ret_fullB1:
    s_cbranch_scc1 f_special0
f_fullB0:
    s_waitcnt lgkmcnt(4)
    v_mfma_f32_16x16x32_bf16 v[136:139], v[24:27], v[56:59], v[152:155]
    v_exp_f32 v220, v124
    v_mfma_f32_16x16x32_bf16 v[136:139], v[28:31], v[64:67], v[136:139]
    v_cvt_pk_bf16_f32 v168, v216, v217
    v_mfma_f32_16x16x32_bf16 v[136:139], v[32:35], v[72:75], v[136:139]
    v_exp_f32 v221, v125
    v_mfma_f32_16x16x32_bf16 v[136:139], v[36:39], v[80:83], v[136:139]
    v_cvt_pk_bf16_f32 v169, v218, v219
    s_waitcnt lgkmcnt(2)
    v_cmp_gt_i32 vcc, v245, v241
    v_mfma_f32_16x16x32_bf16 v[144:147], v[24:27], v[60:63], v[160:163]
    v_exp_f32 v222, v126
    v_mfma_f32_16x16x32_bf16 v[144:147], v[28:31], v[68:71], v[144:147]
    ds_read_b128 v[24:27], v232 offset:24576
    ds_read_b128 v[28:31], v232 offset:25600
    v_mfma_f32_16x16x32_bf16 v[144:147], v[32:35], v[76:79], v[144:147]
    v_exp_f32 v223, v127
    v_mfma_f32_16x16x32_bf16 v[144:147], v[36:39], v[84:87], v[144:147]
    ds_read_b128 v[32:35], v232 offset:26624
    ds_read_b128 v[36:39], v232 offset:27648
    v_cvt_pk_bf16_f32 v170, v220, v221
    s_waitcnt lgkmcnt(4)
    v_mfma_f32_16x16x32_bf16 v[140:143], v[40:43], v[56:59], v[156:159]
    v_exp_f32 v216, v128
    v_mfma_f32_16x16x32_bf16 v[140:143], v[44:47], v[64:67], v[140:143]
    v_or3_b32 v249, v168, v169, v170
    v_mfma_f32_16x16x32_bf16 v[140:143], v[48:51], v[72:75], v[140:143]
    v_exp_f32 v217, v129
    v_mfma_f32_16x16x32_bf16 v[140:143], v[52:55], v[80:83], v[140:143]
    v_cvt_pk_bf16_f32 v171, v222, v223
    v_mfma_f32_16x16x32_bf16 v[148:151], v[40:43], v[60:63], v[164:167]
    v_exp_f32 v218, v130
    v_mfma_f32_16x16x32_bf16 v[148:151], v[44:47], v[68:71], v[148:151]
    ds_read_b128 v[40:43], v232 offset:28672
    ds_read_b128 v[44:47], v232 offset:29696
    v_mfma_f32_16x16x32_bf16 v[148:151], v[48:51], v[76:79], v[148:151]
    v_exp_f32 v219, v131
    v_mfma_f32_16x16x32_bf16 v[148:151], v[52:55], v[84:87], v[148:151]
    ds_read_b128 v[48:51], v232 offset:30720
    ds_read_b128 v[52:55], v232 offset:31744
    v_add_u32 v232, s46, v0
    v_cvt_pk_bf16_f32 v172, v216, v217
    s_waitcnt lgkmcnt(4)
    v_mfma_f32_16x16x32_bf16 v[88:91], v[24:27], v[176:179], v[88:91]
    v_exp_f32 v220, v132
    v_mfma_f32_16x16x32_bf16 v[92:95], v[24:27], v[180:183], v[92:95]
    s_cbranch_vccnz f_fs12
f_fbB:
    ds_read_b128 v[24:27], v232 offset:0
    v_or3_b32 v249, v249, v171, v172
    v_mfma_f32_16x16x32_bf16 v[96:99], v[28:31], v[176:179], v[96:99]
    v_exp_f32 v221, v133
    v_mfma_f32_16x16x32_bf16 v[100:103], v[28:31], v[180:183], v[100:103]
    ds_read_b128 v[28:31], v232 offset:1024
    v_cvt_pk_bf16_f32 v173, v218, v219
    v_mfma_f32_16x16x32_bf16 v[104:107], v[32:35], v[176:179], v[104:107]
    v_exp_f32 v222, v134
    v_mfma_f32_16x16x32_bf16 v[108:111], v[32:35], v[180:183], v[108:111]
    ds_read_b128 v[32:35], v232 offset:2048
    v_mfma_f32_16x16x32_bf16 v[224:227], v[252:255], v[176:179], v[224:227]
    v_mfma_f32_16x16x32_bf16 v[112:115], v[36:39], v[176:179], v[112:115]
    v_exp_f32 v223, v135
    v_mfma_f32_16x16x32_bf16 v[116:119], v[36:39], v[180:183], v[116:119]
    ds_read_b128 v[36:39], v232 offset:3072
    v_cvt_pk_bf16_f32 v174, v220, v221
    s_waitcnt lgkmcnt(4)
    v_mfma_f32_16x16x32_bf16 v[184:187], v[40:43], v[176:179], v[184:187]
    v_exp_f32 v216, v136
    v_mfma_f32_16x16x32_bf16 v[188:191], v[40:43], v[180:183], v[188:191]
    ds_read_b128 v[40:43], v232 offset:4096
    v_or3_b32 v249, v249, v173, v174
    v_cvt_pk_bf16_f32 v175, v222, v223
    v_mfma_f32_16x16x32_bf16 v[192:195], v[44:47], v[176:179], v[192:195]
    v_exp_f32 v217, v137
    v_mfma_f32_16x16x32_bf16 v[196:199], v[44:47], v[180:183], v[196:199]
    ds_read_b128 v[44:47], v232 offset:5120
    v_or_b32 v249, v249, v175
    v_and_b32 v249, 0x40004000, v249
    v_mfma_f32_16x16x32_bf16 v[200:203], v[48:51], v[176:179], v[200:203]
    v_exp_f32 v218, v138
    v_mfma_f32_16x16x32_bf16 v[204:207], v[48:51], v[180:183], v[204:207]
    ds_read_b128 v[48:51], v232 offset:6144
    v_cmp_ne_u32 vcc, 0, v249
    v_mfma_f32_16x16x32_bf16 v[228:231], v[252:255], v[180:183], v[228:231]
    v_mfma_f32_16x16x32_bf16 v[208:211], v[52:55], v[176:179], v[208:211]
    v_exp_f32 v219, v139
    v_mfma_f32_16x16x32_bf16 v[212:215], v[52:55], v[180:183], v[212:215]
    ds_read_b128 v[52:55], v232 offset:7168
    s_sub_u32 s44, s44, 1
    ds_write_b32 v243, v245
    s_cbranch_vccnz f_fix0
f_ret_fullB0:
    s_cbranch_scc0 f_fullB1
    s_branch f_special1
f_fullA1:
    s_waitcnt lgkmcnt(4)
    v_mfma_f32_16x16x32_bf16 v[120:123], v[24:27], v[56:59], v[152:155]
    v_exp_f32 v220, v140
    v_mfma_f32_16x16x32_bf16 v[120:123], v[28:31], v[64:67], v[120:123]
    v_cvt_pk_bf16_f32 v176, v216, v217
    s_add_u32 s46, s46, 32768
    v_mfma_f32_16x16x32_bf16 v[120:123], v[32:35], v[72:75], v[120:123]
    v_exp_f32 v221, v141
    v_mfma_f32_16x16x32_bf16 v[120:123], v[36:39], v[80:83], v[120:123]
    v_cvt_pk_bf16_f32 v177, v218, v219
    s_and_b32 s46, s46, 0x1ffff
    v_mfma_f32_16x16x32_bf16 v[128:131], v[24:27], v[60:63], v[160:163]
    v_exp_f32 v222, v142
    v_mfma_f32_16x16x32_bf16 v[128:131], v[28:31], v[68:71], v[128:131]
    ds_read_b128 v[24:27], v232 offset:8192
    ds_read_b128 v[28:31], v232 offset:9216
    s_cmp_gt_u32 s43, s42
    s_cbranch_scc1 f_ni13
    s_sub_u32 s32, s43, 3
    s_waitcnt lgkmcnt(5)
    v_cmp_gt_i32 vcc, s32, v247
    s_nop 0
    s_cbranch_vccz f_go13
f_sp13:
    s_sub_u32 s38, s38, 1
    s_cselect_b32 s38, 0, s38
    s_cbranch_scc1 f_go13
    ds_read_b32 v247, v244
    s_waitcnt lgkmcnt(0)
    v_cmp_gt_i32 vcc, s32, v247
    s_nop 0
    s_cbranch_vccnz f_sp13
f_go13:
    s_mov_b32 m0, s48
    s_nop 0
    buffer_load_dwordx4 v0, s[28:31], s47 offen offset:0 sc1 lds
    buffer_load_dwordx4 v0, s[28:31], s47 offen offset:1024 sc1 lds
    buffer_load_dwordx4 v0, s[28:31], s47 offen offset:2048 sc1 lds
    buffer_load_dwordx4 v0, s[28:31], s47 offen offset:3072 sc1 lds
    s_add_u32 m0, s48, 4096
    s_nop 0
    buffer_load_dwordx4 v239, s[28:31], s47 offen offset:0 sc1 lds
    buffer_load_dwordx4 v239, s[28:31], s47 offen offset:1024 sc1 lds
    buffer_load_dwordx4 v239, s[28:31], s47 offen offset:2048 sc1 lds
    buffer_load_dwordx4 v239, s[28:31], s47 offen offset:3072 sc1 lds
    s_add_u32 s43, s43, 1
    s_add_u32 s48, s48, 32768
    s_and_b32 s48, s48, 0x1ffff
    s_add_u32 s47, s47, 32768
    s_mov_b32 s52, 1
f_ni13:
    v_mfma_f32_16x16x32_bf16 v[128:131], v[32:35], v[76:79], v[128:131]
    v_exp_f32 v223, v143
    v_mfma_f32_16x16x32_bf16 v[128:131], v[36:39], v[84:87], v[128:131]
    ds_read_b128 v[32:35], v232 offset:10240
    ds_read_b128 v[36:39], v232 offset:11264
    v_cvt_pk_bf16_f32 v178, v220, v221
    s_waitcnt lgkmcnt(4)
    v_mfma_f32_16x16x32_bf16 v[124:127], v[40:43], v[56:59], v[156:159]
    v_exp_f32 v216, v144
    v_mfma_f32_16x16x32_bf16 v[124:127], v[44:47], v[64:67], v[124:127]
    v_or3_b32 v249, v176, v177, v178
    v_mfma_f32_16x16x32_bf16 v[124:127], v[48:51], v[72:75], v[124:127]
    v_exp_f32 v217, v145
    v_mfma_f32_16x16x32_bf16 v[124:127], v[52:55], v[80:83], v[124:127]
    v_cvt_pk_bf16_f32 v179, v222, v223
    v_mfma_f32_16x16x32_bf16 v[132:135], v[40:43], v[60:63], v[164:167]
    v_exp_f32 v218, v146
    v_mfma_f32_16x16x32_bf16 v[132:135], v[44:47], v[68:71], v[132:135]
    ds_read_b128 v[40:43], v232 offset:12288
    ds_read_b128 v[44:47], v232 offset:13312
    v_mfma_f32_16x16x32_bf16 v[132:135], v[48:51], v[76:79], v[132:135]
    v_exp_f32 v219, v147
    v_mfma_f32_16x16x32_bf16 v[132:135], v[52:55], v[84:87], v[132:135]
    ds_read_b128 v[48:51], v232 offset:14336
    ds_read_b128 v[52:55], v232 offset:15360
    v_cvt_pk_bf16_f32 v180, v216, v217
    s_waitcnt lgkmcnt(4)
    v_mfma_f32_16x16x32_bf16 v[88:91], v[24:27], v[168:171], v[88:91]
    v_exp_f32 v220, v148
    v_mfma_f32_16x16x32_bf16 v[92:95], v[24:27], v[172:175], v[92:95]
    ds_read_b128 v[24:27], v232 offset:16384
    v_or3_b32 v249, v249, v179, v180
    v_mfma_f32_16x16x32_bf16 v[96:99], v[28:31], v[168:171], v[96:99]
    v_exp_f32 v221, v149
    v_mfma_f32_16x16x32_bf16 v[100:103], v[28:31], v[172:175], v[100:103]
    ds_read_b128 v[28:31], v232 offset:17408
    v_cvt_pk_bf16_f32 v181, v218, v219
    v_mfma_f32_16x16x32_bf16 v[104:107], v[32:35], v[168:171], v[104:107]
    v_exp_f32 v222, v150
    v_mfma_f32_16x16x32_bf16 v[108:111], v[32:35], v[172:175], v[108:111]
    ds_read_b128 v[32:35], v232 offset:18432
    v_mfma_f32_16x16x32_bf16 v[224:227], v[252:255], v[168:171], v[224:227]
    s_lshr_b32 s33, s46, 13
    v_add_u32 v240, s33, v242
    v_mfma_f32_16x16x32_bf16 v[112:115], v[36:39], v[168:171], v[112:115]
    v_exp_f32 v223, v151
    v_mfma_f32_16x16x32_bf16 v[116:119], v[36:39], v[172:175], v[116:119]
    ds_read_b128 v[36:39], v232 offset:19456
    v_cvt_pk_bf16_f32 v182, v220, v221
    s_waitcnt lgkmcnt(4)
    v_mfma_f32_16x16x32_bf16 v[184:187], v[40:43], v[168:171], v[184:187]
    v_exp_f32 v216, v120
    v_mfma_f32_16x16x32_bf16 v[188:191], v[40:43], v[172:175], v[188:191]
    ds_read_b128 v[40:43], v232 offset:20480
    v_or3_b32 v249, v249, v181, v182
    v_cvt_pk_bf16_f32 v183, v222, v223
    v_mfma_f32_16x16x32_bf16 v[192:195], v[44:47], v[168:171], v[192:195]
    v_exp_f32 v217, v121
    v_mfma_f32_16x16x32_bf16 v[196:199], v[44:47], v[172:175], v[196:199]
    ds_read_b128 v[44:47], v232 offset:21504
    v_or_b32 v249, v249, v183
    v_and_b32 v249, 0x40004000, v249
    v_add_u32 v245, 1, v245
    ds_read_b32 v241, v240
    v_mfma_f32_16x16x32_bf16 v[200:203], v[48:51], v[168:171], v[200:203]
    v_exp_f32 v218, v122
    v_mfma_f32_16x16x32_bf16 v[204:207], v[48:51], v[172:175], v[204:207]
    ds_read_b128 v[48:51], v232 offset:22528
    v_cmp_ne_u32 vcc, 0, v249
    v_mfma_f32_16x16x32_bf16 v[228:231], v[252:255], v[172:175], v[228:231]
    v_mfma_f32_16x16x32_bf16 v[208:211], v[52:55], v[168:171], v[208:211]
    v_exp_f32 v219, v123
    v_mfma_f32_16x16x32_bf16 v[212:215], v[52:55], v[172:175], v[212:215]
    ds_read_b128 v[52:55], v232 offset:23552
    s_sub_u32 s44, s44, 1
    s_cbranch_vccnz f_fix1
f_ret_fullA1:
    s_cbranch_scc1 f_special0
f_fullA0:
    s_waitcnt lgkmcnt(4)
    v_mfma_f32_16x16x32_bf16 v[136:139], v[24:27], v[56:59], v[152:155]
    v_exp_f32 v220, v124
    v_mfma_f32_16x16x32_bf16 v[136:139], v[28:31], v[64:67], v[136:139]
    v_cvt_pk_bf16_f32 v168, v216, v217
    s_cmp_eq_u32 s52, 0
    s_cbranch_scc1 f_nf14
    s_add_u32 s32, s43, 1
    s_and_b32 s32, s32, 3
    s_lshl_b32 s32, s32, 2
    s_add_u32 s32, s32, 131072
    v_mov_b32 v3, s32
    s_mov_b32 s52, 0
    s_waitcnt vmcnt(0)
    s_mov_b64 exec, 1
    ds_add_u32 v3, v246
    s_mov_b64 exec, -1
f_nf14:
    v_mfma_f32_16x16x32_bf16 v[136:139], v[32:35], v[72:75], v[136:139]
    v_exp_f32 v221, v125
    v_mfma_f32_16x16x32_bf16 v[136:139], v[36:39], v[80:83], v[136:139]
    v_cvt_pk_bf16_f32 v169, v218, v219
    s_waitcnt lgkmcnt(2)
    v_cmp_gt_i32 vcc, v245, v241
    v_mfma_f32_16x16x32_bf16 v[144:147], v[24:27], v[60:63], v[160:163]
    v_exp_f32 v222, v126
    v_mfma_f32_16x16x32_bf16 v[144:147], v[28:31], v[68:71], v[144:147]
    ds_read_b128 v[24:27], v232 offset:24576
    ds_read_b128 v[28:31], v232 offset:25600
    v_mfma_f32_16x16x32_bf16 v[144:147], v[32:35], v[76:79], v[144:147]
    v_exp_f32 v223, v127
    v_mfma_f32_16x16x32_bf16 v[144:147], v[36:39], v[84:87], v[144:147]
    ds_read_b128 v[32:35], v232 offset:26624
    ds_read_b128 v[36:39], v232 offset:27648
    v_cvt_pk_bf16_f32 v170, v220, v221
    s_waitcnt lgkmcnt(4)
    v_mfma_f32_16x16x32_bf16 v[140:143], v[40:43], v[56:59], v[156:159]
    v_exp_f32 v216, v128
    v_mfma_f32_16x16x32_bf16 v[140:143], v[44:47], v[64:67], v[140:143]
    v_or3_b32 v249, v168, v169, v170
    v_mfma_f32_16x16x32_bf16 v[140:143], v[48:51], v[72:75], v[140:143]
    v_exp_f32 v217, v129
    v_mfma_f32_16x16x32_bf16 v[140:143], v[52:55], v[80:83], v[140:143]
    v_cvt_pk_bf16_f32 v171, v222, v223
    v_mfma_f32_16x16x32_bf16 v[148:151], v[40:43], v[60:63], v[164:167]
    v_exp_f32 v218, v130
    v_mfma_f32_16x16x32_bf16 v[148:151], v[44:47], v[68:71], v[148:151]
    ds_read_b128 v[40:43], v232 offset:28672
    ds_read_b128 v[44:47], v232 offset:29696
    v_mfma_f32_16x16x32_bf16 v[148:151], v[48:51], v[76:79], v[148:151]
    v_exp_f32 v219, v131
    v_mfma_f32_16x16x32_bf16 v[148:151], v[52:55], v[84:87], v[148:151]
    ds_read_b128 v[48:51], v232 offset:30720
    ds_read_b128 v[52:55], v232 offset:31744
    v_add_u32 v232, s46, v0
    v_cvt_pk_bf16_f32 v172, v216, v217
    s_waitcnt lgkmcnt(4)
    v_mfma_f32_16x16x32_bf16 v[88:91], v[24:27], v[176:179], v[88:91]
    v_exp_f32 v220, v132
    v_mfma_f32_16x16x32_bf16 v[92:95], v[24:27], v[180:183], v[92:95]
    s_cbranch_vccnz f_fs15
f_fbA:
    ds_read_b128 v[24:27], v232 offset:0
    v_or3_b32 v249, v249, v171, v172
    v_mfma_f32_16x16x32_bf16 v[96:99], v[28:31], v[176:179], v[96:99]
    v_exp_f32 v221, v133
    v_mfma_f32_16x16x32_bf16 v[100:103], v[28:31], v[180:183], v[100:103]
    ds_read_b128 v[28:31], v232 offset:1024
    v_cvt_pk_bf16_f32 v173, v218, v219
    v_mfma_f32_16x16x32_bf16 v[104:107], v[32:35], v[176:179], v[104:107]
    v_exp_f32 v222, v134
    v_mfma_f32_16x16x32_bf16 v[108:111], v[32:35], v[180:183], v[108:111]
    ds_read_b128 v[32:35], v232 offset:2048
    v_mfma_f32_16x16x32_bf16 v[224:227], v[252:255], v[176:179], v[224:227]
    v_mfma_f32_16x16x32_bf16 v[112:115], v[36:39], v[176:179], v[112:115]
    v_exp_f32 v223, v135
    v_mfma_f32_16x16x32_bf16 v[116:119], v[36:39], v[180:183], v[116:119]
    ds_read_b128 v[36:39], v232 offset:3072
    v_cvt_pk_bf16_f32 v174, v220, v221
    s_waitcnt lgkmcnt(4)
    v_mfma_f32_16x16x32_bf16 v[184:187], v[40:43], v[176:179], v[184:187]
    v_exp_f32 v216, v136
    v_mfma_f32_16x16x32_bf16 v[188:191], v[40:43], v[180:183], v[188:191]
    ds_read_b128 v[40:43], v232 offset:4096
    v_or3_b32 v249, v249, v173, v174
    v_cvt_pk_bf16_f32 v175, v222, v223
    v_mfma_f32_16x16x32_bf16 v[192:195], v[44:47], v[176:179], v[192:195]
    v_exp_f32 v217, v137
    v_mfma_f32_16x16x32_bf16 v[196:199], v[44:47], v[180:183], v[196:199]
    ds_read_b128 v[44:47], v232 offset:5120
    v_or_b32 v249, v249, v175
    v_and_b32 v249, 0x40004000, v249
    ds_read_b32 v247, v244
    v_mfma_f32_16x16x32_bf16 v[200:203], v[48:51], v[176:179], v[200:203]
    v_exp_f32 v218, v138
    v_mfma_f32_16x16x32_bf16 v[204:207], v[48:51], v[180:183], v[204:207]
    ds_read_b128 v[48:51], v232 offset:6144
    v_cmp_ne_u32 vcc, 0, v249
    v_mfma_f32_16x16x32_bf16 v[228:231], v[252:255], v[180:183], v[228:231]
    v_mfma_f32_16x16x32_bf16 v[208:211], v[52:55], v[176:179], v[208:211]
    v_exp_f32 v219, v139
    v_mfma_f32_16x16x32_bf16 v[212:215], v[52:55], v[180:183], v[212:215]
    ds_read_b128 v[52:55], v232 offset:7168
    s_sub_u32 s44, s44, 1
    ds_write_b32 v243, v245
    s_cbranch_vccnz f_fix0
f_ret_fullA0:
    s_cbranch_scc0 f_fullA1
f_special1:
    s_cmp_lg_u32 s50, 0
    s_cbranch_scc1 f_noqk1
    s_mov_b32 s50, 1
    s_mov_b32 s44, 0
    v_cmp_gt_i32 s[58:59], 0, v233
    v_cmp_gt_i32 s[60:61], 1, v233
    v_cmp_gt_i32 s[62:63], 2, v233
    v_cndmask_b32 v152, v152, v234, s[58:59]
    v_cndmask_b32 v153, v153, v234, s[60:61]
    v_cndmask_b32 v154, v154, v234, s[62:63]
    v_cmp_gt_i32 s[58:59], 3, v233
    v_cmp_gt_i32 s[60:61], 16, v233
    v_cmp_gt_i32 s[62:63], 17, v233
    v_cndmask_b32 v155, v155, v234, s[58:59]
    v_cndmask_b32 v156, v156, v234, s[60:61]
    v_cndmask_b32 v157, v157, v234, s[62:63]
    v_cmp_gt_i32 s[58:59], 18, v233
    v_cmp_gt_i32 s[60:61], 19, v233
    v_cmp_gt_i32 s[62:63], -16, v233
    v_cndmask_b32 v158, v158, v234, s[58:59]
    v_cndmask_b32 v159, v159, v234, s[60:61]
    v_cndmask_b32 v160, v160, v234, s[62:63]
    v_cmp_gt_i32 s[58:59], -15, v233
    v_cmp_gt_i32 s[60:61], -14, v233
    v_cmp_gt_i32 s[62:63], -13, v233
    v_cndmask_b32 v161, v161, v234, s[58:59]
    v_cndmask_b32 v162, v162, v234, s[60:61]
    v_cndmask_b32 v163, v163, v234, s[62:63]
    v_cmp_gt_i32 s[58:59], 0, v233
    v_cmp_gt_i32 s[60:61], 1, v233
    v_cmp_gt_i32 s[62:63], 2, v233
    v_cndmask_b32 v164, v164, v234, s[58:59]
    v_cndmask_b32 v165, v165, v234, s[60:61]
    v_cndmask_b32 v166, v166, v234, s[62:63]
    v_cmp_gt_i32 s[58:59], 3, v233
    s_nop 1
    v_cndmask_b32 v167, v167, v234, s[58:59]
    s_cmp_eq_u32 s41, 0
    s_cbranch_scc1 f_fullA1
    s_branch f_fullB1
f_special0:
    s_cmp_lg_u32 s50, 0
    s_cbranch_scc1 f_noqk0
    s_mov_b32 s50, 1
    s_mov_b32 s44, 0
    v_cmp_gt_i32 s[58:59], 0, v233
    v_cmp_gt_i32 s[60:61], 1, v233
    v_cmp_gt_i32 s[62:63], 2, v233
    v_cndmask_b32 v152, v152, v234, s[58:59]
    v_cndmask_b32 v153, v153, v234, s[60:61]
    v_cndmask_b32 v154, v154, v234, s[62:63]
    v_cmp_gt_i32 s[58:59], 3, v233
    v_cmp_gt_i32 s[60:61], 16, v233
    v_cmp_gt_i32 s[62:63], 17, v233
    v_cndmask_b32 v155, v155, v234, s[58:59]
    v_cndmask_b32 v156, v156, v234, s[60:61]
    v_cndmask_b32 v157, v157, v234, s[62:63]
    v_cmp_gt_i32 s[58:59], 18, v233
    v_cmp_gt_i32 s[60:61], 19, v233
    v_cmp_gt_i32 s[62:63], -16, v233
    v_cndmask_b32 v158, v158, v234, s[58:59]
    v_cndmask_b32 v159, v159, v234, s[60:61]
    v_cndmask_b32 v160, v160, v234, s[62:63]
    v_cmp_gt_i32 s[58:59], -15, v233
    v_cmp_gt_i32 s[60:61], -14, v233
    v_cmp_gt_i32 s[62:63], -13, v233
    v_cndmask_b32 v161, v161, v234, s[58:59]
    v_cndmask_b32 v162, v162, v234, s[60:61]
    v_cndmask_b32 v163, v163, v234, s[62:63]
    v_cmp_gt_i32 s[58:59], 0, v233
    v_cmp_gt_i32 s[60:61], 1, v233
    v_cmp_gt_i32 s[62:63], 2, v233
    v_cndmask_b32 v164, v164, v234, s[58:59]
    v_cndmask_b32 v165, v165, v234, s[60:61]
    v_cndmask_b32 v166, v166, v234, s[62:63]
    v_cmp_gt_i32 s[58:59], 3, v233
    s_nop 1
    v_cndmask_b32 v167, v167, v234, s[58:59]
    s_cmp_eq_u32 s41, 0
    s_cbranch_scc1 f_fullA0
    s_branch f_fullB0
f_noqk1:
    s_mov_b32 s45, 1
    ds_read_b128 v[24:27], v232 offset:8192
    ds_read_b128 v[28:31], v232 offset:9216
    ds_read_b128 v[32:35], v232 offset:10240
    ds_read_b128 v[36:39], v232 offset:11264
    ds_read_b128 v[40:43], v232 offset:12288
    ds_read_b128 v[44:47], v232 offset:13312
    ds_read_b128 v[48:51], v232 offset:14336
    ds_read_b128 v[52:55], v232 offset:15360
    s_cmp_lg_u32 s41, 0
    s_cbranch_scc1 f_rb16
    s_cmp_gt_u32 s43, s42
    s_cbranch_scc1 f_ni17
    s_sub_u32 s32, s43, 3
f_sp17:
    s_sub_u32 s38, s38, 1
    s_cselect_b32 s38, 0, s38
    s_cbranch_scc1 f_go17
    ds_read_b32 v247, v244
    s_waitcnt lgkmcnt(0)
    v_cmp_gt_i32 vcc, s32, v247
    s_nop 0
    s_cbranch_vccnz f_sp17
f_go17:
    s_mov_b32 m0, s48
    s_nop 0
    buffer_load_dwordx4 v0, s[28:31], s47 offen offset:0 sc1 lds
    buffer_load_dwordx4 v0, s[28:31], s47 offen offset:1024 sc1 lds
    buffer_load_dwordx4 v0, s[28:31], s47 offen offset:2048 sc1 lds
    buffer_load_dwordx4 v0, s[28:31], s47 offen offset:3072 sc1 lds
    s_add_u32 m0, s48, 4096
    s_nop 0
    buffer_load_dwordx4 v239, s[28:31], s47 offen offset:0 sc1 lds
    buffer_load_dwordx4 v239, s[28:31], s47 offen offset:1024 sc1 lds
    buffer_load_dwordx4 v239, s[28:31], s47 offen offset:2048 sc1 lds
    buffer_load_dwordx4 v239, s[28:31], s47 offen offset:3072 sc1 lds
    s_add_u32 s43, s43, 1
    s_add_u32 s48, s48, 32768
    s_and_b32 s48, s48, 0x1ffff
    s_add_u32 s47, s47, 32768
    s_mov_b32 s52, 1
f_ni17:
f_rb16:
    v_exp_f32 v220, v140
    v_cvt_pk_bf16_f32 v176, v216, v217
    v_exp_f32 v221, v141
    v_cvt_pk_bf16_f32 v177, v218, v219
    v_exp_f32 v222, v142
    v_exp_f32 v223, v143
    v_cvt_pk_bf16_f32 v178, v220, v221
    v_exp_f32 v216, v144
    v_or3_b32 v249, v176, v177, v178
    v_exp_f32 v217, v145
    v_cvt_pk_bf16_f32 v179, v222, v223
    v_exp_f32 v218, v146
    v_exp_f32 v219, v147
    v_cvt_pk_bf16_f32 v180, v216, v217
    s_waitcnt lgkmcnt(7)
    v_mfma_f32_16x16x32_bf16 v[88:91], v[24:27], v[168:171], v[88:91]
    v_mfma_f32_16x16x32_bf16 v[92:95], v[24:27], v[172:175], v[92:95]
    v_mfma_f32_16x16x32_bf16 v[224:227], v[252:255], v[168:171], v[224:227]
    ds_read_b128 v[24:27], v232 offset:24576
    v_exp_f32 v220, v148
    v_or3_b32 v249, v249, v179, v180
    s_waitcnt lgkmcnt(7)
    v_mfma_f32_16x16x32_bf16 v[96:99], v[28:31], v[168:171], v[96:99]
    v_mfma_f32_16x16x32_bf16 v[100:103], v[28:31], v[172:175], v[100:103]
    v_mfma_f32_16x16x32_bf16 v[228:231], v[252:255], v[172:175], v[228:231]
    ds_read_b128 v[28:31], v232 offset:25600
    v_exp_f32 v221, v149
    v_cvt_pk_bf16_f32 v181, v218, v219
    s_waitcnt lgkmcnt(7)
    v_mfma_f32_16x16x32_bf16 v[104:107], v[32:35], v[168:171], v[104:107]
    v_mfma_f32_16x16x32_bf16 v[108:111], v[32:35], v[172:175], v[108:111]
    ds_read_b128 v[32:35], v232 offset:26624
    v_exp_f32 v222, v150
    s_waitcnt lgkmcnt(7)
    v_mfma_f32_16x16x32_bf16 v[112:115], v[36:39], v[168:171], v[112:115]
    v_mfma_f32_16x16x32_bf16 v[116:119], v[36:39], v[172:175], v[116:119]
    ds_read_b128 v[36:39], v232 offset:27648
    v_exp_f32 v223, v151
    v_cvt_pk_bf16_f32 v182, v220, v221
    s_waitcnt lgkmcnt(7)
    v_mfma_f32_16x16x32_bf16 v[184:187], v[40:43], v[168:171], v[184:187]
    v_mfma_f32_16x16x32_bf16 v[188:191], v[40:43], v[172:175], v[188:191]
    ds_read_b128 v[40:43], v232 offset:28672
    v_or3_b32 v249, v249, v181, v182
    v_cvt_pk_bf16_f32 v183, v222, v223
    s_waitcnt lgkmcnt(7)
    v_mfma_f32_16x16x32_bf16 v[192:195], v[44:47], v[168:171], v[192:195]
    v_mfma_f32_16x16x32_bf16 v[196:199], v[44:47], v[172:175], v[196:199]
    ds_read_b128 v[44:47], v232 offset:29696
    v_or_b32 v249, v249, v183
    v_and_b32 v249, 0x40004000, v249
    s_waitcnt lgkmcnt(7)
    v_mfma_f32_16x16x32_bf16 v[200:203], v[48:51], v[168:171], v[200:203]
    v_mfma_f32_16x16x32_bf16 v[204:207], v[48:51], v[172:175], v[204:207]
    ds_read_b128 v[48:51], v232 offset:30720
    v_cmp_ne_u32 vcc, 0, v249
    s_waitcnt lgkmcnt(7)
    v_mfma_f32_16x16x32_bf16 v[208:211], v[52:55], v[168:171], v[208:211]
    v_mfma_f32_16x16x32_bf16 v[212:215], v[52:55], v[172:175], v[212:215]
    ds_read_b128 v[52:55], v232 offset:31744
    s_cbranch_vccnz f_fix1
f_ret_noqk1:
    s_waitcnt lgkmcnt(7)
    v_mfma_f32_16x16x32_bf16 v[88:91], v[24:27], v[176:179], v[88:91]
    v_mfma_f32_16x16x32_bf16 v[92:95], v[24:27], v[180:183], v[92:95]
    v_mfma_f32_16x16x32_bf16 v[224:227], v[252:255], v[176:179], v[224:227]
    s_waitcnt lgkmcnt(6)
    v_mfma_f32_16x16x32_bf16 v[96:99], v[28:31], v[176:179], v[96:99]
    v_mfma_f32_16x16x32_bf16 v[100:103], v[28:31], v[180:183], v[100:103]
    v_mfma_f32_16x16x32_bf16 v[228:231], v[252:255], v[180:183], v[228:231]
    s_waitcnt lgkmcnt(5)
    v_mfma_f32_16x16x32_bf16 v[104:107], v[32:35], v[176:179], v[104:107]
    v_mfma_f32_16x16x32_bf16 v[108:111], v[32:35], v[180:183], v[108:111]
    s_waitcnt lgkmcnt(4)
    v_mfma_f32_16x16x32_bf16 v[112:115], v[36:39], v[176:179], v[112:115]
    v_mfma_f32_16x16x32_bf16 v[116:119], v[36:39], v[180:183], v[116:119]
    s_waitcnt lgkmcnt(3)
    v_mfma_f32_16x16x32_bf16 v[184:187], v[40:43], v[176:179], v[184:187]
    v_mfma_f32_16x16x32_bf16 v[188:191], v[40:43], v[180:183], v[188:191]
    s_waitcnt lgkmcnt(2)
    v_mfma_f32_16x16x32_bf16 v[192:195], v[44:47], v[176:179], v[192:195]
    v_mfma_f32_16x16x32_bf16 v[196:199], v[44:47], v[180:183], v[196:199]
    s_waitcnt lgkmcnt(1)
    v_mfma_f32_16x16x32_bf16 v[200:203], v[48:51], v[176:179], v[200:203]
    v_mfma_f32_16x16x32_bf16 v[204:207], v[48:51], v[180:183], v[204:207]
    s_waitcnt lgkmcnt(0)
    v_mfma_f32_16x16x32_bf16 v[208:211], v[52:55], v[176:179], v[208:211]
    v_mfma_f32_16x16x32_bf16 v[212:215], v[52:55], v[180:183], v[212:215]
    s_branch f_fin
f_fix0:
    v_max3_f32 v1, v120, v121, v122
    v_max3_f32 v1, v1, v123, v124
    v_max3_f32 v1, v1, v125, v126
    v_max_f32 v1, v1, v127
    v_max3_f32 v2, v128, v129, v130
    v_max3_f32 v2, v2, v131, v132
    v_max3_f32 v2, v2, v133, v134
    v_max_f32 v2, v2, v135
    v_mov_b32 v3, v1
    v_mov_b32 v250, v2
    s_nop 0
    v_permlane16_swap_b32 v1, v3
    v_permlane16_swap_b32 v2, v250
    v_max_f32 v1, v1, v3
    v_max_f32 v2, v2, v250
    v_mov_b32 v3, v1
    v_mov_b32 v250, v2
    s_nop 0
    v_permlane32_swap_b32 v1, v3
    v_permlane32_swap_b32 v2, v250
    v_max_f32 v1, v1, v3
    v_max_f32 v2, v2, v250
    v_add_f32 v1, 0x41a80000, v1
    v_add_f32 v2, 0x41a80000, v2
    v_max_f32 v1, v1, v235
    v_max_f32 v2, v2, v235
    v_mov_b32 v235, 0
    v_min_f32 v3, -v1, 0
    v_min_f32 v250, -v2, 0
    v_exp_f32 v3, v3
    v_exp_f32 v250, v250
    v_sub_f32 v120, v120, v1
    v_sub_f32 v121, v121, v1
    v_sub_f32 v122, v122, v1
    v_sub_f32 v123, v123, v1
    v_sub_f32 v124, v124, v1
    v_sub_f32 v125, v125, v1
    v_sub_f32 v126, v126, v1
    v_sub_f32 v127, v127, v1
    v_sub_f32 v128, v128, v2
    v_sub_f32 v129, v129, v2
    v_sub_f32 v130, v130, v2
    v_sub_f32 v131, v131, v2
    v_sub_f32 v132, v132, v2
    v_sub_f32 v133, v133, v2
    v_sub_f32 v134, v134, v2
    v_sub_f32 v135, v135, v2
    v_exp_f32 v120, v120
    v_exp_f32 v121, v121
    v_exp_f32 v122, v122
    v_exp_f32 v123, v123
    v_exp_f32 v124, v124
    v_exp_f32 v125, v125
    v_exp_f32 v126, v126
    v_exp_f32 v127, v127
    v_exp_f32 v128, v128
    v_exp_f32 v129, v129
    v_exp_f32 v130, v130
    v_exp_f32 v131, v131
    v_exp_f32 v132, v132
    v_exp_f32 v133, v133
    v_exp_f32 v134, v134
    v_exp_f32 v135, v135
    v_sub_f32 v152, v152, v1
    v_sub_f32 v153, v153, v1
    v_sub_f32 v154, v154, v1
    v_sub_f32 v155, v155, v1
    v_sub_f32 v156, v156, v1
    v_sub_f32 v157, v157, v1
    v_sub_f32 v158, v158, v1
    v_sub_f32 v159, v159, v1
    v_sub_f32 v160, v160, v2
    v_sub_f32 v161, v161, v2
    v_sub_f32 v162, v162, v2
    v_sub_f32 v163, v163, v2
    v_sub_f32 v164, v164, v2
    v_sub_f32 v165, v165, v2
    v_sub_f32 v166, v166, v2
    v_sub_f32 v167, v167, v2
    v_sub_f32 v136, v136, v1
    v_sub_f32 v137, v137, v1
    v_sub_f32 v138, v138, v1
    v_sub_f32 v139, v139, v1
    v_sub_f32 v140, v140, v1
    v_sub_f32 v141, v141, v1
    v_sub_f32 v142, v142, v1
    v_sub_f32 v143, v143, v1
    v_sub_f32 v144, v144, v2
    v_sub_f32 v145, v145, v2
    v_sub_f32 v146, v146, v2
    v_sub_f32 v147, v147, v2
    v_sub_f32 v148, v148, v2
    v_sub_f32 v149, v149, v2
    v_sub_f32 v150, v150, v2
    v_sub_f32 v151, v151, v2
    v_cvt_pk_bf16_f32 v168, v120, v121
    v_cvt_pk_bf16_f32 v169, v122, v123
    v_cvt_pk_bf16_f32 v170, v124, v125
    v_cvt_pk_bf16_f32 v171, v126, v127
    v_cvt_pk_bf16_f32 v172, v128, v129
    v_cvt_pk_bf16_f32 v173, v130, v131
    v_cvt_pk_bf16_f32 v174, v132, v133
    v_cvt_pk_bf16_f32 v175, v134, v135
    v_mul_f32 v224, v224, v3
    v_mul_f32 v225, v225, v3
    v_mul_f32 v226, v226, v3
    v_mul_f32 v227, v227, v3
    v_mul_f32 v228, v228, v250
    v_mul_f32 v229, v229, v250
    v_mul_f32 v230, v230, v250
    v_mul_f32 v231, v231, v250
    v_exp_f32 v216, v136
    v_exp_f32 v217, v137
    v_exp_f32 v218, v138
    v_exp_f32 v219, v139
    s_cmp_eq_u32 s45, 2
    s_cbranch_scc1 f_ret_p0
    v_mul_f32 v88, v88, v3
    v_mul_f32 v89, v89, v3
    v_mul_f32 v90, v90, v3
    v_mul_f32 v91, v91, v3
    v_mul_f32 v92, v92, v250
    v_mul_f32 v93, v93, v250
    v_mul_f32 v94, v94, v250
    v_mul_f32 v95, v95, v250
    v_mul_f32 v96, v96, v3
    v_mul_f32 v97, v97, v3
    v_mul_f32 v98, v98, v3
    v_mul_f32 v99, v99, v3
    v_mul_f32 v100, v100, v250
    v_mul_f32 v101, v101, v250
    v_mul_f32 v102, v102, v250
    v_mul_f32 v103, v103, v250
    v_mul_f32 v104, v104, v3
    v_mul_f32 v105, v105, v3
    v_mul_f32 v106, v106, v3
    v_mul_f32 v107, v107, v3
    v_mul_f32 v108, v108, v250
    v_mul_f32 v109, v109, v250
    v_mul_f32 v110, v110, v250
    v_mul_f32 v111, v111, v250
    v_mul_f32 v112, v112, v3
    v_mul_f32 v113, v113, v3
    v_mul_f32 v114, v114, v3
    v_mul_f32 v115, v115, v3
    v_mul_f32 v116, v116, v250
    v_mul_f32 v117, v117, v250
    v_mul_f32 v118, v118, v250
    v_mul_f32 v119, v119, v250
    v_mul_f32 v184, v184, v3
    v_mul_f32 v185, v185, v3
    v_mul_f32 v186, v186, v3
    v_mul_f32 v187, v187, v3
    v_mul_f32 v188, v188, v250
    v_mul_f32 v189, v189, v250
    v_mul_f32 v190, v190, v250
    v_mul_f32 v191, v191, v250
    v_mul_f32 v192, v192, v3
    v_mul_f32 v193, v193, v3
    v_mul_f32 v194, v194, v3
    v_mul_f32 v195, v195, v3
    v_mul_f32 v196, v196, v250
    v_mul_f32 v197, v197, v250
    v_mul_f32 v198, v198, v250
    v_mul_f32 v199, v199, v250
    v_mul_f32 v200, v200, v3
    v_mul_f32 v201, v201, v3
    v_mul_f32 v202, v202, v3
    v_mul_f32 v203, v203, v3
    v_mul_f32 v204, v204, v250
    v_mul_f32 v205, v205, v250
    v_mul_f32 v206, v206, v250
    v_mul_f32 v207, v207, v250
    v_mul_f32 v208, v208, v3
    v_mul_f32 v209, v209, v3
    v_mul_f32 v210, v210, v3
    v_mul_f32 v211, v211, v3
    v_mul_f32 v212, v212, v250
    v_mul_f32 v213, v213, v250
    v_mul_f32 v214, v214, v250
    v_mul_f32 v215, v215, v250
    s_cmp_eq_u32 s45, 1
    s_cbranch_scc1 f_ret_noqk0
    s_cmp_eq_u32 s41, 0
    s_cbranch_scc1 f_fixa0
    s_cmp_eq_u32 s44, -1
    s_branch f_ret_fullB0
f_fixa0:
    s_cmp_eq_u32 s44, -1
    s_branch f_ret_fullA0
f_fix1:
    v_max3_f32 v1, v136, v137, v138
    v_max3_f32 v1, v1, v139, v140
    v_max3_f32 v1, v1, v141, v142
    v_max_f32 v1, v1, v143
    v_max3_f32 v2, v144, v145, v146
    v_max3_f32 v2, v2, v147, v148
    v_max3_f32 v2, v2, v149, v150
    v_max_f32 v2, v2, v151
    v_mov_b32 v3, v1
    v_mov_b32 v250, v2
    s_nop 0
    v_permlane16_swap_b32 v1, v3
    v_permlane16_swap_b32 v2, v250
    v_max_f32 v1, v1, v3
    v_max_f32 v2, v2, v250
    v_mov_b32 v3, v1
    v_mov_b32 v250, v2
    s_nop 0
    v_permlane32_swap_b32 v1, v3
    v_permlane32_swap_b32 v2, v250
    v_max_f32 v1, v1, v3
    v_max_f32 v2, v2, v250
    v_add_f32 v1, 0x41a80000, v1
    v_add_f32 v2, 0x41a80000, v2
    v_max_f32 v1, v1, v235
    v_max_f32 v2, v2, v235
    v_mov_b32 v235, 0
    v_min_f32 v3, -v1, 0
    v_min_f32 v250, -v2, 0
    v_exp_f32 v3, v3
    v_exp_f32 v250, v250
    v_sub_f32 v136, v136, v1
    v_sub_f32 v137, v137, v1
    v_sub_f32 v138, v138, v1
    v_sub_f32 v139, v139, v1
    v_sub_f32 v140, v140, v1
    v_sub_f32 v141, v141, v1
    v_sub_f32 v142, v142, v1
    v_sub_f32 v143, v143, v1
    v_sub_f32 v144, v144, v2
    v_sub_f32 v145, v145, v2
    v_sub_f32 v146, v146, v2
    v_sub_f32 v147, v147, v2
    v_sub_f32 v148, v148, v2
    v_sub_f32 v149, v149, v2
    v_sub_f32 v150, v150, v2
    v_sub_f32 v151, v151, v2
    v_exp_f32 v136, v136
    v_exp_f32 v137, v137
    v_exp_f32 v138, v138
    v_exp_f32 v139, v139
    v_exp_f32 v140, v140
    v_exp_f32 v141, v141
    v_exp_f32 v142, v142
    v_exp_f32 v143, v143
    v_exp_f32 v144, v144
    v_exp_f32 v145, v145
    v_exp_f32 v146, v146
    v_exp_f32 v147, v147
    v_exp_f32 v148, v148
    v_exp_f32 v149, v149
    v_exp_f32 v150, v150
    v_exp_f32 v151, v151
    v_sub_f32 v152, v152, v1
    v_sub_f32 v153, v153, v1
    v_sub_f32 v154, v154, v1
    v_sub_f32 v155, v155, v1
    v_sub_f32 v156, v156, v1
    v_sub_f32 v157, v157, v1
    v_sub_f32 v158, v158, v1
    v_sub_f32 v159, v159, v1
    v_sub_f32 v160, v160, v2
    v_sub_f32 v161, v161, v2
    v_sub_f32 v162, v162, v2
    v_sub_f32 v163, v163, v2
    v_sub_f32 v164, v164, v2
    v_sub_f32 v165, v165, v2
    v_sub_f32 v166, v166, v2
    v_sub_f32 v167, v167, v2
    v_sub_f32 v120, v120, v1
    v_sub_f32 v121, v121, v1
    v_sub_f32 v122, v122, v1
    v_sub_f32 v123, v123, v1
    v_sub_f32 v124, v124, v1
    v_sub_f32 v125, v125, v1
    v_sub_f32 v126, v126, v1
    v_sub_f32 v127, v127, v1
    v_sub_f32 v128, v128, v2
    v_sub_f32 v129, v129, v2
    v_sub_f32 v130, v130, v2
    v_sub_f32 v131, v131, v2
    v_sub_f32 v132, v132, v2
    v_sub_f32 v133, v133, v2
    v_sub_f32 v134, v134, v2
    v_sub_f32 v135, v135, v2
    v_cvt_pk_bf16_f32 v176, v136, v137
    v_cvt_pk_bf16_f32 v177, v138, v139
    v_cvt_pk_bf16_f32 v178, v140, v141
    v_cvt_pk_bf16_f32 v179, v142, v143
    v_cvt_pk_bf16_f32 v180, v144, v145
    v_cvt_pk_bf16_f32 v181, v146, v147
    v_cvt_pk_bf16_f32 v182, v148, v149
    v_cvt_pk_bf16_f32 v183, v150, v151
    v_mul_f32 v224, v224, v3
    v_mul_f32 v225, v225, v3
    v_mul_f32 v226, v226, v3
    v_mul_f32 v227, v227, v3
    v_mul_f32 v228, v228, v250
    v_mul_f32 v229, v229, v250
    v_mul_f32 v230, v230, v250
    v_mul_f32 v231, v231, v250
    v_exp_f32 v216, v120
    v_exp_f32 v217, v121
    v_exp_f32 v218, v122
    v_exp_f32 v219, v123
    v_mul_f32 v88, v88, v3
    v_mul_f32 v89, v89, v3
    v_mul_f32 v90, v90, v3
    v_mul_f32 v91, v91, v3
    v_mul_f32 v92, v92, v250
    v_mul_f32 v93, v93, v250
    v_mul_f32 v94, v94, v250
    v_mul_f32 v95, v95, v250
    v_mul_f32 v96, v96, v3
    v_mul_f32 v97, v97, v3
    v_mul_f32 v98, v98, v3
    v_mul_f32 v99, v99, v3
    v_mul_f32 v100, v100, v250
    v_mul_f32 v101, v101, v250
    v_mul_f32 v102, v102, v250
    v_mul_f32 v103, v103, v250
    v_mul_f32 v104, v104, v3
    v_mul_f32 v105, v105, v3
    v_mul_f32 v106, v106, v3
    v_mul_f32 v107, v107, v3
    v_mul_f32 v108, v108, v250
    v_mul_f32 v109, v109, v250
    v_mul_f32 v110, v110, v250
    v_mul_f32 v111, v111, v250
    v_mul_f32 v112, v112, v3
    v_mul_f32 v113, v113, v3
    v_mul_f32 v114, v114, v3
    v_mul_f32 v115, v115, v3
    v_mul_f32 v116, v116, v250
    v_mul_f32 v117, v117, v250
    v_mul_f32 v118, v118, v250
    v_mul_f32 v119, v119, v250
    v_mul_f32 v184, v184, v3
    v_mul_f32 v185, v185, v3
    v_mul_f32 v186, v186, v3
    v_mul_f32 v187, v187, v3
    v_mul_f32 v188, v188, v250
    v_mul_f32 v189, v189, v250
    v_mul_f32 v190, v190, v250
    v_mul_f32 v191, v191, v250
    v_mul_f32 v192, v192, v3
    v_mul_f32 v193, v193, v3
    v_mul_f32 v194, v194, v3
    v_mul_f32 v195, v195, v3
    v_mul_f32 v196, v196, v250
    v_mul_f32 v197, v197, v250
    v_mul_f32 v198, v198, v250
    v_mul_f32 v199, v199, v250
    v_mul_f32 v200, v200, v3
    v_mul_f32 v201, v201, v3
    v_mul_f32 v202, v202, v3
    v_mul_f32 v203, v203, v3
    v_mul_f32 v204, v204, v250
    v_mul_f32 v205, v205, v250
    v_mul_f32 v206, v206, v250
    v_mul_f32 v207, v207, v250
    v_mul_f32 v208, v208, v3
    v_mul_f32 v209, v209, v3
    v_mul_f32 v210, v210, v3
    v_mul_f32 v211, v211, v3
    v_mul_f32 v212, v212, v250
    v_mul_f32 v213, v213, v250
    v_mul_f32 v214, v214, v250
    v_mul_f32 v215, v215, v250
    s_cmp_eq_u32 s45, 1
    s_cbranch_scc1 f_ret_noqk1
    s_cmp_eq_u32 s41, 0
    s_cbranch_scc1 f_fixa1
    s_cmp_eq_u32 s44, -1
    s_branch f_ret_fullB1
f_fixa1:
    s_cmp_eq_u32 s44, -1
    s_branch f_ret_fullA1
f_noqk0:
    s_mov_b32 s45, 1
    ds_read_b128 v[24:27], v232 offset:24576
    ds_read_b128 v[28:31], v232 offset:25600
    ds_read_b128 v[32:35], v232 offset:26624
    ds_read_b128 v[36:39], v232 offset:27648
    ds_read_b128 v[40:43], v232 offset:28672
    ds_read_b128 v[44:47], v232 offset:29696
    ds_read_b128 v[48:51], v232 offset:30720
    ds_read_b128 v[52:55], v232 offset:31744
    v_add_u32 v232, s46, v0
    s_cmp_lg_u32 s41, 0
    s_cbranch_scc1 f_rb18
    s_cmp_eq_u32 s52, 0
    s_cbranch_scc1 f_nf19
    s_add_u32 s32, s43, 1
    s_and_b32 s32, s32, 3
    s_lshl_b32 s32, s32, 2
    s_add_u32 s32, s32, 131072
    v_mov_b32 v3, s32
    s_mov_b32 s52, 0
    s_waitcnt vmcnt(0)
    s_mov_b64 exec, 1
    ds_add_u32 v3, v246
    s_mov_b64 exec, -1
f_nf19:
f_rb18:
    s_waitcnt lgkmcnt(10)
    v_cmp_gt_i32 vcc, v245, v241
    s_nop 0
    s_cbranch_vccnz f_fs20
f_fbN:
    v_exp_f32 v220, v124
    v_cvt_pk_bf16_f32 v168, v216, v217
    v_exp_f32 v221, v125
    v_cvt_pk_bf16_f32 v169, v218, v219
    v_exp_f32 v222, v126
    v_exp_f32 v223, v127
    v_cvt_pk_bf16_f32 v170, v220, v221
    v_exp_f32 v216, v128
    v_or3_b32 v249, v168, v169, v170
    v_exp_f32 v217, v129
    v_cvt_pk_bf16_f32 v171, v222, v223
    v_exp_f32 v218, v130
    v_exp_f32 v219, v131
    v_cvt_pk_bf16_f32 v172, v216, v217
    s_waitcnt lgkmcnt(7)
    v_mfma_f32_16x16x32_bf16 v[88:91], v[24:27], v[176:179], v[88:91]
    v_mfma_f32_16x16x32_bf16 v[92:95], v[24:27], v[180:183], v[92:95]
    v_mfma_f32_16x16x32_bf16 v[224:227], v[252:255], v[176:179], v[224:227]
    ds_read_b128 v[24:27], v232 offset:8192
    v_exp_f32 v220, v132
    v_or3_b32 v249, v249, v171, v172
    s_waitcnt lgkmcnt(7)
    v_mfma_f32_16x16x32_bf16 v[96:99], v[28:31], v[176:179], v[96:99]
    v_mfma_f32_16x16x32_bf16 v[100:103], v[28:31], v[180:183], v[100:103]
    v_mfma_f32_16x16x32_bf16 v[228:231], v[252:255], v[180:183], v[228:231]
    ds_read_b128 v[28:31], v232 offset:9216
    v_exp_f32 v221, v133
    v_cvt_pk_bf16_f32 v173, v218, v219
    s_waitcnt lgkmcnt(7)
    v_mfma_f32_16x16x32_bf16 v[104:107], v[32:35], v[176:179], v[104:107]
    v_mfma_f32_16x16x32_bf16 v[108:111], v[32:35], v[180:183], v[108:111]
    ds_read_b128 v[32:35], v232 offset:10240
    v_exp_f32 v222, v134
    s_waitcnt lgkmcnt(7)
    v_mfma_f32_16x16x32_bf16 v[112:115], v[36:39], v[176:179], v[112:115]
    v_mfma_f32_16x16x32_bf16 v[116:119], v[36:39], v[180:183], v[116:119]
    ds_read_b128 v[36:39], v232 offset:11264
    v_exp_f32 v223, v135
    v_cvt_pk_bf16_f32 v174, v220, v221
    s_waitcnt lgkmcnt(7)
    v_mfma_f32_16x16x32_bf16 v[184:187], v[40:43], v[176:179], v[184:187]
    v_mfma_f32_16x16x32_bf16 v[188:191], v[40:43], v[180:183], v[188:191]
    ds_read_b128 v[40:43], v232 offset:12288
    v_or3_b32 v249, v249, v173, v174
    v_cvt_pk_bf16_f32 v175, v222, v223
    s_waitcnt lgkmcnt(7)
    v_mfma_f32_16x16x32_bf16 v[192:195], v[44:47], v[176:179], v[192:195]
    v_mfma_f32_16x16x32_bf16 v[196:199], v[44:47], v[180:183], v[196:199]
    ds_read_b128 v[44:47], v232 offset:13312
    v_or_b32 v249, v249, v175
    v_and_b32 v249, 0x40004000, v249
    s_waitcnt lgkmcnt(7)
    v_mfma_f32_16x16x32_bf16 v[200:203], v[48:51], v[176:179], v[200:203]
    v_mfma_f32_16x16x32_bf16 v[204:207], v[48:51], v[180:183], v[204:207]
    ds_read_b128 v[48:51], v232 offset:14336
    v_cmp_ne_u32 vcc, 0, v249
    s_waitcnt lgkmcnt(7)
    v_mfma_f32_16x16x32_bf16 v[208:211], v[52:55], v[176:179], v[208:211]
    v_mfma_f32_16x16x32_bf16 v[212:215], v[52:55], v[180:183], v[212:215]
    ds_read_b128 v[52:55], v232 offset:15360
    s_cbranch_vccnz f_fix0
f_ret_noqk0:
f_final0:
    s_waitcnt lgkmcnt(7)
    v_mfma_f32_16x16x32_bf16 v[88:91], v[24:27], v[168:171], v[88:91]
    v_mfma_f32_16x16x32_bf16 v[92:95], v[24:27], v[172:175], v[92:95]
    v_mfma_f32_16x16x32_bf16 v[224:227], v[252:255], v[168:171], v[224:227]
    s_waitcnt lgkmcnt(6)
    v_mfma_f32_16x16x32_bf16 v[96:99], v[28:31], v[168:171], v[96:99]
    v_mfma_f32_16x16x32_bf16 v[100:103], v[28:31], v[172:175], v[100:103]
    v_mfma_f32_16x16x32_bf16 v[228:231], v[252:255], v[172:175], v[228:231]
    s_waitcnt lgkmcnt(5)
    v_mfma_f32_16x16x32_bf16 v[104:107], v[32:35], v[168:171], v[104:107]
    v_mfma_f32_16x16x32_bf16 v[108:111], v[32:35], v[172:175], v[108:111]
    s_waitcnt lgkmcnt(4)
    v_mfma_f32_16x16x32_bf16 v[112:115], v[36:39], v[168:171], v[112:115]
    v_mfma_f32_16x16x32_bf16 v[116:119], v[36:39], v[172:175], v[116:119]
    s_waitcnt lgkmcnt(3)
    v_mfma_f32_16x16x32_bf16 v[184:187], v[40:43], v[168:171], v[184:187]
    v_mfma_f32_16x16x32_bf16 v[188:191], v[40:43], v[172:175], v[188:191]
    s_waitcnt lgkmcnt(2)
    v_mfma_f32_16x16x32_bf16 v[192:195], v[44:47], v[168:171], v[192:195]
    v_mfma_f32_16x16x32_bf16 v[196:199], v[44:47], v[172:175], v[196:199]
    s_waitcnt lgkmcnt(1)
    v_mfma_f32_16x16x32_bf16 v[200:203], v[48:51], v[168:171], v[200:203]
    v_mfma_f32_16x16x32_bf16 v[204:207], v[48:51], v[172:175], v[204:207]
    s_waitcnt lgkmcnt(0)
    v_mfma_f32_16x16x32_bf16 v[208:211], v[52:55], v[168:171], v[208:211]
    v_mfma_f32_16x16x32_bf16 v[212:215], v[52:55], v[172:175], v[212:215]
f_fin:
    v_mov_b32 v245, 0x4000
    ds_write_b32 v243, v245
    s_and_b32 s39, s2, 3
    s_mul_i32 s49, s39, 85
    s_add_u32 s57, s49, 86
    s_cmp_lg_u32 s39, 0
    s_addc_u32 s49, s49, 0
    s_cmp_eq_u32 s39, 3
    s_addc_u32 s57, s57, 0
    s_cmp_eq_u32 s39, 3
    s_cselect_b32 s12, s82, s74
    s_cselect_b32 s13, s83, s75
    s_cselect_b32 s32, 256, 0
    s_and_b32 s13, s13, 0xffff
    s_sub_u32 s14, s57, s32
    s_lshl_b32 s14, s14, 14
    s_mov_b32 s15, 0x20000
    s_sub_u32 s50, s49, s32
    s_lshl_b32 s50, s50, 14
    s_cmp_lg_u32 s41, 0
    s_cbranch_scc1 f_rb21
    s_setprio 0
    s_cmp_eq_u32 s52, 0
    s_cbranch_scc1 f_nf22
    s_add_u32 s32, s43, 1
    s_and_b32 s32, s32, 3
    s_lshl_b32 s32, s32, 2
    s_add_u32 s32, s32, 131072
    v_mov_b32 v3, s32
    s_mov_b32 s52, 0
    s_waitcnt vmcnt(0)
    s_mov_b64 exec, 1
    ds_add_u32 v3, v246
    s_mov_b64 exec, -1
f_nf22:
    s_cmp_gt_u32 s43, s42
    s_cbranch_scc1 f_ni23
    s_sub_u32 s32, s43, 3
f_sp23:
    s_sub_u32 s38, s38, 1
    s_cselect_b32 s38, 0, s38
    s_cbranch_scc1 f_go23
    ds_read_b32 v247, v244
    s_waitcnt lgkmcnt(0)
    v_cmp_gt_i32 vcc, s32, v247
    s_nop 0
    s_cbranch_vccnz f_sp23
f_go23:
    s_mov_b32 m0, s48
    s_nop 0
    buffer_load_dwordx4 v0, s[28:31], s47 offen offset:0 sc1 lds
    buffer_load_dwordx4 v0, s[28:31], s47 offen offset:1024 sc1 lds
    buffer_load_dwordx4 v0, s[28:31], s47 offen offset:2048 sc1 lds
    buffer_load_dwordx4 v0, s[28:31], s47 offen offset:3072 sc1 lds
    s_add_u32 m0, s48, 4096
    s_nop 0
    buffer_load_dwordx4 v239, s[28:31], s47 offen offset:0 sc1 lds
    buffer_load_dwordx4 v239, s[28:31], s47 offen offset:1024 sc1 lds
    buffer_load_dwordx4 v239, s[28:31], s47 offen offset:2048 sc1 lds
    buffer_load_dwordx4 v239, s[28:31], s47 offen offset:3072 sc1 lds
    s_add_u32 s43, s43, 1
    s_add_u32 s48, s48, 32768
    s_and_b32 s48, s48, 0x1ffff
    s_add_u32 s47, s47, 32768
    s_mov_b32 s52, 1
f_ni23:
f_rb21:
    v_rcp_f32 v1, v224
    v_rcp_f32 v2, v228
    s_lshl_b32 s54, s4, 13
    s_add_u32 s54, s54, s40
    v_mul_f32 v88, v88, v1
    v_mul_f32 v89, v89, v1
    v_mul_f32 v90, v90, v1
    v_mul_f32 v91, v91, v1
    v_mul_f32 v92, v92, v2
    v_mul_f32 v93, v93, v2
    v_mul_f32 v94, v94, v2
    v_mul_f32 v95, v95, v2
    v_mul_f32 v96, v96, v1
    v_mul_f32 v97, v97, v1
    v_mul_f32 v98, v98, v1
    v_mul_f32 v99, v99, v1
    v_mul_f32 v100, v100, v2
    v_mul_f32 v101, v101, v2
    v_mul_f32 v102, v102, v2
    v_mul_f32 v103, v103, v2
    v_cvt_pk_bf16_f32 v120, v88, v89
    v_cvt_pk_bf16_f32 v121, v90, v91
    v_cvt_pk_bf16_f32 v122, v92, v93
    v_cvt_pk_bf16_f32 v123, v94, v95
    v_cvt_pk_bf16_f32 v124, v96, v97
    v_cvt_pk_bf16_f32 v125, v98, v99
    v_cvt_pk_bf16_f32 v126, v100, v101
    v_cvt_pk_bf16_f32 v127, v102, v103
    v_permlane16_swap_b32 v120, v122
    v_permlane16_swap_b32 v121, v123
    s_nop 0
    v_permlane32_swap_b32 v120, v122
    v_permlane32_swap_b32 v121, v123
    v_permlane16_swap_b32 v124, v126
    v_permlane16_swap_b32 v125, v127
    s_nop 0
    v_permlane32_swap_b32 v124, v126
    v_permlane32_swap_b32 v125, v127
    buffer_store_dwordx4 v[120:123], v0, s[20:23], s54 offen offset:0 sc1
    buffer_store_dwordx4 v[124:127], v0, s[20:23], s54 offen offset:1024 sc1
    v_mul_f32 v104, v104, v1
    v_mul_f32 v105, v105, v1
    v_mul_f32 v106, v106, v1
    v_mul_f32 v107, v107, v1
    v_mul_f32 v108, v108, v2
    v_mul_f32 v109, v109, v2
    v_mul_f32 v110, v110, v2
    v_mul_f32 v111, v111, v2
    v_mul_f32 v112, v112, v1
    v_mul_f32 v113, v113, v1
    v_mul_f32 v114, v114, v1
    v_mul_f32 v115, v115, v1
    v_mul_f32 v116, v116, v2
    v_mul_f32 v117, v117, v2
    v_mul_f32 v118, v118, v2
    v_mul_f32 v119, v119, v2
    v_cvt_pk_bf16_f32 v128, v104, v105
    v_cvt_pk_bf16_f32 v129, v106, v107
    v_cvt_pk_bf16_f32 v130, v108, v109
    v_cvt_pk_bf16_f32 v131, v110, v111
    v_cvt_pk_bf16_f32 v132, v112, v113
    v_cvt_pk_bf16_f32 v133, v114, v115
    v_cvt_pk_bf16_f32 v134, v116, v117
    v_cvt_pk_bf16_f32 v135, v118, v119
    v_permlane16_swap_b32 v128, v130
    v_permlane16_swap_b32 v129, v131
    s_nop 0
    v_permlane32_swap_b32 v128, v130
    v_permlane32_swap_b32 v129, v131
    v_permlane16_swap_b32 v132, v134
    v_permlane16_swap_b32 v133, v135
    s_nop 0
    v_permlane32_swap_b32 v132, v134
    v_permlane32_swap_b32 v133, v135
    buffer_store_dwordx4 v[128:131], v0, s[20:23], s54 offen offset:2048 sc1
    buffer_store_dwordx4 v[132:135], v0, s[20:23], s54 offen offset:3072 sc1
    v_mul_f32 v184, v184, v1
    v_mul_f32 v185, v185, v1
    v_mul_f32 v186, v186, v1
    v_mul_f32 v187, v187, v1
    v_mul_f32 v188, v188, v2
    v_mul_f32 v189, v189, v2
    v_mul_f32 v190, v190, v2
    v_mul_f32 v191, v191, v2
    v_mul_f32 v192, v192, v1
    v_mul_f32 v193, v193, v1
    v_mul_f32 v194, v194, v1
    v_mul_f32 v195, v195, v1
    v_mul_f32 v196, v196, v2
    v_mul_f32 v197, v197, v2
    v_mul_f32 v198, v198, v2
    v_mul_f32 v199, v199, v2
    v_cvt_pk_bf16_f32 v136, v184, v185
    v_cvt_pk_bf16_f32 v137, v186, v187
    v_cvt_pk_bf16_f32 v138, v188, v189
    v_cvt_pk_bf16_f32 v139, v190, v191
    v_cvt_pk_bf16_f32 v140, v192, v193
    v_cvt_pk_bf16_f32 v141, v194, v195
    v_cvt_pk_bf16_f32 v142, v196, v197
    v_cvt_pk_bf16_f32 v143, v198, v199
    v_permlane16_swap_b32 v136, v138
    v_permlane16_swap_b32 v137, v139
    s_nop 0
    v_permlane32_swap_b32 v136, v138
    v_permlane32_swap_b32 v137, v139
    v_permlane16_swap_b32 v140, v142
    v_permlane16_swap_b32 v141, v143
    s_nop 0
    v_permlane32_swap_b32 v140, v142
    v_permlane32_swap_b32 v141, v143
    buffer_store_dwordx4 v[136:139], v239, s[20:23], s54 offen offset:0 sc1
    buffer_store_dwordx4 v[140:143], v239, s[20:23], s54 offen offset:1024 sc1
    v_mul_f32 v200, v200, v1
    v_mul_f32 v201, v201, v1
    v_mul_f32 v202, v202, v1
    v_mul_f32 v203, v203, v1
    v_mul_f32 v204, v204, v2
    v_mul_f32 v205, v205, v2
    v_mul_f32 v206, v206, v2
    v_mul_f32 v207, v207, v2
    v_mul_f32 v208, v208, v1
    v_mul_f32 v209, v209, v1
    v_mul_f32 v210, v210, v1
    v_mul_f32 v211, v211, v1
    v_mul_f32 v212, v212, v2
    v_mul_f32 v213, v213, v2
    v_mul_f32 v214, v214, v2
    v_mul_f32 v215, v215, v2
    v_cvt_pk_bf16_f32 v144, v200, v201
    v_cvt_pk_bf16_f32 v145, v202, v203
    v_cvt_pk_bf16_f32 v146, v204, v205
    v_cvt_pk_bf16_f32 v147, v206, v207
    v_cvt_pk_bf16_f32 v148, v208, v209
    v_cvt_pk_bf16_f32 v149, v210, v211
    v_cvt_pk_bf16_f32 v150, v212, v213
    v_cvt_pk_bf16_f32 v151, v214, v215
    v_permlane16_swap_b32 v144, v146
    v_permlane16_swap_b32 v145, v147
    s_nop 0
    v_permlane32_swap_b32 v144, v146
    v_permlane32_swap_b32 v145, v147
    v_permlane16_swap_b32 v148, v150
    v_permlane16_swap_b32 v149, v151
    s_nop 0
    v_permlane32_swap_b32 v148, v150
    v_permlane32_swap_b32 v149, v151
    buffer_store_dwordx4 v[144:147], v239, s[20:23], s54 offen offset:2048 sc1
    buffer_store_dwordx4 v[148:151], v239, s[20:23], s54 offen offset:3072 sc1
    s_sub_u32 s32, 15, s5
    s_bitcmp1_b32 s2, 2
    s_cselect_b32 s44, s32, s5
    s_and_b32 s45, s4, 3
    s_lshl_b32 s35, s44, 2
    s_add_u32 s35, s35, s45
    s_lshl_b32 s32, s44, 2
    s_and_b32 s33, s3, 3
    s_add_u32 s32, s32, s33
    s_lshl_b32 s51, s32, 7
    s_add_u32 s51, s51, 59121664
    s_mul_i32 s32, s32, 350208
    s_add_u32 s32, s32, 36700160
    s_add_u32 s8, s88, s32
    s_addc_u32 s9, s89, 0
    s_and_b32 s9, s9, 0xffff
    s_lshl_b32 s10, s57, 10
    s_lshl_b32 s32, s33, 14
    s_add_u32 s50, s50, s32
    s_lshl_b32 s7, s33, 12
    s_lshl_b32 s53, s49, 10
    v_lshrrev_b32 v1, 4, v248
    v_bfe_u32 v2, v248, 2, 2
    v_xor_b32 v2, v2, v1
    v_lshlrev_b32 v2, 6, v2
    v_lshl_add_u32 v2, v1, 10, v2
    v_and_b32 v3, 3, v248
    v_lshl_add_u32 v2, v3, 4, v2
    s_lshl_b32 s32, s45, 8
    v_add_u32 v5, s32, v2
    v_xor_b32 v6, 32, v5
    s_and_b32 s32, s3, 2
    s_lshl_b32 s32, s32, 12
    v_and_b32 v1, 0xf0, v0
    v_lshrrev_b32 v2, 4, v248
    v_lshl_add_u32 v1, v2, 9, v1
    v_add_u32 v7, s32, v1
    v_add_u32 v8, 0x10000, v7
    v_bfe_u32 v1, v248, 2, 2
    v_lshrrev_b32 v2, 5, v248
    v_lshl_add_u32 v2, v2, 4, v1
    v_bfe_u32 v9, v248, 4, 1
    v_lshl_add_u32 v2, v9, 2, v2
    v_lshlrev_b32 v2, 8, v2
    v_lshl_add_u32 v2, v9, 5, v2
    s_and_b32 s32, s3, 1
    s_lshl_b32 s32, s32, 1
    v_xor_b32 v1, s32, v1
    v_lshl_add_u32 v2, v1, 6, v2
    v_lshl_add_u32 v2, v3, 3, v2
    v_add_u32 v9, 0x4000, v2
    v_xor_b32 v10, 32, v9
    v_xor_b32 v11, 64, v9
    v_xor_b32 v12, 96, v9
    v_add_u32 v13, 0x10000, v9
    v_add_u32 v14, 0x10000, v10
    v_add_u32 v15, 0x10000, v11
    v_add_u32 v16, 0x10000, v12
    s_lshr_b32 s32, s49, 3
    s_sub_u32 s33, s57, 1
    s_lshr_b32 s33, s33, 3
    s_sub_u32 s33, s33, s32
    s_add_u32 s33, s33, 1
    s_bfm_b32 s58, s33, s32
    s_cmp_eq_u32 s39, 3
    s_cselect_b32 s58, -1, s58
    s_mov_b32 s59, 0
    v_lshrrev_b32 v18, 2, v0
    v_and_b32 v18, 127, v18
    s_lshl_b32 s32, s55, 7
    s_lshl_b32 s33, s4, 2
    s_add_u32 s54, s32, s33
    s_add_u32 s54, s54, 59121664
    s_waitcnt vmcnt(0)
    v_mov_b32 v1, s37
    v_mov_b32 v2, 0
    s_mov_b64 exec, 1
    buffer_store_dword v1, v2, s[20:23], s54 offen sc1
    s_mov_b64 exec, -1
    s_cmp_lg_u32 s41, 0
    s_cbranch_scc1 f_p4
    s_lshr_b32 s32, s2, 3
    s_lshl_b32 s32, s32, 2
    s_and_b32 s33, s3, 3
    s_add_u32 s32, s32, s33
    s_mul_i32 s32, s32, 11008
    s_add_u32 s32, s32, s50
    s_lshl_b32 s33, s33, 14
    s_sub_u32 s32, s32, s33
    v_lshlrev_b32 v1, 3, v0
    buffer_load_dword v22, v1, s[12:15], s32 offen
    s_add_u32 s32, s32, 2816
    buffer_load_dword v22, v1, s[12:15], s32 offen
    s_cmp_eq_u32 s52, 0
    s_cbranch_scc1 f_nf24
    s_add_u32 s32, s43, 1
    s_and_b32 s32, s32, 3
    s_lshl_b32 s32, s32, 2
    s_add_u32 s32, s32, 131072
    v_mov_b32 v3, s32
    s_mov_b32 s52, 0
    s_waitcnt vmcnt(0)
    s_mov_b64 exec, 1
    ds_add_u32 v3, v246
    s_mov_b64 exec, -1
f_nf24:
    v_cmp_eq_u32 vcc, 0, v248
    s_nop 1
    v_cndmask_b32 v27, 0, 1, vcc
    v_lshlrev_b32 v25, 2, v27
    v_mov_b32 v26, 131084
    v_cndmask_b32 v26, -1, v26, vcc
    s_add_u32 s32, s43, 1
    s_and_b32 s32, s32, 3
    s_lshl_b32 s32, s32, 2
    s_add_u32 s32, s32, 131072
    v_mov_b32 v24, s32
    v_lshrrev_b32 v1, 2, v0
    v_add_u32 v1, 131328, v1
    v_cndmask_b32 v24, v1, v24, vcc
    s_sub_u32 s54, s43, 3
    s_sub_u32 s42, s42, 3
    s_cmp_gt_i32 s54, s42
    s_cbranch_scc1 f_lddone
    s_branch f_ldpoll
f_ldwait:
    s_cmp_eq_u32 s52, 0
    s_cbranch_scc1 f_ldnp
    s_mov_b32 s52, 0
    s_waitcnt vmcnt(0)
    ds_add_u32 v24, v27
f_ldnp:
    s_sub_u32 s38, s38, 1
    s_cselect_b32 s38, 0, s38
    s_cbranch_scc1 f_ldgo
    s_sleep 4
f_ldpoll:
    ds_read_b32 v247, v244
    s_waitcnt lgkmcnt(0)
    v_cmp_gt_i32 vcc, s54, v247
    s_nop 0
    s_cbranch_vccnz f_ldwait
f_ldgo:
    s_mov_b32 m0, s48
    s_nop 0
    buffer_load_dwordx4 v0, s[28:31], s47 offen offset:0 sc1 lds
    buffer_load_dwordx4 v0, s[28:31], s47 offen offset:1024 sc1 lds
    s_cmp_eq_u32 s52, 0
    s_cbranch_scc1 f_ldnq
    s_waitcnt vmcnt(2)
    ds_add_u32 v24, v27
f_ldnq:
    buffer_load_dwordx4 v0, s[28:31], s47 offen offset:2048 sc1 lds
    buffer_load_dwordx4 v0, s[28:31], s47 offen offset:3072 sc1 lds
    s_add_u32 m0, s48, 4096
    s_nop 0
    buffer_load_dwordx4 v239, s[28:31], s47 offen offset:0 sc1 lds
    buffer_load_dwordx4 v239, s[28:31], s47 offen offset:1024 sc1 lds
    buffer_load_dwordx4 v239, s[28:31], s47 offen offset:2048 sc1 lds
    buffer_load_dwordx4 v239, s[28:31], s47 offen offset:3072 sc1 lds
    v_add_u32 v24, v25, v24
    s_add_u32 s48, s48, 32768
    s_and_b32 s48, s48, 0x1ffff
    v_and_b32 v24, v26, v24
    s_add_u32 s47, s47, 32768
    s_mov_b32 s52, 1
    s_add_u32 s54, s54, 1
    s_sleep 10
    s_cmp_le_i32 s54, s42
    s_cbranch_scc1 f_ldpoll
    s_waitcnt vmcnt(0)
    ds_add_u32 v24, v27
f_lddone:
    s_mov_b32 s52, 0
f_ldend:
    s_cmp_eq_u32 s52, 0
    s_cbranch_scc1 f_nf25
    s_add_u32 s32, s43, 1
    s_and_b32 s32, s32, 3
    s_lshl_b32 s32, s32, 2
    s_add_u32 s32, s32, 131072
    v_mov_b32 v3, s32
    s_mov_b32 s52, 0
    s_waitcnt vmcnt(0)
    s_mov_b64 exec, 1
    ds_add_u32 v3, v246
    s_mov_b64 exec, -1
f_nf25:
    s_lshr_b32 s32, s2, 3
    s_lshl_b32 s32, s32, 2
    s_and_b32 s33, s3, 3
    s_add_u32 s32, s32, s33
    s_mul_i32 s32, s32, 11008
    s_add_u32 s32, s32, s50
    s_lshl_b32 s33, s33, 14
    s_sub_u32 s32, s32, s33
    v_lshlrev_b32 v1, 3, v0
    buffer_load_dword v22, v1, s[12:15], s32 offen
    s_add_u32 s32, s32, 2816
    buffer_load_dword v22, v1, s[12:15], s32 offen
f_p4:
    s_setprio 0
    s_cmp_lg_u32 s41, 0
    s_cbranch_scc1 f_rb26
    buffer_load_dword v23, v18, s[20:23], s51 offen sc1
f_rb26:
    s_lshl_b32 s32, s44, 3
    s_and_b32 s33, s39, 2
    s_lshl_b32 s33, s33, 1
    s_add_u32 s32, s32, s33
    s_lshr_b32 s33, s3, 1
    s_add_u32 s32, s32, s33
    s_lshl_b32 s32, s32, 14
    s_lshl_b32 s33, s45, 8
    s_add_u32 s32, s32, s33
    s_and_b32 s33, s39, 1
    s_lshl_b32 s33, s33, 7
    s_add_u32 s32, s32, s33
    s_and_b32 s33, s3, 1
    s_lshl_b32 s33, s33, 6
    s_add_u32 s32, s32, s33
    v_and_b32 v1, 15, v248
    v_lshlrev_b32 v1, 10, v1
    v_lshrrev_b32 v2, 4, v248
    v_lshl_add_u32 v1, v2, 3, v1
    v_add_u32 v17, s32, v1
    s_mov_b32 s24, s64
    s_and_b32 s25, s65, 0xffff
    s_mov_b32 s26, 0x200000
    s_mov_b32 s27, 0x20000
    s_mov_b32 s16, s84
    s_and_b32 s17, s85, 0xffff
    s_mov_b32 s18, 0x200000
    s_mov_b32 s19, 0x20000
    s_waitcnt lgkmcnt(0)
    s_barrier
    s_cmp_lg_u32 s41, 0
    s_cbranch_scc1 f_c4
    s_add_u32 m0, s7, 16384
    s_add_u32 s32, s50, 0
    buffer_load_dwordx4 v5, s[12:15], s32 offen lds
    s_add_u32 m0, s7, 17408
    s_add_u32 s32, s50, 4096
    buffer_load_dwordx4 v6, s[12:15], s32 offen lds
    s_add_u32 m0, s7, 18432
    s_add_u32 s32, s50, 8192
    buffer_load_dwordx4 v5, s[12:15], s32 offen lds
    s_add_u32 m0, s7, 19456
    s_add_u32 s32, s50, 12288
    buffer_load_dwordx4 v6, s[12:15], s32 offen lds
    s_add_u32 s50, s50, 65536
    s_add_u32 m0, s7, 49152
    s_add_u32 s32, s50, 0
    buffer_load_dwordx4 v5, s[12:15], s32 offen lds
    s_add_u32 m0, s7, 50176
    s_add_u32 s32, s50, 4096
    buffer_load_dwordx4 v6, s[12:15], s32 offen lds
    s_add_u32 m0, s7, 51200
    s_add_u32 s32, s50, 8192
    buffer_load_dwordx4 v5, s[12:15], s32 offen lds
    s_add_u32 m0, s7, 52224
    s_add_u32 s32, s50, 12288
    buffer_load_dwordx4 v6, s[12:15], s32 offen lds
    s_add_u32 s50, s50, 65536
    s_waitcnt vmcnt(8)
    v_cmp_ne_u32 vcc, s37, v23
    s_nop 1
    s_and_b64 vcc, vcc, s[58:59]
    s_cbranch_vccz f_pk27
f_pl27:
    s_sub_u32 s38, s38, 1
    s_cselect_b32 s38, 0, s38
    s_cbranch_scc1 f_pk27
    s_sleep 2
    buffer_load_dword v23, v18, s[20:23], s51 offen sc1
    s_waitcnt vmcnt(0)
    v_cmp_ne_u32 vcc, s37, v23
    s_nop 1
    s_and_b64 vcc, vcc, s[58:59]
    s_cbranch_vccz f_pk27
    s_branch f_pl27
f_pk27:
    s_add_u32 m0, s7, 0
    s_nop 0
    buffer_load_dwordx4 v0, s[8:11], s53 offen offset:0 sc1 lds
    buffer_load_dwordx4 v0, s[8:11], s53 offen offset:1024 sc1 lds
    buffer_load_dwordx4 v0, s[8:11], s53 offen offset:2048 sc1 lds
    buffer_load_dwordx4 v0, s[8:11], s53 offen offset:3072 sc1 lds
    s_add_u32 s53, s53, 4096
    s_add_u32 m0, s7, 32768
    s_nop 0
    buffer_load_dwordx4 v0, s[8:11], s53 offen offset:0 sc1 lds
    buffer_load_dwordx4 v0, s[8:11], s53 offen offset:1024 sc1 lds
    buffer_load_dwordx4 v0, s[8:11], s53 offen offset:2048 sc1 lds
    buffer_load_dwordx4 v0, s[8:11], s53 offen offset:3072 sc1 lds
    s_add_u32 s53, s53, 4096
    s_add_u32 m0, s7, 81920
    s_add_u32 s32, s50, 0
    buffer_load_dwordx4 v5, s[12:15], s32 offen lds
    s_add_u32 m0, s7, 82944
    s_add_u32 s32, s50, 4096
    buffer_load_dwordx4 v6, s[12:15], s32 offen lds
    s_add_u32 m0, s7, 83968
    s_add_u32 s32, s50, 8192
    buffer_load_dwordx4 v5, s[12:15], s32 offen lds
    s_add_u32 m0, s7, 84992
    s_add_u32 s32, s50, 12288
    buffer_load_dwordx4 v6, s[12:15], s32 offen lds
    s_add_u32 s50, s50, 65536
    s_add_u32 m0, s7, 65536
    s_nop 0
    buffer_load_dwordx4 v0, s[8:11], s53 offen offset:0 sc1 lds
    buffer_load_dwordx4 v0, s[8:11], s53 offen offset:1024 sc1 lds
    buffer_load_dwordx4 v0, s[8:11], s53 offen offset:2048 sc1 lds
    buffer_load_dwordx4 v0, s[8:11], s53 offen offset:3072 sc1 lds
    s_add_u32 s53, s53, 4096
    s_waitcnt vmcnt(12)
    s_barrier
    s_mov_b32 s34, 5
f_ll4:
    s_waitcnt vmcnt(8)
    s_barrier
    s_add_u32 m0, s7, 114688
    s_add_u32 s32, s50, 0
    buffer_load_dwordx4 v5, s[12:15], s32 offen lds
    s_add_u32 m0, s7, 115712
    s_add_u32 s32, s50, 4096
    buffer_load_dwordx4 v6, s[12:15], s32 offen lds
    s_add_u32 m0, s7, 116736
    s_add_u32 s32, s50, 8192
    buffer_load_dwordx4 v5, s[12:15], s32 offen lds
    s_add_u32 m0, s7, 117760
    s_add_u32 s32, s50, 12288
    buffer_load_dwordx4 v6, s[12:15], s32 offen lds
    s_add_u32 s50, s50, 65536
    s_add_u32 m0, s7, 98304
    s_nop 0
    buffer_load_dwordx4 v0, s[8:11], s53 offen offset:0 sc1 lds
    buffer_load_dwordx4 v0, s[8:11], s53 offen offset:1024 sc1 lds
    buffer_load_dwordx4 v0, s[8:11], s53 offen offset:2048 sc1 lds
    buffer_load_dwordx4 v0, s[8:11], s53 offen offset:3072 sc1 lds
    s_add_u32 s53, s53, 4096
    s_waitcnt vmcnt(8)
    s_barrier
    s_add_u32 m0, s7, 16384
    s_add_u32 s32, s50, 0
    buffer_load_dwordx4 v5, s[12:15], s32 offen lds
    s_add_u32 m0, s7, 17408
    s_add_u32 s32, s50, 4096
    buffer_load_dwordx4 v6, s[12:15], s32 offen lds
    s_add_u32 m0, s7, 18432
    s_add_u32 s32, s50, 8192
    buffer_load_dwordx4 v5, s[12:15], s32 offen lds
    s_add_u32 m0, s7, 19456
    s_add_u32 s32, s50, 12288
    buffer_load_dwordx4 v6, s[12:15], s32 offen lds
    s_add_u32 s50, s50, 65536
    s_add_u32 m0, s7, 0
    s_nop 0
    buffer_load_dwordx4 v0, s[8:11], s53 offen offset:0 sc1 lds
    buffer_load_dwordx4 v0, s[8:11], s53 offen offset:1024 sc1 lds
    buffer_load_dwordx4 v0, s[8:11], s53 offen offset:2048 sc1 lds
    buffer_load_dwordx4 v0, s[8:11], s53 offen offset:3072 sc1 lds
    s_add_u32 s53, s53, 4096
    s_waitcnt vmcnt(8)
    s_barrier
    s_add_u32 m0, s7, 49152
    s_add_u32 s32, s50, 0
    buffer_load_dwordx4 v5, s[12:15], s32 offen lds
    s_add_u32 m0, s7, 50176
    s_add_u32 s32, s50, 4096
    buffer_load_dwordx4 v6, s[12:15], s32 offen lds
    s_add_u32 m0, s7, 51200
    s_add_u32 s32, s50, 8192
    buffer_load_dwordx4 v5, s[12:15], s32 offen lds
    s_add_u32 m0, s7, 52224
    s_add_u32 s32, s50, 12288
    buffer_load_dwordx4 v6, s[12:15], s32 offen lds
    s_add_u32 s50, s50, 65536
    s_add_u32 m0, s7, 32768
    s_nop 0
    buffer_load_dwordx4 v0, s[8:11], s53 offen offset:0 sc1 lds
    buffer_load_dwordx4 v0, s[8:11], s53 offen offset:1024 sc1 lds
    buffer_load_dwordx4 v0, s[8:11], s53 offen offset:2048 sc1 lds
    buffer_load_dwordx4 v0, s[8:11], s53 offen offset:3072 sc1 lds
    s_add_u32 s53, s53, 4096
    s_waitcnt vmcnt(8)
    s_barrier
    s_add_u32 m0, s7, 81920
    s_add_u32 s32, s50, 0
    buffer_load_dwordx4 v5, s[12:15], s32 offen lds
    s_add_u32 m0, s7, 82944
    s_add_u32 s32, s50, 4096
    buffer_load_dwordx4 v6, s[12:15], s32 offen lds
    s_add_u32 m0, s7, 83968
    s_add_u32 s32, s50, 8192
    buffer_load_dwordx4 v5, s[12:15], s32 offen lds
    s_add_u32 m0, s7, 84992
    s_add_u32 s32, s50, 12288
    buffer_load_dwordx4 v6, s[12:15], s32 offen lds
    s_add_u32 s50, s50, 65536
    s_add_u32 m0, s7, 65536
    s_nop 0
    buffer_load_dwordx4 v0, s[8:11], s53 offen offset:0 sc1 lds
    buffer_load_dwordx4 v0, s[8:11], s53 offen offset:1024 sc1 lds
    buffer_load_dwordx4 v0, s[8:11], s53 offen offset:2048 sc1 lds
    buffer_load_dwordx4 v0, s[8:11], s53 offen offset:3072 sc1 lds
    s_add_u32 s53, s53, 4096
    s_cmp_lg_u32 s34, 5
    s_cbranch_scc1 f_np28
f_np28:
    s_sub_u32 s34, s34, 1
    s_cmp_lg_u32 s34, 0
    s_cbranch_scc1 f_ll4
    s_waitcnt vmcnt(8)
    s_barrier
    buffer_load_dwordx2 v[20:21], v17, s[24:27], 0 offen
    buffer_load_dwordx2 v[22:23], v17, s[24:27], 0 offen offset:32
    s_waitcnt vmcnt(2)
    s_branch f_sent
f_c4:
    buffer_load_dwordx2 v[20:21], v17, s[24:27], 0 offen
    buffer_load_dwordx2 v[22:23], v17, s[24:27], 0 offen offset:32
    s_setprio 1
    s_barrier
    ds_read_b128 v[120:123], v7 offset:0
    ds_read_b64_tr_b16 v[88:89], v9 offset:0
    ds_read_b64_tr_b16 v[90:91], v9 offset:2048
    ds_read_b128 v[136:139], v7 offset:2048
    ds_read_b64_tr_b16 v[104:105], v9 offset:8192
    ds_read_b64_tr_b16 v[106:107], v9 offset:10240
    ds_read_b64_tr_b16 v[92:93], v10 offset:0
    ds_read_b64_tr_b16 v[94:95], v10 offset:2048
    ds_read_b64_tr_b16 v[108:109], v10 offset:8192
    ds_read_b64_tr_b16 v[110:111], v10 offset:10240
    ds_read_b64_tr_b16 v[96:97], v11 offset:0
    ds_read_b64_tr_b16 v[98:99], v11 offset:2048
    ds_read_b64_tr_b16 v[112:113], v11 offset:8192
    ds_read_b64_tr_b16 v[114:115], v11 offset:10240
    ds_read_b64_tr_b16 v[100:101], v12 offset:0
    ds_read_b64_tr_b16 v[102:103], v12 offset:2048
    ds_read_b64_tr_b16 v[116:117], v12 offset:8192
    ds_read_b64_tr_b16 v[118:119], v12 offset:10240
    ds_read_b128 v[124:127], v7 offset:256
    ds_read_b128 v[140:143], v7 offset:2304
    ds_read_b128 v[128:131], v7 offset:4096
    ds_read_b128 v[144:147], v7 offset:6144
    ds_read_b128 v[132:135], v7 offset:4352
    ds_read_b128 v[148:151], v7 offset:6400
    s_waitcnt lgkmcnt(14)
    v_mfma_f32_16x16x32_bf16 v[24:27], v[88:91], v[120:123], 0
    v_mfma_f32_16x16x32_bf16 v[24:27], v[104:107], v[136:139], v[24:27]
    v_mfma_f32_16x16x32_bf16 v[28:31], v[92:95], v[120:123], 0
    v_mfma_f32_16x16x32_bf16 v[28:31], v[108:111], v[136:139], v[28:31]
    s_barrier
    s_waitcnt lgkmcnt(6)
    v_mfma_f32_16x16x32_bf16 v[32:35], v[96:99], v[120:123], 0
    ds_read_b128 v[184:187], v7 offset:32768
    v_mfma_f32_16x16x32_bf16 v[32:35], v[112:115], v[136:139], v[32:35]
    ds_read_b64_tr_b16 v[152:153], v9 offset:32768
    v_mfma_f32_16x16x32_bf16 v[36:39], v[100:103], v[120:123], 0
    ds_read_b64_tr_b16 v[154:155], v9 offset:34816
    v_mfma_f32_16x16x32_bf16 v[36:39], v[116:119], v[136:139], v[36:39]
    ds_read_b128 v[200:203], v7 offset:34816
    s_waitcnt lgkmcnt(8)
    v_mfma_f32_16x16x32_bf16 v[40:43], v[88:91], v[124:127], 0
    ds_read_b64_tr_b16 v[168:169], v9 offset:40960
    v_mfma_f32_16x16x32_bf16 v[40:43], v[104:107], v[140:143], v[40:43]
    ds_read_b64_tr_b16 v[170:171], v9 offset:43008
    v_mfma_f32_16x16x32_bf16 v[44:47], v[92:95], v[124:127], 0
    ds_read_b64_tr_b16 v[156:157], v10 offset:32768
    v_mfma_f32_16x16x32_bf16 v[44:47], v[108:111], v[140:143], v[44:47]
    ds_read_b64_tr_b16 v[158:159], v10 offset:34816
    v_mfma_f32_16x16x32_bf16 v[48:51], v[96:99], v[124:127], 0
    ds_read_b64_tr_b16 v[172:173], v10 offset:40960
    v_mfma_f32_16x16x32_bf16 v[48:51], v[112:115], v[140:143], v[48:51]
    ds_read_b64_tr_b16 v[174:175], v10 offset:43008
    v_mfma_f32_16x16x32_bf16 v[52:55], v[100:103], v[124:127], 0
    ds_read_b64_tr_b16 v[160:161], v11 offset:32768
    v_mfma_f32_16x16x32_bf16 v[52:55], v[116:119], v[140:143], v[52:55]
    ds_read_b64_tr_b16 v[162:163], v11 offset:34816
    s_waitcnt lgkmcnt(14)
    v_mfma_f32_16x16x32_bf16 v[56:59], v[88:91], v[128:131], 0
    ds_read_b64_tr_b16 v[176:177], v11 offset:40960
    v_mfma_f32_16x16x32_bf16 v[56:59], v[104:107], v[144:147], v[56:59]
    ds_read_b64_tr_b16 v[178:179], v11 offset:43008
    v_mfma_f32_16x16x32_bf16 v[60:63], v[92:95], v[128:131], 0
    ds_read_b64_tr_b16 v[164:165], v12 offset:32768
    v_mfma_f32_16x16x32_bf16 v[60:63], v[108:111], v[144:147], v[60:63]
    ds_read_b64_tr_b16 v[166:167], v12 offset:34816
    v_mfma_f32_16x16x32_bf16 v[64:67], v[96:99], v[128:131], 0
    ds_read_b64_tr_b16 v[180:181], v12 offset:40960
    v_mfma_f32_16x16x32_bf16 v[64:67], v[112:115], v[144:147], v[64:67]
    ds_read_b64_tr_b16 v[182:183], v12 offset:43008
    v_mfma_f32_16x16x32_bf16 v[68:71], v[100:103], v[128:131], 0
    ds_read_b128 v[188:191], v7 offset:33024
    v_mfma_f32_16x16x32_bf16 v[68:71], v[116:119], v[144:147], v[68:71]
    ds_read_b128 v[204:207], v7 offset:35072
    v_mfma_f32_16x16x32_bf16 v[72:75], v[88:91], v[132:135], 0
    ds_read_b128 v[192:195], v7 offset:36864
    v_mfma_f32_16x16x32_bf16 v[72:75], v[104:107], v[148:151], v[72:75]
    ds_read_b128 v[208:211], v7 offset:38912
    v_mfma_f32_16x16x32_bf16 v[76:79], v[92:95], v[132:135], 0
    ds_read_b128 v[196:199], v7 offset:37120
    v_mfma_f32_16x16x32_bf16 v[76:79], v[108:111], v[148:151], v[76:79]
    ds_read_b128 v[212:215], v7 offset:39168
    v_mfma_f32_16x16x32_bf16 v[80:83], v[96:99], v[132:135], 0
    v_mfma_f32_16x16x32_bf16 v[80:83], v[112:115], v[148:151], v[80:83]
    v_mfma_f32_16x16x32_bf16 v[84:87], v[100:103], v[132:135], 0
    v_mfma_f32_16x16x32_bf16 v[84:87], v[116:119], v[148:151], v[84:87]
    s_waitcnt lgkmcnt(14)
    v_mfma_f32_16x16x32_bf16 v[24:27], v[152:155], v[184:187], v[24:27]
    v_mfma_f32_16x16x32_bf16 v[24:27], v[168:171], v[200:203], v[24:27]
    v_mfma_f32_16x16x32_bf16 v[28:31], v[156:159], v[184:187], v[28:31]
    v_mfma_f32_16x16x32_bf16 v[28:31], v[172:175], v[200:203], v[28:31]
    s_barrier
    s_waitcnt lgkmcnt(6)
    v_mfma_f32_16x16x32_bf16 v[32:35], v[160:163], v[184:187], v[32:35]
    ds_read_b128 v[120:123], v8 offset:0
    v_mfma_f32_16x16x32_bf16 v[32:35], v[176:179], v[200:203], v[32:35]
    ds_read_b64_tr_b16 v[88:89], v13 offset:0
    v_mfma_f32_16x16x32_bf16 v[36:39], v[164:167], v[184:187], v[36:39]
    ds_read_b64_tr_b16 v[90:91], v13 offset:2048
    v_mfma_f32_16x16x32_bf16 v[36:39], v[180:183], v[200:203], v[36:39]
    ds_read_b128 v[136:139], v8 offset:2048
    s_waitcnt lgkmcnt(8)
    v_mfma_f32_16x16x32_bf16 v[40:43], v[152:155], v[188:191], v[40:43]
    ds_read_b64_tr_b16 v[104:105], v13 offset:8192
    v_mfma_f32_16x16x32_bf16 v[40:43], v[168:171], v[204:207], v[40:43]
    ds_read_b64_tr_b16 v[106:107], v13 offset:10240
    v_mfma_f32_16x16x32_bf16 v[44:47], v[156:159], v[188:191], v[44:47]
    ds_read_b64_tr_b16 v[92:93], v14 offset:0
    v_mfma_f32_16x16x32_bf16 v[44:47], v[172:175], v[204:207], v[44:47]
    ds_read_b64_tr_b16 v[94:95], v14 offset:2048
    v_mfma_f32_16x16x32_bf16 v[48:51], v[160:163], v[188:191], v[48:51]
    ds_read_b64_tr_b16 v[108:109], v14 offset:8192
    v_mfma_f32_16x16x32_bf16 v[48:51], v[176:179], v[204:207], v[48:51]
    ds_read_b64_tr_b16 v[110:111], v14 offset:10240
    v_mfma_f32_16x16x32_bf16 v[52:55], v[164:167], v[188:191], v[52:55]
    ds_read_b64_tr_b16 v[96:97], v15 offset:0
    v_mfma_f32_16x16x32_bf16 v[52:55], v[180:183], v[204:207], v[52:55]
    ds_read_b64_tr_b16 v[98:99], v15 offset:2048
    s_waitcnt lgkmcnt(14)
    v_mfma_f32_16x16x32_bf16 v[56:59], v[152:155], v[192:195], v[56:59]
    ds_read_b64_tr_b16 v[112:113], v15 offset:8192
    v_mfma_f32_16x16x32_bf16 v[56:59], v[168:171], v[208:211], v[56:59]
    ds_read_b64_tr_b16 v[114:115], v15 offset:10240
    v_mfma_f32_16x16x32_bf16 v[60:63], v[156:159], v[192:195], v[60:63]
    ds_read_b64_tr_b16 v[100:101], v16 offset:0
    v_mfma_f32_16x16x32_bf16 v[60:63], v[172:175], v[208:211], v[60:63]
    ds_read_b64_tr_b16 v[102:103], v16 offset:2048
    v_mfma_f32_16x16x32_bf16 v[64:67], v[160:163], v[192:195], v[64:67]
    ds_read_b64_tr_b16 v[116:117], v16 offset:8192
    v_mfma_f32_16x16x32_bf16 v[64:67], v[176:179], v[208:211], v[64:67]
    ds_read_b64_tr_b16 v[118:119], v16 offset:10240
    v_mfma_f32_16x16x32_bf16 v[68:71], v[164:167], v[192:195], v[68:71]
    ds_read_b128 v[124:127], v8 offset:256
    v_mfma_f32_16x16x32_bf16 v[68:71], v[180:183], v[208:211], v[68:71]
    ds_read_b128 v[140:143], v8 offset:2304
    v_mfma_f32_16x16x32_bf16 v[72:75], v[152:155], v[196:199], v[72:75]
    ds_read_b128 v[128:131], v8 offset:4096
    v_mfma_f32_16x16x32_bf16 v[72:75], v[168:171], v[212:215], v[72:75]
    ds_read_b128 v[144:147], v8 offset:6144
    v_mfma_f32_16x16x32_bf16 v[76:79], v[156:159], v[196:199], v[76:79]
    ds_read_b128 v[132:135], v8 offset:4352
    v_mfma_f32_16x16x32_bf16 v[76:79], v[172:175], v[212:215], v[76:79]
    ds_read_b128 v[148:151], v8 offset:6400
    v_mfma_f32_16x16x32_bf16 v[80:83], v[160:163], v[196:199], v[80:83]
    v_mfma_f32_16x16x32_bf16 v[80:83], v[176:179], v[212:215], v[80:83]
    v_mfma_f32_16x16x32_bf16 v[84:87], v[164:167], v[196:199], v[84:87]
    v_mfma_f32_16x16x32_bf16 v[84:87], v[180:183], v[212:215], v[84:87]
    s_mov_b32 s34, 4
f_l4:
    s_waitcnt lgkmcnt(14)
    v_mfma_f32_16x16x32_bf16 v[24:27], v[88:91], v[120:123], v[24:27]
    v_mfma_f32_16x16x32_bf16 v[24:27], v[104:107], v[136:139], v[24:27]
    v_mfma_f32_16x16x32_bf16 v[28:31], v[92:95], v[120:123], v[28:31]
    v_mfma_f32_16x16x32_bf16 v[28:31], v[108:111], v[136:139], v[28:31]
    s_barrier
    s_waitcnt lgkmcnt(6)
    v_mfma_f32_16x16x32_bf16 v[32:35], v[96:99], v[120:123], v[32:35]
    ds_read_b128 v[184:187], v8 offset:32768
    v_mfma_f32_16x16x32_bf16 v[32:35], v[112:115], v[136:139], v[32:35]
    ds_read_b64_tr_b16 v[152:153], v13 offset:32768
    v_mfma_f32_16x16x32_bf16 v[36:39], v[100:103], v[120:123], v[36:39]
    ds_read_b64_tr_b16 v[154:155], v13 offset:34816
    v_mfma_f32_16x16x32_bf16 v[36:39], v[116:119], v[136:139], v[36:39]
    ds_read_b128 v[200:203], v8 offset:34816
    s_waitcnt lgkmcnt(8)
    v_mfma_f32_16x16x32_bf16 v[40:43], v[88:91], v[124:127], v[40:43]
    ds_read_b64_tr_b16 v[168:169], v13 offset:40960
    v_mfma_f32_16x16x32_bf16 v[40:43], v[104:107], v[140:143], v[40:43]
    ds_read_b64_tr_b16 v[170:171], v13 offset:43008
    v_mfma_f32_16x16x32_bf16 v[44:47], v[92:95], v[124:127], v[44:47]
    ds_read_b64_tr_b16 v[156:157], v14 offset:32768
    v_mfma_f32_16x16x32_bf16 v[44:47], v[108:111], v[140:143], v[44:47]
    ds_read_b64_tr_b16 v[158:159], v14 offset:34816
    v_mfma_f32_16x16x32_bf16 v[48:51], v[96:99], v[124:127], v[48:51]
    ds_read_b64_tr_b16 v[172:173], v14 offset:40960
    v_mfma_f32_16x16x32_bf16 v[48:51], v[112:115], v[140:143], v[48:51]
    ds_read_b64_tr_b16 v[174:175], v14 offset:43008
    v_mfma_f32_16x16x32_bf16 v[52:55], v[100:103], v[124:127], v[52:55]
    ds_read_b64_tr_b16 v[160:161], v15 offset:32768
    v_mfma_f32_16x16x32_bf16 v[52:55], v[116:119], v[140:143], v[52:55]
    ds_read_b64_tr_b16 v[162:163], v15 offset:34816
    s_waitcnt lgkmcnt(14)
    v_mfma_f32_16x16x32_bf16 v[56:59], v[88:91], v[128:131], v[56:59]
    ds_read_b64_tr_b16 v[176:177], v15 offset:40960
    v_mfma_f32_16x16x32_bf16 v[56:59], v[104:107], v[144:147], v[56:59]
    ds_read_b64_tr_b16 v[178:179], v15 offset:43008
    v_mfma_f32_16x16x32_bf16 v[60:63], v[92:95], v[128:131], v[60:63]
    ds_read_b64_tr_b16 v[164:165], v16 offset:32768
    v_mfma_f32_16x16x32_bf16 v[60:63], v[108:111], v[144:147], v[60:63]
    ds_read_b64_tr_b16 v[166:167], v16 offset:34816
    v_mfma_f32_16x16x32_bf16 v[64:67], v[96:99], v[128:131], v[64:67]
    ds_read_b64_tr_b16 v[180:181], v16 offset:40960
    v_mfma_f32_16x16x32_bf16 v[64:67], v[112:115], v[144:147], v[64:67]
    ds_read_b64_tr_b16 v[182:183], v16 offset:43008
    v_mfma_f32_16x16x32_bf16 v[68:71], v[100:103], v[128:131], v[68:71]
    ds_read_b128 v[188:191], v8 offset:33024
    v_mfma_f32_16x16x32_bf16 v[68:71], v[116:119], v[144:147], v[68:71]
    ds_read_b128 v[204:207], v8 offset:35072
    v_mfma_f32_16x16x32_bf16 v[72:75], v[88:91], v[132:135], v[72:75]
    ds_read_b128 v[192:195], v8 offset:36864
    v_mfma_f32_16x16x32_bf16 v[72:75], v[104:107], v[148:151], v[72:75]
    ds_read_b128 v[208:211], v8 offset:38912
    v_mfma_f32_16x16x32_bf16 v[76:79], v[92:95], v[132:135], v[76:79]
    ds_read_b128 v[196:199], v8 offset:37120
    v_mfma_f32_16x16x32_bf16 v[76:79], v[108:111], v[148:151], v[76:79]
    ds_read_b128 v[212:215], v8 offset:39168
    v_mfma_f32_16x16x32_bf16 v[80:83], v[96:99], v[132:135], v[80:83]
    v_mfma_f32_16x16x32_bf16 v[80:83], v[112:115], v[148:151], v[80:83]
    v_mfma_f32_16x16x32_bf16 v[84:87], v[100:103], v[132:135], v[84:87]
    v_mfma_f32_16x16x32_bf16 v[84:87], v[116:119], v[148:151], v[84:87]
    s_waitcnt lgkmcnt(14)
    v_mfma_f32_16x16x32_bf16 v[24:27], v[152:155], v[184:187], v[24:27]
    v_mfma_f32_16x16x32_bf16 v[24:27], v[168:171], v[200:203], v[24:27]
    v_mfma_f32_16x16x32_bf16 v[28:31], v[156:159], v[184:187], v[28:31]
    v_mfma_f32_16x16x32_bf16 v[28:31], v[172:175], v[200:203], v[28:31]
    s_barrier
    s_waitcnt lgkmcnt(6)
    v_mfma_f32_16x16x32_bf16 v[32:35], v[160:163], v[184:187], v[32:35]
    ds_read_b128 v[120:123], v7 offset:0
    v_mfma_f32_16x16x32_bf16 v[32:35], v[176:179], v[200:203], v[32:35]
    ds_read_b64_tr_b16 v[88:89], v9 offset:0
    v_mfma_f32_16x16x32_bf16 v[36:39], v[164:167], v[184:187], v[36:39]
    ds_read_b64_tr_b16 v[90:91], v9 offset:2048
    v_mfma_f32_16x16x32_bf16 v[36:39], v[180:183], v[200:203], v[36:39]
    ds_read_b128 v[136:139], v7 offset:2048
    s_waitcnt lgkmcnt(8)
    v_mfma_f32_16x16x32_bf16 v[40:43], v[152:155], v[188:191], v[40:43]
    ds_read_b64_tr_b16 v[104:105], v9 offset:8192
    v_mfma_f32_16x16x32_bf16 v[40:43], v[168:171], v[204:207], v[40:43]
    ds_read_b64_tr_b16 v[106:107], v9 offset:10240
    v_mfma_f32_16x16x32_bf16 v[44:47], v[156:159], v[188:191], v[44:47]
    ds_read_b64_tr_b16 v[92:93], v10 offset:0
    v_mfma_f32_16x16x32_bf16 v[44:47], v[172:175], v[204:207], v[44:47]
    ds_read_b64_tr_b16 v[94:95], v10 offset:2048
    v_mfma_f32_16x16x32_bf16 v[48:51], v[160:163], v[188:191], v[48:51]
    ds_read_b64_tr_b16 v[108:109], v10 offset:8192
    v_mfma_f32_16x16x32_bf16 v[48:51], v[176:179], v[204:207], v[48:51]
    ds_read_b64_tr_b16 v[110:111], v10 offset:10240
    v_mfma_f32_16x16x32_bf16 v[52:55], v[164:167], v[188:191], v[52:55]
    ds_read_b64_tr_b16 v[96:97], v11 offset:0
    v_mfma_f32_16x16x32_bf16 v[52:55], v[180:183], v[204:207], v[52:55]
    ds_read_b64_tr_b16 v[98:99], v11 offset:2048
    s_waitcnt lgkmcnt(14)
    v_mfma_f32_16x16x32_bf16 v[56:59], v[152:155], v[192:195], v[56:59]
    ds_read_b64_tr_b16 v[112:113], v11 offset:8192
    v_mfma_f32_16x16x32_bf16 v[56:59], v[168:171], v[208:211], v[56:59]
    ds_read_b64_tr_b16 v[114:115], v11 offset:10240
    v_mfma_f32_16x16x32_bf16 v[60:63], v[156:159], v[192:195], v[60:63]
    ds_read_b64_tr_b16 v[100:101], v12 offset:0
    v_mfma_f32_16x16x32_bf16 v[60:63], v[172:175], v[208:211], v[60:63]
    ds_read_b64_tr_b16 v[102:103], v12 offset:2048
    v_mfma_f32_16x16x32_bf16 v[64:67], v[160:163], v[192:195], v[64:67]
    ds_read_b64_tr_b16 v[116:117], v12 offset:8192
    v_mfma_f32_16x16x32_bf16 v[64:67], v[176:179], v[208:211], v[64:67]
    ds_read_b64_tr_b16 v[118:119], v12 offset:10240
    v_mfma_f32_16x16x32_bf16 v[68:71], v[164:167], v[192:195], v[68:71]
    ds_read_b128 v[124:127], v7 offset:256
    v_mfma_f32_16x16x32_bf16 v[68:71], v[180:183], v[208:211], v[68:71]
    ds_read_b128 v[140:143], v7 offset:2304
    v_mfma_f32_16x16x32_bf16 v[72:75], v[152:155], v[196:199], v[72:75]
    ds_read_b128 v[128:131], v7 offset:4096
    v_mfma_f32_16x16x32_bf16 v[72:75], v[168:171], v[212:215], v[72:75]
    ds_read_b128 v[144:147], v7 offset:6144
    v_mfma_f32_16x16x32_bf16 v[76:79], v[156:159], v[196:199], v[76:79]
    ds_read_b128 v[132:135], v7 offset:4352
    v_mfma_f32_16x16x32_bf16 v[76:79], v[172:175], v[212:215], v[76:79]
    ds_read_b128 v[148:151], v7 offset:6400
    v_mfma_f32_16x16x32_bf16 v[80:83], v[160:163], v[196:199], v[80:83]
    v_mfma_f32_16x16x32_bf16 v[80:83], v[176:179], v[212:215], v[80:83]
    v_mfma_f32_16x16x32_bf16 v[84:87], v[164:167], v[196:199], v[84:87]
    v_mfma_f32_16x16x32_bf16 v[84:87], v[180:183], v[212:215], v[84:87]
    s_waitcnt lgkmcnt(14)
    v_mfma_f32_16x16x32_bf16 v[24:27], v[88:91], v[120:123], v[24:27]
    v_mfma_f32_16x16x32_bf16 v[24:27], v[104:107], v[136:139], v[24:27]
    v_mfma_f32_16x16x32_bf16 v[28:31], v[92:95], v[120:123], v[28:31]
    v_mfma_f32_16x16x32_bf16 v[28:31], v[108:111], v[136:139], v[28:31]
    s_barrier
    s_waitcnt lgkmcnt(6)
    v_mfma_f32_16x16x32_bf16 v[32:35], v[96:99], v[120:123], v[32:35]
    ds_read_b128 v[184:187], v7 offset:32768
    v_mfma_f32_16x16x32_bf16 v[32:35], v[112:115], v[136:139], v[32:35]
    ds_read_b64_tr_b16 v[152:153], v9 offset:32768
    v_mfma_f32_16x16x32_bf16 v[36:39], v[100:103], v[120:123], v[36:39]
    ds_read_b64_tr_b16 v[154:155], v9 offset:34816
    v_mfma_f32_16x16x32_bf16 v[36:39], v[116:119], v[136:139], v[36:39]
    ds_read_b128 v[200:203], v7 offset:34816
    s_waitcnt lgkmcnt(8)
    v_mfma_f32_16x16x32_bf16 v[40:43], v[88:91], v[124:127], v[40:43]
    ds_read_b64_tr_b16 v[168:169], v9 offset:40960
    v_mfma_f32_16x16x32_bf16 v[40:43], v[104:107], v[140:143], v[40:43]
    ds_read_b64_tr_b16 v[170:171], v9 offset:43008
    v_mfma_f32_16x16x32_bf16 v[44:47], v[92:95], v[124:127], v[44:47]
    ds_read_b64_tr_b16 v[156:157], v10 offset:32768
    v_mfma_f32_16x16x32_bf16 v[44:47], v[108:111], v[140:143], v[44:47]
    ds_read_b64_tr_b16 v[158:159], v10 offset:34816
    v_mfma_f32_16x16x32_bf16 v[48:51], v[96:99], v[124:127], v[48:51]
    ds_read_b64_tr_b16 v[172:173], v10 offset:40960
    v_mfma_f32_16x16x32_bf16 v[48:51], v[112:115], v[140:143], v[48:51]
    ds_read_b64_tr_b16 v[174:175], v10 offset:43008
    v_mfma_f32_16x16x32_bf16 v[52:55], v[100:103], v[124:127], v[52:55]
    ds_read_b64_tr_b16 v[160:161], v11 offset:32768
    v_mfma_f32_16x16x32_bf16 v[52:55], v[116:119], v[140:143], v[52:55]
    ds_read_b64_tr_b16 v[162:163], v11 offset:34816
    s_waitcnt lgkmcnt(14)
    v_mfma_f32_16x16x32_bf16 v[56:59], v[88:91], v[128:131], v[56:59]
    ds_read_b64_tr_b16 v[176:177], v11 offset:40960
    v_mfma_f32_16x16x32_bf16 v[56:59], v[104:107], v[144:147], v[56:59]
    ds_read_b64_tr_b16 v[178:179], v11 offset:43008
    v_mfma_f32_16x16x32_bf16 v[60:63], v[92:95], v[128:131], v[60:63]
    ds_read_b64_tr_b16 v[164:165], v12 offset:32768
    v_mfma_f32_16x16x32_bf16 v[60:63], v[108:111], v[144:147], v[60:63]
    ds_read_b64_tr_b16 v[166:167], v12 offset:34816
    v_mfma_f32_16x16x32_bf16 v[64:67], v[96:99], v[128:131], v[64:67]
    ds_read_b64_tr_b16 v[180:181], v12 offset:40960
    v_mfma_f32_16x16x32_bf16 v[64:67], v[112:115], v[144:147], v[64:67]
    ds_read_b64_tr_b16 v[182:183], v12 offset:43008
    v_mfma_f32_16x16x32_bf16 v[68:71], v[100:103], v[128:131], v[68:71]
    ds_read_b128 v[188:191], v7 offset:33024
    v_mfma_f32_16x16x32_bf16 v[68:71], v[116:119], v[144:147], v[68:71]
    ds_read_b128 v[204:207], v7 offset:35072
    v_mfma_f32_16x16x32_bf16 v[72:75], v[88:91], v[132:135], v[72:75]
    ds_read_b128 v[192:195], v7 offset:36864
    v_mfma_f32_16x16x32_bf16 v[72:75], v[104:107], v[148:151], v[72:75]
    ds_read_b128 v[208:211], v7 offset:38912
    v_mfma_f32_16x16x32_bf16 v[76:79], v[92:95], v[132:135], v[76:79]
    ds_read_b128 v[196:199], v7 offset:37120
    v_mfma_f32_16x16x32_bf16 v[76:79], v[108:111], v[148:151], v[76:79]
    ds_read_b128 v[212:215], v7 offset:39168
    v_mfma_f32_16x16x32_bf16 v[80:83], v[96:99], v[132:135], v[80:83]
    v_mfma_f32_16x16x32_bf16 v[80:83], v[112:115], v[148:151], v[80:83]
    v_mfma_f32_16x16x32_bf16 v[84:87], v[100:103], v[132:135], v[84:87]
    v_mfma_f32_16x16x32_bf16 v[84:87], v[116:119], v[148:151], v[84:87]
    s_waitcnt lgkmcnt(14)
    v_mfma_f32_16x16x32_bf16 v[24:27], v[152:155], v[184:187], v[24:27]
    v_mfma_f32_16x16x32_bf16 v[24:27], v[168:171], v[200:203], v[24:27]
    v_mfma_f32_16x16x32_bf16 v[28:31], v[156:159], v[184:187], v[28:31]
    v_mfma_f32_16x16x32_bf16 v[28:31], v[172:175], v[200:203], v[28:31]
    s_barrier
    s_waitcnt lgkmcnt(6)
    v_mfma_f32_16x16x32_bf16 v[32:35], v[160:163], v[184:187], v[32:35]
    ds_read_b128 v[120:123], v8 offset:0
    v_mfma_f32_16x16x32_bf16 v[32:35], v[176:179], v[200:203], v[32:35]
    ds_read_b64_tr_b16 v[88:89], v13 offset:0
    v_mfma_f32_16x16x32_bf16 v[36:39], v[164:167], v[184:187], v[36:39]
    ds_read_b64_tr_b16 v[90:91], v13 offset:2048
    v_mfma_f32_16x16x32_bf16 v[36:39], v[180:183], v[200:203], v[36:39]
    ds_read_b128 v[136:139], v8 offset:2048
    s_waitcnt lgkmcnt(8)
    v_mfma_f32_16x16x32_bf16 v[40:43], v[152:155], v[188:191], v[40:43]
    ds_read_b64_tr_b16 v[104:105], v13 offset:8192
    v_mfma_f32_16x16x32_bf16 v[40:43], v[168:171], v[204:207], v[40:43]
    ds_read_b64_tr_b16 v[106:107], v13 offset:10240
    v_mfma_f32_16x16x32_bf16 v[44:47], v[156:159], v[188:191], v[44:47]
    ds_read_b64_tr_b16 v[92:93], v14 offset:0
    v_mfma_f32_16x16x32_bf16 v[44:47], v[172:175], v[204:207], v[44:47]
    ds_read_b64_tr_b16 v[94:95], v14 offset:2048
    v_mfma_f32_16x16x32_bf16 v[48:51], v[160:163], v[188:191], v[48:51]
    ds_read_b64_tr_b16 v[108:109], v14 offset:8192
    v_mfma_f32_16x16x32_bf16 v[48:51], v[176:179], v[204:207], v[48:51]
    ds_read_b64_tr_b16 v[110:111], v14 offset:10240
    v_mfma_f32_16x16x32_bf16 v[52:55], v[164:167], v[188:191], v[52:55]
    ds_read_b64_tr_b16 v[96:97], v15 offset:0
    v_mfma_f32_16x16x32_bf16 v[52:55], v[180:183], v[204:207], v[52:55]
    ds_read_b64_tr_b16 v[98:99], v15 offset:2048
    s_waitcnt lgkmcnt(14)
    v_mfma_f32_16x16x32_bf16 v[56:59], v[152:155], v[192:195], v[56:59]
    ds_read_b64_tr_b16 v[112:113], v15 offset:8192
    v_mfma_f32_16x16x32_bf16 v[56:59], v[168:171], v[208:211], v[56:59]
    ds_read_b64_tr_b16 v[114:115], v15 offset:10240
    v_mfma_f32_16x16x32_bf16 v[60:63], v[156:159], v[192:195], v[60:63]
    ds_read_b64_tr_b16 v[100:101], v16 offset:0
    v_mfma_f32_16x16x32_bf16 v[60:63], v[172:175], v[208:211], v[60:63]
    ds_read_b64_tr_b16 v[102:103], v16 offset:2048
    v_mfma_f32_16x16x32_bf16 v[64:67], v[160:163], v[192:195], v[64:67]
    ds_read_b64_tr_b16 v[116:117], v16 offset:8192
    v_mfma_f32_16x16x32_bf16 v[64:67], v[176:179], v[208:211], v[64:67]
    ds_read_b64_tr_b16 v[118:119], v16 offset:10240
    v_mfma_f32_16x16x32_bf16 v[68:71], v[164:167], v[192:195], v[68:71]
    ds_read_b128 v[124:127], v8 offset:256
    v_mfma_f32_16x16x32_bf16 v[68:71], v[180:183], v[208:211], v[68:71]
    ds_read_b128 v[140:143], v8 offset:2304
    v_mfma_f32_16x16x32_bf16 v[72:75], v[152:155], v[196:199], v[72:75]
    ds_read_b128 v[128:131], v8 offset:4096
    v_mfma_f32_16x16x32_bf16 v[72:75], v[168:171], v[212:215], v[72:75]
    ds_read_b128 v[144:147], v8 offset:6144
    v_mfma_f32_16x16x32_bf16 v[76:79], v[156:159], v[196:199], v[76:79]
    ds_read_b128 v[132:135], v8 offset:4352
    v_mfma_f32_16x16x32_bf16 v[76:79], v[172:175], v[212:215], v[76:79]
    ds_read_b128 v[148:151], v8 offset:6400
    v_mfma_f32_16x16x32_bf16 v[80:83], v[160:163], v[196:199], v[80:83]
    v_mfma_f32_16x16x32_bf16 v[80:83], v[176:179], v[212:215], v[80:83]
    v_mfma_f32_16x16x32_bf16 v[84:87], v[164:167], v[196:199], v[84:87]
    v_mfma_f32_16x16x32_bf16 v[84:87], v[180:183], v[212:215], v[84:87]
    s_sub_u32 s34, s34, 1
    s_cmp_lg_u32 s34, 0
    s_cbranch_scc1 f_l4
    s_waitcnt lgkmcnt(14)
    v_mfma_f32_16x16x32_bf16 v[24:27], v[88:91], v[120:123], v[24:27]
    v_mfma_f32_16x16x32_bf16 v[24:27], v[104:107], v[136:139], v[24:27]
    v_mfma_f32_16x16x32_bf16 v[28:31], v[92:95], v[120:123], v[28:31]
    v_mfma_f32_16x16x32_bf16 v[28:31], v[108:111], v[136:139], v[28:31]
    s_barrier
    s_waitcnt lgkmcnt(6)
    v_mfma_f32_16x16x32_bf16 v[32:35], v[96:99], v[120:123], v[32:35]
    ds_read_b128 v[184:187], v8 offset:32768
    v_mfma_f32_16x16x32_bf16 v[32:35], v[112:115], v[136:139], v[32:35]
    ds_read_b64_tr_b16 v[152:153], v13 offset:32768
    v_mfma_f32_16x16x32_bf16 v[36:39], v[100:103], v[120:123], v[36:39]
    ds_read_b64_tr_b16 v[154:155], v13 offset:34816
    v_mfma_f32_16x16x32_bf16 v[36:39], v[116:119], v[136:139], v[36:39]
    ds_read_b128 v[200:203], v8 offset:34816
    s_waitcnt lgkmcnt(8)
    v_mfma_f32_16x16x32_bf16 v[40:43], v[88:91], v[124:127], v[40:43]
    ds_read_b64_tr_b16 v[168:169], v13 offset:40960
    v_mfma_f32_16x16x32_bf16 v[40:43], v[104:107], v[140:143], v[40:43]
    ds_read_b64_tr_b16 v[170:171], v13 offset:43008
    v_mfma_f32_16x16x32_bf16 v[44:47], v[92:95], v[124:127], v[44:47]
    ds_read_b64_tr_b16 v[156:157], v14 offset:32768
    v_mfma_f32_16x16x32_bf16 v[44:47], v[108:111], v[140:143], v[44:47]
    ds_read_b64_tr_b16 v[158:159], v14 offset:34816
    v_mfma_f32_16x16x32_bf16 v[48:51], v[96:99], v[124:127], v[48:51]
    ds_read_b64_tr_b16 v[172:173], v14 offset:40960
    v_mfma_f32_16x16x32_bf16 v[48:51], v[112:115], v[140:143], v[48:51]
    ds_read_b64_tr_b16 v[174:175], v14 offset:43008
    v_mfma_f32_16x16x32_bf16 v[52:55], v[100:103], v[124:127], v[52:55]
    ds_read_b64_tr_b16 v[160:161], v15 offset:32768
    v_mfma_f32_16x16x32_bf16 v[52:55], v[116:119], v[140:143], v[52:55]
    ds_read_b64_tr_b16 v[162:163], v15 offset:34816
    s_waitcnt lgkmcnt(14)
    v_mfma_f32_16x16x32_bf16 v[56:59], v[88:91], v[128:131], v[56:59]
    ds_read_b64_tr_b16 v[176:177], v15 offset:40960
    v_mfma_f32_16x16x32_bf16 v[56:59], v[104:107], v[144:147], v[56:59]
    ds_read_b64_tr_b16 v[178:179], v15 offset:43008
    v_mfma_f32_16x16x32_bf16 v[60:63], v[92:95], v[128:131], v[60:63]
    ds_read_b64_tr_b16 v[164:165], v16 offset:32768
    v_mfma_f32_16x16x32_bf16 v[60:63], v[108:111], v[144:147], v[60:63]
    ds_read_b64_tr_b16 v[166:167], v16 offset:34816
    v_mfma_f32_16x16x32_bf16 v[64:67], v[96:99], v[128:131], v[64:67]
    ds_read_b64_tr_b16 v[180:181], v16 offset:40960
    v_mfma_f32_16x16x32_bf16 v[64:67], v[112:115], v[144:147], v[64:67]
    ds_read_b64_tr_b16 v[182:183], v16 offset:43008
    v_mfma_f32_16x16x32_bf16 v[68:71], v[100:103], v[128:131], v[68:71]
    ds_read_b128 v[188:191], v8 offset:33024
    v_mfma_f32_16x16x32_bf16 v[68:71], v[116:119], v[144:147], v[68:71]
    ds_read_b128 v[204:207], v8 offset:35072
    v_mfma_f32_16x16x32_bf16 v[72:75], v[88:91], v[132:135], v[72:75]
    ds_read_b128 v[192:195], v8 offset:36864
    v_mfma_f32_16x16x32_bf16 v[72:75], v[104:107], v[148:151], v[72:75]
    ds_read_b128 v[208:211], v8 offset:38912
    v_mfma_f32_16x16x32_bf16 v[76:79], v[92:95], v[132:135], v[76:79]
    ds_read_b128 v[196:199], v8 offset:37120
    v_mfma_f32_16x16x32_bf16 v[76:79], v[108:111], v[148:151], v[76:79]
    ds_read_b128 v[212:215], v8 offset:39168
    v_mfma_f32_16x16x32_bf16 v[80:83], v[96:99], v[132:135], v[80:83]
    v_mfma_f32_16x16x32_bf16 v[80:83], v[112:115], v[148:151], v[80:83]
    v_mfma_f32_16x16x32_bf16 v[84:87], v[100:103], v[132:135], v[84:87]
    v_mfma_f32_16x16x32_bf16 v[84:87], v[116:119], v[148:151], v[84:87]
    s_waitcnt lgkmcnt(14)
    v_mfma_f32_16x16x32_bf16 v[24:27], v[152:155], v[184:187], v[24:27]
    v_mfma_f32_16x16x32_bf16 v[24:27], v[168:171], v[200:203], v[24:27]
    v_mfma_f32_16x16x32_bf16 v[28:31], v[156:159], v[184:187], v[28:31]
    v_mfma_f32_16x16x32_bf16 v[28:31], v[172:175], v[200:203], v[28:31]
    s_barrier
    s_waitcnt lgkmcnt(6)
    v_mfma_f32_16x16x32_bf16 v[32:35], v[160:163], v[184:187], v[32:35]
    ds_read_b128 v[120:123], v7 offset:0
    v_mfma_f32_16x16x32_bf16 v[32:35], v[176:179], v[200:203], v[32:35]
    ds_read_b64_tr_b16 v[88:89], v9 offset:0
    v_mfma_f32_16x16x32_bf16 v[36:39], v[164:167], v[184:187], v[36:39]
    ds_read_b64_tr_b16 v[90:91], v9 offset:2048
    v_mfma_f32_16x16x32_bf16 v[36:39], v[180:183], v[200:203], v[36:39]
    ds_read_b128 v[136:139], v7 offset:2048
    s_waitcnt lgkmcnt(8)
    v_mfma_f32_16x16x32_bf16 v[40:43], v[152:155], v[188:191], v[40:43]
    ds_read_b64_tr_b16 v[104:105], v9 offset:8192
    v_mfma_f32_16x16x32_bf16 v[40:43], v[168:171], v[204:207], v[40:43]
    ds_read_b64_tr_b16 v[106:107], v9 offset:10240
    v_mfma_f32_16x16x32_bf16 v[44:47], v[156:159], v[188:191], v[44:47]
    ds_read_b64_tr_b16 v[92:93], v10 offset:0
    v_mfma_f32_16x16x32_bf16 v[44:47], v[172:175], v[204:207], v[44:47]
    ds_read_b64_tr_b16 v[94:95], v10 offset:2048
    v_mfma_f32_16x16x32_bf16 v[48:51], v[160:163], v[188:191], v[48:51]
    ds_read_b64_tr_b16 v[108:109], v10 offset:8192
    v_mfma_f32_16x16x32_bf16 v[48:51], v[176:179], v[204:207], v[48:51]
    ds_read_b64_tr_b16 v[110:111], v10 offset:10240
    v_mfma_f32_16x16x32_bf16 v[52:55], v[164:167], v[188:191], v[52:55]
    ds_read_b64_tr_b16 v[96:97], v11 offset:0
    v_mfma_f32_16x16x32_bf16 v[52:55], v[180:183], v[204:207], v[52:55]
    ds_read_b64_tr_b16 v[98:99], v11 offset:2048
    s_waitcnt lgkmcnt(14)
    v_mfma_f32_16x16x32_bf16 v[56:59], v[152:155], v[192:195], v[56:59]
    ds_read_b64_tr_b16 v[112:113], v11 offset:8192
    v_mfma_f32_16x16x32_bf16 v[56:59], v[168:171], v[208:211], v[56:59]
    ds_read_b64_tr_b16 v[114:115], v11 offset:10240
    v_mfma_f32_16x16x32_bf16 v[60:63], v[156:159], v[192:195], v[60:63]
    ds_read_b64_tr_b16 v[100:101], v12 offset:0
    v_mfma_f32_16x16x32_bf16 v[60:63], v[172:175], v[208:211], v[60:63]
    ds_read_b64_tr_b16 v[102:103], v12 offset:2048
    v_mfma_f32_16x16x32_bf16 v[64:67], v[160:163], v[192:195], v[64:67]
    ds_read_b64_tr_b16 v[116:117], v12 offset:8192
    v_mfma_f32_16x16x32_bf16 v[64:67], v[176:179], v[208:211], v[64:67]
    ds_read_b64_tr_b16 v[118:119], v12 offset:10240
    v_mfma_f32_16x16x32_bf16 v[68:71], v[164:167], v[192:195], v[68:71]
    ds_read_b128 v[124:127], v7 offset:256
    v_mfma_f32_16x16x32_bf16 v[68:71], v[180:183], v[208:211], v[68:71]
    ds_read_b128 v[140:143], v7 offset:2304
    v_mfma_f32_16x16x32_bf16 v[72:75], v[152:155], v[196:199], v[72:75]
    ds_read_b128 v[128:131], v7 offset:4096
    v_mfma_f32_16x16x32_bf16 v[72:75], v[168:171], v[212:215], v[72:75]
    ds_read_b128 v[144:147], v7 offset:6144
    v_mfma_f32_16x16x32_bf16 v[76:79], v[156:159], v[196:199], v[76:79]
    ds_read_b128 v[132:135], v7 offset:4352
    v_mfma_f32_16x16x32_bf16 v[76:79], v[172:175], v[212:215], v[76:79]
    ds_read_b128 v[148:151], v7 offset:6400
    v_mfma_f32_16x16x32_bf16 v[80:83], v[160:163], v[196:199], v[80:83]
    v_mfma_f32_16x16x32_bf16 v[80:83], v[176:179], v[212:215], v[80:83]
    v_mfma_f32_16x16x32_bf16 v[84:87], v[164:167], v[196:199], v[84:87]
    v_mfma_f32_16x16x32_bf16 v[84:87], v[180:183], v[212:215], v[84:87]
    s_and_b32 s50, s3, 3
    s_lshl_b32 s32, s35, 2
    s_add_u32 s32, s32, s50
    s_lshl_b32 s32, s32, 2
    s_add_u32 s32, s32, s39
    s_lshl_b32 s32, s32, 14
    s_add_u32 s32, s32, 59244544
    s_add_u32 s33, s32, 8192
    s_mov_b32 s58, 0x05030201
    s_mov_b32 s59, 0x06050302
    s_mov_b32 s60, 0x07060503
    v_add_u32 v3, 98304, v0
    s_waitcnt lgkmcnt(14)
    v_mfma_f32_16x16x32_bf16 v[24:27], v[88:91], v[120:123], v[24:27]
    v_mfma_f32_16x16x32_bf16 v[24:27], v[104:107], v[136:139], v[24:27]
    v_mfma_f32_16x16x32_bf16 v[28:31], v[92:95], v[120:123], v[28:31]
    v_mfma_f32_16x16x32_bf16 v[28:31], v[108:111], v[136:139], v[28:31]
    s_barrier
    s_waitcnt lgkmcnt(6)
    v_mfma_f32_16x16x32_bf16 v[32:35], v[96:99], v[120:123], v[32:35]
    ds_read_b128 v[184:187], v7 offset:32768
    v_mfma_f32_16x16x32_bf16 v[32:35], v[112:115], v[136:139], v[32:35]
    ds_read_b64_tr_b16 v[152:153], v9 offset:32768
    v_mfma_f32_16x16x32_bf16 v[36:39], v[100:103], v[120:123], v[36:39]
    ds_read_b64_tr_b16 v[154:155], v9 offset:34816
    v_mfma_f32_16x16x32_bf16 v[36:39], v[116:119], v[136:139], v[36:39]
    ds_read_b128 v[200:203], v7 offset:34816
    s_waitcnt lgkmcnt(8)
    v_mfma_f32_16x16x32_bf16 v[40:43], v[88:91], v[124:127], v[40:43]
    ds_read_b64_tr_b16 v[168:169], v9 offset:40960
    v_mfma_f32_16x16x32_bf16 v[40:43], v[104:107], v[140:143], v[40:43]
    ds_read_b64_tr_b16 v[170:171], v9 offset:43008
    v_mfma_f32_16x16x32_bf16 v[44:47], v[92:95], v[124:127], v[44:47]
    ds_read_b64_tr_b16 v[156:157], v10 offset:32768
    v_mfma_f32_16x16x32_bf16 v[44:47], v[108:111], v[140:143], v[44:47]
    ds_read_b64_tr_b16 v[158:159], v10 offset:34816
    v_mfma_f32_16x16x32_bf16 v[48:51], v[96:99], v[124:127], v[48:51]
    ds_read_b64_tr_b16 v[172:173], v10 offset:40960
    v_mfma_f32_16x16x32_bf16 v[48:51], v[112:115], v[140:143], v[48:51]
    ds_read_b64_tr_b16 v[174:175], v10 offset:43008
    v_mfma_f32_16x16x32_bf16 v[52:55], v[100:103], v[124:127], v[52:55]
    ds_read_b64_tr_b16 v[160:161], v11 offset:32768
    v_mfma_f32_16x16x32_bf16 v[52:55], v[116:119], v[140:143], v[52:55]
    ds_read_b64_tr_b16 v[162:163], v11 offset:34816
    s_waitcnt lgkmcnt(14)
    v_mfma_f32_16x16x32_bf16 v[56:59], v[88:91], v[128:131], v[56:59]
    ds_read_b64_tr_b16 v[176:177], v11 offset:40960
    v_mfma_f32_16x16x32_bf16 v[56:59], v[104:107], v[144:147], v[56:59]
    ds_read_b64_tr_b16 v[178:179], v11 offset:43008
    v_mfma_f32_16x16x32_bf16 v[60:63], v[92:95], v[128:131], v[60:63]
    ds_read_b64_tr_b16 v[164:165], v12 offset:32768
    v_mfma_f32_16x16x32_bf16 v[60:63], v[108:111], v[144:147], v[60:63]
    ds_read_b64_tr_b16 v[166:167], v12 offset:34816
    v_mfma_f32_16x16x32_bf16 v[64:67], v[96:99], v[128:131], v[64:67]
    ds_read_b64_tr_b16 v[180:181], v12 offset:40960
    v_mfma_f32_16x16x32_bf16 v[64:67], v[112:115], v[144:147], v[64:67]
    ds_read_b64_tr_b16 v[182:183], v12 offset:43008
    v_mfma_f32_16x16x32_bf16 v[68:71], v[100:103], v[128:131], v[68:71]
    ds_read_b128 v[188:191], v7 offset:33024
    v_mfma_f32_16x16x32_bf16 v[68:71], v[116:119], v[144:147], v[68:71]
    ds_read_b128 v[204:207], v7 offset:35072
    v_mfma_f32_16x16x32_bf16 v[72:75], v[88:91], v[132:135], v[72:75]
    ds_read_b128 v[192:195], v7 offset:36864
    v_mfma_f32_16x16x32_bf16 v[72:75], v[104:107], v[148:151], v[72:75]
    ds_read_b128 v[208:211], v7 offset:38912
    v_mfma_f32_16x16x32_bf16 v[76:79], v[92:95], v[132:135], v[76:79]
    ds_read_b128 v[196:199], v7 offset:37120
    v_mfma_f32_16x16x32_bf16 v[76:79], v[108:111], v[148:151], v[76:79]
    ds_read_b128 v[212:215], v7 offset:39168
    v_mfma_f32_16x16x32_bf16 v[80:83], v[96:99], v[132:135], v[80:83]
    v_mfma_f32_16x16x32_bf16 v[80:83], v[112:115], v[148:151], v[80:83]
    v_mfma_f32_16x16x32_bf16 v[84:87], v[100:103], v[132:135], v[84:87]
    v_mfma_f32_16x16x32_bf16 v[84:87], v[116:119], v[148:151], v[84:87]
    s_cmp_eq_u32 s50, s39
    s_cbranch_scc1 f_own
    s_waitcnt lgkmcnt(14)
    v_mfma_f32_16x16x32_bf16 v[24:27], v[152:155], v[184:187], v[24:27]
    v_mfma_f32_16x16x32_bf16 v[24:27], v[168:171], v[200:203], v[24:27]
    v_mfma_f32_16x16x32_bf16 v[28:31], v[156:159], v[184:187], v[28:31]
    v_mfma_f32_16x16x32_bf16 v[28:31], v[172:175], v[200:203], v[28:31]
    s_waitcnt lgkmcnt(6)
    v_mfma_f32_16x16x32_bf16 v[32:35], v[160:163], v[184:187], v[32:35]
    v_mfma_f32_16x16x32_bf16 v[32:35], v[176:179], v[200:203], v[32:35]
    v_mfma_f32_16x16x32_bf16 v[36:39], v[164:167], v[184:187], v[36:39]
    v_mfma_f32_16x16x32_bf16 v[36:39], v[180:183], v[200:203], v[36:39]
    s_nop 0
    v_perm_b32 v24, v25, v24, s58
    v_perm_b32 v25, v26, v25, s59
    v_perm_b32 v26, v27, v26, s60
    v_mov_b32 v27, s37
    buffer_store_dwordx4 v[24:27], v0, s[20:23], s32 offen offset:0 sc1
    s_waitcnt lgkmcnt(4)
    v_mfma_f32_16x16x32_bf16 v[40:43], v[152:155], v[188:191], v[40:43]
    v_mfma_f32_16x16x32_bf16 v[40:43], v[168:171], v[204:207], v[40:43]
    v_perm_b32 v28, v29, v28, s58
    v_perm_b32 v29, v30, v29, s59
    v_perm_b32 v30, v31, v30, s60
    v_mov_b32 v31, s37
    buffer_store_dwordx4 v[28:31], v0, s[20:23], s32 offen offset:1024 sc1
    v_mfma_f32_16x16x32_bf16 v[44:47], v[156:159], v[188:191], v[44:47]
    v_mfma_f32_16x16x32_bf16 v[44:47], v[172:175], v[204:207], v[44:47]
    v_perm_b32 v32, v33, v32, s58
    v_perm_b32 v33, v34, v33, s59
    v_perm_b32 v34, v35, v34, s60
    v_mov_b32 v35, s37
    buffer_store_dwordx4 v[32:35], v0, s[20:23], s32 offen offset:2048 sc1
    v_mfma_f32_16x16x32_bf16 v[48:51], v[160:163], v[188:191], v[48:51]
    v_mfma_f32_16x16x32_bf16 v[48:51], v[176:179], v[204:207], v[48:51]
    v_perm_b32 v36, v37, v36, s58
    v_perm_b32 v37, v38, v37, s59
    v_perm_b32 v38, v39, v38, s60
    v_mov_b32 v39, s37
    buffer_store_dwordx4 v[36:39], v0, s[20:23], s32 offen offset:3072 sc1
    v_mfma_f32_16x16x32_bf16 v[52:55], v[164:167], v[188:191], v[52:55]
    v_mfma_f32_16x16x32_bf16 v[52:55], v[180:183], v[204:207], v[52:55]
    v_perm_b32 v40, v41, v40, s58
    v_perm_b32 v41, v42, v41, s59
    v_perm_b32 v42, v43, v42, s60
    v_mov_b32 v43, s37
    buffer_store_dwordx4 v[40:43], v239, s[20:23], s32 offen offset:0 sc1
    s_waitcnt lgkmcnt(2)
    v_mfma_f32_16x16x32_bf16 v[56:59], v[152:155], v[192:195], v[56:59]
    v_mfma_f32_16x16x32_bf16 v[56:59], v[168:171], v[208:211], v[56:59]
    v_perm_b32 v44, v45, v44, s58
    v_perm_b32 v45, v46, v45, s59
    v_perm_b32 v46, v47, v46, s60
    v_mov_b32 v47, s37
    buffer_store_dwordx4 v[44:47], v239, s[20:23], s32 offen offset:1024 sc1
    v_mfma_f32_16x16x32_bf16 v[60:63], v[156:159], v[192:195], v[60:63]
    v_mfma_f32_16x16x32_bf16 v[60:63], v[172:175], v[208:211], v[60:63]
    v_perm_b32 v48, v49, v48, s58
    v_perm_b32 v49, v50, v49, s59
    v_perm_b32 v50, v51, v50, s60
    v_mov_b32 v51, s37
    buffer_store_dwordx4 v[48:51], v239, s[20:23], s32 offen offset:2048 sc1
    v_mfma_f32_16x16x32_bf16 v[64:67], v[160:163], v[192:195], v[64:67]
    v_mfma_f32_16x16x32_bf16 v[64:67], v[176:179], v[208:211], v[64:67]
    v_perm_b32 v52, v53, v52, s58
    v_perm_b32 v53, v54, v53, s59
    v_perm_b32 v54, v55, v54, s60
    v_mov_b32 v55, s37
    buffer_store_dwordx4 v[52:55], v239, s[20:23], s32 offen offset:3072 sc1
    v_mfma_f32_16x16x32_bf16 v[68:71], v[164:167], v[192:195], v[68:71]
    v_mfma_f32_16x16x32_bf16 v[68:71], v[180:183], v[208:211], v[68:71]
    v_perm_b32 v56, v57, v56, s58
    v_perm_b32 v57, v58, v57, s59
    v_perm_b32 v58, v59, v58, s60
    v_mov_b32 v59, s37
    buffer_store_dwordx4 v[56:59], v0, s[20:23], s33 offen offset:0 sc1
    s_waitcnt lgkmcnt(0)
    v_mfma_f32_16x16x32_bf16 v[72:75], v[152:155], v[196:199], v[72:75]
    v_mfma_f32_16x16x32_bf16 v[72:75], v[168:171], v[212:215], v[72:75]
    v_perm_b32 v60, v61, v60, s58
    v_perm_b32 v61, v62, v61, s59
    v_perm_b32 v62, v63, v62, s60
    v_mov_b32 v63, s37
    buffer_store_dwordx4 v[60:63], v0, s[20:23], s33 offen offset:1024 sc1
    v_mfma_f32_16x16x32_bf16 v[76:79], v[156:159], v[196:199], v[76:79]
    v_mfma_f32_16x16x32_bf16 v[76:79], v[172:175], v[212:215], v[76:79]
    v_perm_b32 v64, v65, v64, s58
    v_perm_b32 v65, v66, v65, s59
    v_perm_b32 v66, v67, v66, s60
    v_mov_b32 v67, s37
    buffer_store_dwordx4 v[64:67], v0, s[20:23], s33 offen offset:2048 sc1
    v_mfma_f32_16x16x32_bf16 v[80:83], v[160:163], v[196:199], v[80:83]
    v_mfma_f32_16x16x32_bf16 v[80:83], v[176:179], v[212:215], v[80:83]
    v_perm_b32 v68, v69, v68, s58
    v_perm_b32 v69, v70, v69, s59
    v_perm_b32 v70, v71, v70, s60
    v_mov_b32 v71, s37
    buffer_store_dwordx4 v[68:71], v0, s[20:23], s33 offen offset:3072 sc1
    v_mfma_f32_16x16x32_bf16 v[84:87], v[164:167], v[196:199], v[84:87]
    v_mfma_f32_16x16x32_bf16 v[84:87], v[180:183], v[212:215], v[84:87]
    v_perm_b32 v72, v73, v72, s58
    v_perm_b32 v73, v74, v73, s59
    v_perm_b32 v74, v75, v74, s60
    v_mov_b32 v75, s37
    buffer_store_dwordx4 v[72:75], v239, s[20:23], s33 offen offset:0 sc1
    v_perm_b32 v76, v77, v76, s58
    v_perm_b32 v77, v78, v77, s59
    v_perm_b32 v78, v79, v78, s60
    v_mov_b32 v79, s37
    buffer_store_dwordx4 v[76:79], v239, s[20:23], s33 offen offset:1024 sc1
    v_perm_b32 v80, v81, v80, s58
    v_perm_b32 v81, v82, v81, s59
    v_perm_b32 v82, v83, v82, s60
    v_mov_b32 v83, s37
    buffer_store_dwordx4 v[80:83], v239, s[20:23], s33 offen offset:2048 sc1
    v_perm_b32 v84, v85, v84, s58
    v_perm_b32 v85, v86, v85, s59
    v_perm_b32 v86, v87, v86, s60
    v_mov_b32 v87, s37
    buffer_store_dwordx4 v[84:87], v239, s[20:23], s33 offen offset:3072 sc1
    s_branch f_sent
f_own:
    s_waitcnt lgkmcnt(14)
    v_mfma_f32_16x16x32_bf16 v[24:27], v[152:155], v[184:187], v[24:27]
    v_mfma_f32_16x16x32_bf16 v[24:27], v[168:171], v[200:203], v[24:27]
    v_mfma_f32_16x16x32_bf16 v[28:31], v[156:159], v[184:187], v[28:31]
    v_mfma_f32_16x16x32_bf16 v[28:31], v[172:175], v[200:203], v[28:31]
    s_waitcnt lgkmcnt(6)
    v_mfma_f32_16x16x32_bf16 v[32:35], v[160:163], v[184:187], v[32:35]
    v_mfma_f32_16x16x32_bf16 v[32:35], v[176:179], v[200:203], v[32:35]
    v_mfma_f32_16x16x32_bf16 v[36:39], v[164:167], v[184:187], v[36:39]
    v_mfma_f32_16x16x32_bf16 v[36:39], v[180:183], v[200:203], v[36:39]
    s_nop 0
    ds_write_b128 v3, v[24:27] offset:0
    s_waitcnt lgkmcnt(5)
    v_mfma_f32_16x16x32_bf16 v[40:43], v[152:155], v[188:191], v[40:43]
    v_mfma_f32_16x16x32_bf16 v[40:43], v[168:171], v[204:207], v[40:43]
    ds_write_b128 v3, v[28:31] offset:1024
    v_mfma_f32_16x16x32_bf16 v[44:47], v[156:159], v[188:191], v[44:47]
    v_mfma_f32_16x16x32_bf16 v[44:47], v[172:175], v[204:207], v[44:47]
    ds_write_b128 v3, v[32:35] offset:2048
    v_mfma_f32_16x16x32_bf16 v[48:51], v[160:163], v[188:191], v[48:51]
    v_mfma_f32_16x16x32_bf16 v[48:51], v[176:179], v[204:207], v[48:51]
    ds_write_b128 v3, v[36:39] offset:3072
    v_mfma_f32_16x16x32_bf16 v[52:55], v[164:167], v[188:191], v[52:55]
    v_mfma_f32_16x16x32_bf16 v[52:55], v[180:183], v[204:207], v[52:55]
    ds_write_b128 v3, v[40:43] offset:4096
    s_waitcnt lgkmcnt(7)
    v_mfma_f32_16x16x32_bf16 v[56:59], v[152:155], v[192:195], v[56:59]
    v_mfma_f32_16x16x32_bf16 v[56:59], v[168:171], v[208:211], v[56:59]
    ds_write_b128 v3, v[44:47] offset:5120
    v_mfma_f32_16x16x32_bf16 v[60:63], v[156:159], v[192:195], v[60:63]
    v_mfma_f32_16x16x32_bf16 v[60:63], v[172:175], v[208:211], v[60:63]
    ds_write_b128 v3, v[48:51] offset:6144
    v_mfma_f32_16x16x32_bf16 v[64:67], v[160:163], v[192:195], v[64:67]
    v_mfma_f32_16x16x32_bf16 v[64:67], v[176:179], v[208:211], v[64:67]
    ds_write_b128 v3, v[52:55] offset:7168
    v_mfma_f32_16x16x32_bf16 v[68:71], v[164:167], v[192:195], v[68:71]
    v_mfma_f32_16x16x32_bf16 v[68:71], v[180:183], v[208:211], v[68:71]
    ds_write_b128 v3, v[56:59] offset:8192
    s_waitcnt lgkmcnt(9)
    v_mfma_f32_16x16x32_bf16 v[72:75], v[152:155], v[196:199], v[72:75]
    v_mfma_f32_16x16x32_bf16 v[72:75], v[168:171], v[212:215], v[72:75]
    ds_write_b128 v3, v[60:63] offset:9216
    v_mfma_f32_16x16x32_bf16 v[76:79], v[156:159], v[196:199], v[76:79]
    v_mfma_f32_16x16x32_bf16 v[76:79], v[172:175], v[212:215], v[76:79]
    ds_write_b128 v3, v[64:67] offset:10240
    v_mfma_f32_16x16x32_bf16 v[80:83], v[160:163], v[196:199], v[80:83]
    v_mfma_f32_16x16x32_bf16 v[80:83], v[176:179], v[212:215], v[80:83]
    ds_write_b128 v3, v[68:71] offset:11264
    v_mfma_f32_16x16x32_bf16 v[84:87], v[164:167], v[196:199], v[84:87]
    v_mfma_f32_16x16x32_bf16 v[84:87], v[180:183], v[212:215], v[84:87]
    ds_write_b128 v3, v[72:75] offset:12288
    s_nop 0
    ds_write_b128 v3, v[76:79] offset:13312
    s_nop 1
    ds_write_b128 v3, v[80:83] offset:14336
    s_nop 1
    ds_write_b128 v3, v[84:87] offset:15360
f_sent:
    s_lshl_b32 s32, s35, 2
    s_add_u32 s32, s32, s39
    s_lshl_b32 s49, s32, 16
    s_lshl_b32 s33, s3, 11
    v_add_u32 v18, s33, v0
    s_sub_u32 s33, s33, 3072
    s_max_i32 s33, s33, 0
    s_add_u32 s33, s33, 1020
    v_mov_b32 v5, s33
    s_add_u32 s49, s49, 59244544
    s_add_u32 s32, s39, 0
    s_and_b32 s32, s32, 3
    s_cmp_eq_u32 s32, 3
    s_cselect_b32 s50, 1.0, 0
    s_add_u32 s32, s39, 1
    s_and_b32 s32, s32, 3
    s_cmp_eq_u32 s32, 3
    s_cselect_b32 s53, 1.0, 0
    s_lshl_b32 s32, s32, 14
    s_add_u32 s43, s32, s49
    s_add_u32 s32, s39, 2
    s_and_b32 s32, s32, 3
    s_cmp_eq_u32 s32, 3
    s_cselect_b32 s46, 1.0, 0
    s_lshl_b32 s32, s32, 14
    s_add_u32 s42, s32, s49
    s_add_u32 s32, s39, 3
    s_and_b32 s32, s32, 3
    s_cmp_eq_u32 s32, 3
    s_cselect_b32 s7, 1.0, 0
    s_lshl_b32 s32, s32, 14
    s_add_u32 s52, s32, s49
    s_mov_b32 s58, 0x0504030c
    s_mov_b32 s59, 0x0403020c
    s_waitcnt lgkmcnt(0)
    s_barrier
    s_lshl_b32 s32, s3, 11
    s_add_u32 s32, s32, 98304
    v_add_u32 v3, s32, v0
    ds_read_b128 v[152:155], v3 offset:0
    ds_read_b128 v[156:159], v3 offset:1024
f_gl:
    buffer_load_dwordx4 v[224:227], v18, s[20:23], s43 offen offset:0 sc1
    buffer_load_dwordx4 v[228:231], v18, s[20:23], s43 offen offset:1024 sc1
    buffer_load_dwordx4 v[232:235], v18, s[20:23], s42 offen offset:0 sc1
    buffer_load_dwordx4 v[236:239], v18, s[20:23], s42 offen offset:1024 sc1
    buffer_load_dwordx4 v[240:243], v18, s[20:23], s52 offen offset:0 sc1
    buffer_load_dwordx4 v[244:247], v18, s[20:23], s52 offen offset:1024 sc1
    s_waitcnt vmcnt(5)
    v_xor_b32 v1, s37, v227
    s_waitcnt vmcnt(4)
    v_xor_b32 v2, s37, v231
    v_or_b32 v1, v1, v2
    s_waitcnt vmcnt(3)
    v_xor_b32 v2, s37, v235
    v_or_b32 v1, v1, v2
    s_waitcnt vmcnt(2)
    v_xor_b32 v2, s37, v239
    v_or_b32 v1, v1, v2
    s_waitcnt vmcnt(1)
    v_xor_b32 v2, s37, v243
    v_or_b32 v1, v1, v2
    s_waitcnt vmcnt(0)
    v_xor_b32 v2, s37, v247
    v_or_b32 v1, v1, v2
    v_cmp_ne_u32 vcc, 0, v1
    s_nop 0
    s_cbranch_vccz f_gok
f_gp:
    s_sub_u32 s38, s38, 1
    s_cselect_b32 s38, 0, s38
    s_cbranch_scc1 f_gok
    s_sleep 1
    s_mov_b64 exec, 1
    buffer_load_dword v225, v5, s[20:23], s43 offen sc1
    buffer_load_dword v226, v5, s[20:23], s42 offen sc1
    buffer_load_dword v227, v5, s[20:23], s52 offen sc1
    s_waitcnt vmcnt(2)
    v_xor_b32 v1, s37, v225
    s_waitcnt vmcnt(1)
    v_xor_b32 v224, s37, v226
    v_or_b32 v1, v1, v224
    s_waitcnt vmcnt(0)
    v_xor_b32 v224, s37, v227
    v_or_b32 v1, v1, v224
    v_cmp_ne_u32 vcc, 0, v1
    s_mov_b64 exec, -1
    s_cbranch_vccnz f_gp
    s_branch f_gl
f_gok:
    v_lshlrev_b32 v160, 8, v224
    v_perm_b32 v161, v225, v224, s58
    v_perm_b32 v162, v226, v225, s59
    v_and_b32 v163, 0xffffff00, v226
    v_lshlrev_b32 v164, 8, v228
    v_perm_b32 v165, v229, v228, s58
    v_perm_b32 v166, v230, v229, s59
    v_and_b32 v167, 0xffffff00, v230
    v_lshlrev_b32 v168, 8, v232
    v_perm_b32 v169, v233, v232, s58
    v_perm_b32 v170, v234, v233, s59
    v_and_b32 v171, 0xffffff00, v234
    v_lshlrev_b32 v172, 8, v236
    v_perm_b32 v173, v237, v236, s58
    v_perm_b32 v174, v238, v237, s59
    v_and_b32 v175, 0xffffff00, v238
    v_lshlrev_b32 v176, 8, v240
    v_perm_b32 v177, v241, v240, s58
    v_perm_b32 v178, v242, v241, s59
    v_and_b32 v179, 0xffffff00, v242
    v_lshlrev_b32 v180, 8, v244
    v_perm_b32 v181, v245, v244, s58
    v_perm_b32 v182, v246, v245, s59
    v_and_b32 v183, 0xffffff00, v246
    v_lshlrev_b32 v208, 16, v20
    v_and_b32 v209, 0xffff0000, v20
    v_lshlrev_b32 v210, 16, v21
    v_and_b32 v211, 0xffff0000, v21
    v_lshlrev_b32 v212, 16, v22
    v_and_b32 v213, 0xffff0000, v22
    v_lshlrev_b32 v214, 16, v23
    v_and_b32 v215, 0xffff0000, v23
    s_waitcnt lgkmcnt(1)
    v_mul_f32 v184, s50, v152
    v_mul_f32 v185, s50, v153
    v_mul_f32 v186, s50, v154
    v_mul_f32 v187, s50, v155
    s_waitcnt lgkmcnt(0)
    v_mul_f32 v188, s50, v156
    v_mul_f32 v189, s50, v157
    v_mul_f32 v190, s50, v158
    v_mul_f32 v191, s50, v159
    s_xor_b32 s50, s50, 1.0
    v_mul_f32 v192, s50, v152
    v_mul_f32 v193, s50, v153
    v_mul_f32 v194, s50, v154
    v_mul_f32 v195, s50, v155
    v_mul_f32 v196, s50, v156
    v_mul_f32 v197, s50, v157
    v_mul_f32 v198, s50, v158
    v_mul_f32 v199, s50, v159
    v_fma_f32 v184, s53, v160, v184
    v_fma_f32 v185, s53, v161, v185
    v_fma_f32 v186, s53, v162, v186
    v_fma_f32 v187, s53, v163, v187
    v_fma_f32 v188, s53, v164, v188
    v_fma_f32 v189, s53, v165, v189
    v_fma_f32 v190, s53, v166, v190
    v_fma_f32 v191, s53, v167, v191
    s_xor_b32 s53, s53, 1.0
    v_fma_f32 v192, s53, v160, v192
    v_fma_f32 v193, s53, v161, v193
    v_fma_f32 v194, s53, v162, v194
    v_fma_f32 v195, s53, v163, v195
    v_fma_f32 v196, s53, v164, v196
    v_fma_f32 v197, s53, v165, v197
    v_fma_f32 v198, s53, v166, v198
    v_fma_f32 v199, s53, v167, v199
    v_fma_f32 v184, s46, v168, v184
    v_fma_f32 v185, s46, v169, v185
    v_fma_f32 v186, s46, v170, v186
    v_fma_f32 v187, s46, v171, v187
    v_fma_f32 v188, s46, v172, v188
    v_fma_f32 v189, s46, v173, v189
    v_fma_f32 v190, s46, v174, v190
    v_fma_f32 v191, s46, v175, v191
    s_xor_b32 s46, s46, 1.0
    v_fma_f32 v192, s46, v168, v192
    v_fma_f32 v193, s46, v169, v193
    v_fma_f32 v194, s46, v170, v194
    v_fma_f32 v195, s46, v171, v195
    v_fma_f32 v196, s46, v172, v196
    v_fma_f32 v197, s46, v173, v197
    v_fma_f32 v198, s46, v174, v198
    v_fma_f32 v199, s46, v175, v199
    v_fma_f32 v184, s7, v176, v184
    v_fma_f32 v185, s7, v177, v185
    v_fma_f32 v186, s7, v178, v186
    v_fma_f32 v187, s7, v179, v187
    v_fma_f32 v188, s7, v180, v188
    v_fma_f32 v189, s7, v181, v189
    v_fma_f32 v190, s7, v182, v190
    v_fma_f32 v191, s7, v183, v191
    s_xor_b32 s7, s7, 1.0
    v_fma_f32 v192, s7, v176, v192
    v_fma_f32 v193, s7, v177, v193
    v_fma_f32 v194, s7, v178, v194
    v_fma_f32 v195, s7, v179, v195
    v_fma_f32 v196, s7, v180, v196
    v_fma_f32 v197, s7, v181, v197
    v_fma_f32 v198, s7, v182, v198
    v_fma_f32 v199, s7, v183, v199
    v_cvt_pk_bf16_f32 v200, v192, v193
    v_cvt_pk_bf16_f32 v201, v194, v195
    v_cvt_pk_bf16_f32 v202, v196, v197
    v_cvt_pk_bf16_f32 v203, v198, v199
    v_lshlrev_b32 v192, 16, v200
    v_and_b32 v193, 0xffff0000, v200
    v_lshlrev_b32 v194, 16, v201
    v_and_b32 v195, 0xffff0000, v201
    v_lshlrev_b32 v196, 16, v202
    v_and_b32 v197, 0xffff0000, v202
    v_lshlrev_b32 v198, 16, v203
    v_and_b32 v199, 0xffff0000, v203
    v_cvt_pk_bf16_f32 v200, v184, v185
    v_cvt_pk_bf16_f32 v201, v186, v187
    v_cvt_pk_bf16_f32 v202, v188, v189
    v_cvt_pk_bf16_f32 v203, v190, v191
    v_lshlrev_b32 v184, 16, v200
    v_and_b32 v185, 0xffff0000, v200
    v_lshlrev_b32 v186, 16, v201
    v_and_b32 v187, 0xffff0000, v201
    v_lshlrev_b32 v188, 16, v202
    v_and_b32 v189, 0xffff0000, v202
    v_lshlrev_b32 v190, 16, v203
    v_and_b32 v191, 0xffff0000, v203
    v_mul_f32 v216, 0xbfb8aa3b, v184
    v_mul_f32 v217, 0xbfb8aa3b, v185
    v_mul_f32 v218, 0xbfb8aa3b, v186
    v_mul_f32 v219, 0xbfb8aa3b, v187
    v_mul_f32 v220, 0xbfb8aa3b, v188
    v_mul_f32 v221, 0xbfb8aa3b, v189
    v_mul_f32 v222, 0xbfb8aa3b, v190
    v_mul_f32 v223, 0xbfb8aa3b, v191
    v_exp_f32 v216, v216
    v_exp_f32 v217, v217
    v_exp_f32 v218, v218
    v_exp_f32 v219, v219
    v_exp_f32 v220, v220
    v_exp_f32 v221, v221
    v_exp_f32 v222, v222
    v_exp_f32 v223, v223
    v_add_f32 v216, 1.0, v216
    v_add_f32 v217, 1.0, v217
    v_add_f32 v218, 1.0, v218
    v_add_f32 v219, 1.0, v219
    v_add_f32 v220, 1.0, v220
    v_add_f32 v221, 1.0, v221
    v_add_f32 v222, 1.0, v222
    v_add_f32 v223, 1.0, v223
    v_rcp_f32 v216, v216
    v_rcp_f32 v217, v217
    v_rcp_f32 v218, v218
    v_rcp_f32 v219, v219
    v_rcp_f32 v220, v220
    v_rcp_f32 v221, v221
    v_rcp_f32 v222, v222
    v_rcp_f32 v223, v223
    v_mul_f32 v216, v216, v184
    v_mul_f32 v217, v217, v185
    v_mul_f32 v218, v218, v186
    v_mul_f32 v219, v219, v187
    v_mul_f32 v220, v220, v188
    v_mul_f32 v221, v221, v189
    v_mul_f32 v222, v222, v190
    v_mul_f32 v223, v223, v191
    v_cvt_pk_bf16_f32 v200, v216, v217
    v_cvt_pk_bf16_f32 v201, v218, v219
    v_cvt_pk_bf16_f32 v202, v220, v221
    v_cvt_pk_bf16_f32 v203, v222, v223
    v_lshlrev_b32 v216, 16, v200
    v_and_b32 v217, 0xffff0000, v200
    v_lshlrev_b32 v218, 16, v201
    v_and_b32 v219, 0xffff0000, v201
    v_lshlrev_b32 v220, 16, v202
    v_and_b32 v221, 0xffff0000, v202
    v_lshlrev_b32 v222, 16, v203
    v_and_b32 v223, 0xffff0000, v203
    v_mul_f32 v216, v216, v192
    v_mul_f32 v217, v217, v193
    v_mul_f32 v218, v218, v194
    v_mul_f32 v219, v219, v195
    v_mul_f32 v220, v220, v196
    v_mul_f32 v221, v221, v197
    v_mul_f32 v222, v222, v198
    v_mul_f32 v223, v223, v199
    v_cvt_pk_bf16_f32 v200, v216, v217
    v_cvt_pk_bf16_f32 v201, v218, v219
    v_cvt_pk_bf16_f32 v202, v220, v221
    v_cvt_pk_bf16_f32 v203, v222, v223
    v_lshlrev_b32 v216, 16, v200
    v_and_b32 v217, 0xffff0000, v200
    v_lshlrev_b32 v218, 16, v201
    v_and_b32 v219, 0xffff0000, v201
    v_lshlrev_b32 v220, 16, v202
    v_and_b32 v221, 0xffff0000, v202
    v_lshlrev_b32 v222, 16, v203
    v_and_b32 v223, 0xffff0000, v203
    v_add_f32 v216, v216, v208
    v_add_f32 v217, v217, v209
    v_add_f32 v218, v218, v210
    v_add_f32 v219, v219, v211
    v_add_f32 v220, v220, v212
    v_add_f32 v221, v221, v213
    v_add_f32 v222, v222, v214
    v_add_f32 v223, v223, v215
    v_cvt_pk_bf16_f32 v200, v216, v217
    v_cvt_pk_bf16_f32 v201, v218, v219
    v_cvt_pk_bf16_f32 v202, v220, v221
    v_cvt_pk_bf16_f32 v203, v222, v223
    buffer_store_dwordx2 v[200:201], v17, s[16:19], 0 offen
    buffer_store_dwordx2 v[202:203], v17, s[16:19], 0 offen offset:32
f_end:
    s_endpgm
f_fs12:
    s_sub_u32 s38, s38, 1
    s_cselect_b32 s38, 0, s38
    s_cbranch_scc1 f_fbB
    s_sleep 1
    ds_read_b32 v241, v240
    s_waitcnt lgkmcnt(0)
    v_cmp_gt_i32 vcc, v245, v241
    s_nop 0
    s_cbranch_vccnz f_fs12
    s_branch f_fbB
f_fs15:
    s_sub_u32 s38, s38, 1
    s_cselect_b32 s38, 0, s38
    s_cbranch_scc1 f_fbA
    s_sleep 1
    ds_read_b32 v241, v240
    s_waitcnt lgkmcnt(0)
    v_cmp_gt_i32 vcc, v245, v241
    s_nop 0
    s_cbranch_vccnz f_fs15
    s_branch f_fbA
f_fs20:
    s_sub_u32 s38, s38, 1
    s_cselect_b32 s38, 0, s38
    s_cbranch_scc1 f_fbN
    s_sleep 1
    ds_read_b32 v241, v240
    s_waitcnt lgkmcnt(0)
    v_cmp_gt_i32 vcc, v245, v241
    s_nop 0
    s_cbranch_vccnz f_fs20
    s_branch f_fbN
f_code_end:
    s_endpgm
.section .rodata,"a"
.p2align 6
.amdhsa_kernel recurrent_scan__compressed_kv_cla__glu_gated_reglu__prompt_kernel
  .amdhsa_next_free_vgpr 256
  .amdhsa_next_free_sgpr 102
  .amdhsa_accum_offset 256
  .amdhsa_group_segment_fixed_size 0
  .amdhsa_kernarg_size 104
  .amdhsa_user_sgpr_count 2
  .amdhsa_user_sgpr_kernarg_segment_ptr 1
  .amdhsa_system_sgpr_workgroup_id_x 1
  .amdhsa_float_denorm_mode_32 3
.end_amdhsa_kernel
```
